```python
import torch

def _softmax(x, axis=-1):
    return torch.softmax(x, dim=axis)

def _gelu(x):
    return torch.nn.functional.gelu(x, approximate='tanh')

def _silu(x):
    return torch.nn.functional.silu(x)

def _sigmoid(x):
    return torch.sigmoid(x)

def _layernorm(x, axis=-1, eps=1e-05):
    m = x.mean(dim=axis, keepdim=True)
    v = x.var(dim=axis, keepdim=True, unbiased=False)
    return (x - m) / torch.sqrt(v + eps)

def _scatter_add(tgt, idx, src, axis=0):
    return tgt.clone().index_add_(axis, idx, src)

def _segment_sum(src, seg, n):
    out = torch.zeros((n,) + src.shape[1:], dtype=src.dtype)
    return out.index_add_(0, seg, src)

def _pad(x, pw):
    flat = tuple((v for pair in reversed(pw) for v in pair))
    return torch.nn.functional.pad(x, flat)
kernel_name = 'parallel_sum__spectral_fnet__mixer_gmlp__prompt'

def setup_inputs():

    _w = lambda a: (lambda t: t.to(torch.bfloat16) if t.is_floating_point() else t)(torch.as_tensor(a))

    def _A_setup():
        B, S, D = (1, 2048, 512)
        ns = torch.arange(S)[:, None] * torch.arange(S)[None, :]
        nd = torch.arange(D)[:, None] * torch.arange(D)[None, :]
        Ws_re = torch.cos(-2.0 * torch.pi * ns / S).to(float)
        Ws_im = torch.sin(-2.0 * torch.pi * ns / S).to(float)
        Wd_re = torch.cos(-2.0 * torch.pi * nd / D).to(float)
        Wd_im = torch.sin(-2.0 * torch.pi * nd / D).to(float)
        return {'x': _w((lambda *s: torch.randn(*s, dtype=torch.bfloat16) * 0.05)(B, S, D)), 'dft_seq_re': _w(Ws_re), 'dft_seq_im': _w(Ws_im), 'dft_hid_re': _w(Wd_re), 'dft_hid_im': _w(Wd_im)}
    _A_in = _A_setup()

    def _B_setup():
        B, S, D, F = (1, 2048, 512, 1376)
        Fh = F // 2
        return {'x': _w((lambda *s: torch.randn(*s, dtype=torch.bfloat16) * 0.05)(B, S, D)), 'w_in': _w((lambda *s: torch.randn(*s, dtype=torch.bfloat16) * 1.6)(D, 2 * Fh)), 'w_sp': _w(0.01 * (lambda *s: torch.randn(*s, dtype=torch.bfloat16) * 1.6)(S, S)), 'b_sp': _w(1.0 + 0.01 * (lambda *s: torch.randn(*s, dtype=torch.bfloat16) * 0.8)(S)), 'w_out': _w((lambda *s: torch.randn(*s, dtype=torch.bfloat16) * 0.8)(Fh, D))}
    _B_in = _B_setup()
    return {'A_x': _A_in['x'], 'A_dft_seq_re': _A_in['dft_seq_re'], 'A_dft_seq_im': _A_in['dft_seq_im'], 'A_dft_hid_re': _A_in['dft_hid_re'], 'A_dft_hid_im': _A_in['dft_hid_im'], 'B_x': _B_in['x'], 'B_w_in': _B_in['w_in'], 'B_w_sp': _B_in['w_sp'], 'B_b_sp': _B_in['b_sp'], 'B_w_out': _B_in['w_out']}

def reference(A_x, A_dft_seq_re, A_dft_seq_im, A_dft_hid_re, A_dft_hid_im, B_x, B_w_in, B_w_sp, B_b_sp, B_w_out):

    def _A_ref(x, dft_seq_re, dft_seq_im, dft_hid_re, dft_hid_im):
        a = torch.einsum('bsd,ed->bse', x, dft_hid_re)
        b = torch.einsum('bsd,ed->bse', x, dft_hid_im)
        y = torch.einsum('ts,bse->bte', dft_seq_re, a) - torch.einsum('ts,bse->bte', dft_seq_im, b)
        return y

    def _B_ref(x, w_in, w_sp, b_sp, w_out):
        B, S, D = x.shape
        F = w_in.shape[-1]
        Fh = F // 2
        z = _gelu(torch.einsum('bsd,df->bsf', x, w_in))
        z1 = z[..., :Fh].clone()
        z2 = _layernorm(z[..., Fh:], axis=-1)
        g = torch.einsum('ts,bsf->btf', w_sp, z2) + b_sp[None, :, None]
        return torch.einsum('bsf,fd->bsd', z1 * g, w_out)
    x = A_x
    xn = _layernorm(x, axis=-1)
    return x + _A_ref(xn, A_dft_seq_re, A_dft_seq_im, A_dft_hid_re, A_dft_hid_im) + _B_ref(xn, B_w_in, B_w_sp, B_b_sp, B_w_out)
```

```asm
; @launch grid=(256,1,1) block=(256,1,1) lds=163840
.amdgcn_target "amdgcn-amd-amdhsa--gfx950"
.text
.globl parallel_sum__spectral_fnet__mixer_gmlp__prompt_kernel
.p2align 8
.type parallel_sum__spectral_fnet__mixer_gmlp__prompt_kernel,@function
parallel_sum__spectral_fnet__mixer_gmlp__prompt_kernel:
    s_cmp_ge_u32 s2, 256
    s_cbranch_scc1 L_end
    s_load_dwordx2 s[8:9], s[0:1], 0
    s_load_dwordx2 s[12:13], s[0:1], 48
    s_load_dwordx2 s[24:25], s[0:1], 96
    s_load_dwordx2 s[16:17], s[0:1], 56
    s_load_dwordx2 s[20:21], s[0:1], 72
    s_load_dwordx2 s[32:33], s[0:1], 88
    s_load_dwordx2 s[36:37], s[0:1], 64
    s_load_dwordx2 s[28:29], s[0:1], 80
    s_getpc_b64 s[4:5]
    s_lshl_b32 s6, s2, 9
    s_and_b32 s6, s6, 0xf000
    v_lshl_add_u32 v27, v0, 4, s6
    v_min_u32 v27, L_codeend-parallel_sum__spectral_fnet__mixer_gmlp__prompt_kernel-1024, v27
    global_load_dwordx4 v[124:127], v27, s[4:5]
    v_lshrrev_b32 v25, 6, v0
    s_lshr_b32 s3, s2, 3
    v_readfirstlane_b32 s42, v25
    s_and_b32 s40, s2, 3
    s_lshl_b32 s40, s40, 3
    s_and_b32 s6, s3, 7
    s_add_u32 s40, s40, s6
    s_lshr_b32 s7, s3, 3
    s_xor_b32 s7, s7, 3
    s_and_b32 s41, s2, 4
    s_add_u32 s41, s41, s7
    s_mul_i32 s7, s7, 2
    s_add_u32 s47, s7, s6
    s_lshr_b32 s43, s42, 1
    s_and_b32 s44, s42, 1
    s_mov_b32 s10, 2097152
    s_mov_b32 s11, 0x00020000
    v_bfe_u32 v24, v0, 3, 3
    v_and_b32 v25, 7, v0
    s_lshl_b32 s5, s40, 1
    s_add_u32 s5, s5, s43
    s_lshl_b32 s5, s5, 1
    s_and_b32 s6, s41, 1
    s_add_u32 s5, s5, s6
    s_lshl_b32 s5, s5, 2
    s_add_u32 s5, s5, s44
    s_lshl_b32 s5, s5, 12
    v_and_b32 v26, 4, v24
    v_add_u32_e64 v26, v26, v24
    v_lshl_add_u32 v27, v26, 10, s5
    v_lshl_add_u32 v2, v25, 4, v27
    v_xor_b32 v3, 0x4000, v2
    s_lshl_b32 s7, s47, 7
    s_movk_i32 s6, 0x380
    s_and_b32 s64, s7, s6
    s_addk_i32 s7, 128
    s_and_b32 s65, s7, s6
    s_addk_i32 s7, 128
    s_and_b32 s66, s7, s6
    s_addk_i32 s7, 128
    s_and_b32 s67, s7, s6
    s_addk_i32 s7, 128
    s_and_b32 s68, s7, s6
    s_addk_i32 s7, 128
    s_and_b32 s69, s7, s6
    s_addk_i32 s7, 128
    s_and_b32 s70, s7, s6
    s_addk_i32 s7, 128
    s_and_b32 s71, s7, s6
    s_waitcnt lgkmcnt(0)
    buffer_load_dwordx4 v[192:195], v2, s[8:11], s64 offen
    buffer_load_dwordx4 v[196:199], v2, s[8:11], s65 offen
    buffer_load_dwordx4 v[200:203], v2, s[8:11], s66 offen
    buffer_load_dwordx4 v[204:207], v2, s[8:11], s67 offen
    buffer_load_dwordx4 v[208:211], v2, s[8:11], s68 offen
    buffer_load_dwordx4 v[212:215], v2, s[8:11], s69 offen
    buffer_load_dwordx4 v[216:219], v2, s[8:11], s70 offen
    buffer_load_dwordx4 v[220:223], v2, s[8:11], s71 offen
    buffer_load_dwordx4 v[224:227], v3, s[8:11], s64 offen
    buffer_load_dwordx4 v[228:231], v3, s[8:11], s65 offen
    s_or_b32 s5, s2, s42
    s_cselect_b32 s91, 1073741824, 0
    s_mov_b32 s26, 0x10000000
    s_mov_b32 s27, 0x00020000
    v_mul_u32_u24 v28, 260, v0
    v_and_b32 v28, 0x3e04, v28
    v_or_b32 v28, 9240576, v28
    v_mov_b32_e64 v29, 0
    buffer_store_dword v29, v28, s[24:27], s91 offen sc1
    v_and_b32 v0, 63, v0
    v_lshlrev_b32 v1, 4, v0
    s_mul_i32 s45, s41, 3
    s_min_u32 s45, s45, 20
    s_cmp_ge_u32 s41, 6
    s_cselect_b32 s46, 2, 3
    s_mul_i32 s56, s64, 1376
    s_mul_i32 s57, s65, 1376
    s_mul_i32 s58, s66, 1376
    s_mul_i32 s59, s67, 1376
    s_mul_i32 s60, s68, 1376
    s_mul_i32 s61, s69, 1376
    s_mul_i32 s62, s70, 1376
    s_mul_i32 s63, s71, 1376
    s_mul_i32 s3, s42, 44032
    s_lshl_b32 s7, s45, 6
    s_add_u32 s3, s3, s7
    s_add_u32 s3, s3, 1376
    s_movk_i32 s7, 2752
    v_add_u32 v32, 0, v0
    v_mul_u32_u24 v33, 171, v32
    v_lshrrev_b32 v33, 11, v33
    v_mul_u32_u24 v34, 12, v33
    v_sub_u32 v32, v32, v34
    v_lshrrev_b32 v34, 2, v33
    v_and_b32 v34, 2, v34
    v_xor_b32 v32, v32, v34
    v_lshl_add_u32 v32, v32, 4, s3
    v_mad_u32_u24 v8, v33, s7, v32
    s_sub_u32 s3, s3, 1024
    v_add_u32 v32, 64, v0
    v_mul_u32_u24 v33, 171, v32
    v_lshrrev_b32 v33, 11, v33
    v_mul_u32_u24 v34, 12, v33
    v_sub_u32 v32, v32, v34
    v_lshrrev_b32 v34, 2, v33
    v_and_b32 v34, 2, v34
    v_xor_b32_e64 v32, v32, v34
    v_lshl_add_u32 v32, v32, 4, s3
    v_mad_u32_u24 v9, v33, s7, v32
    s_sub_u32 s3, s3, 1024
    v_add_u32 v32, 128, v0
    v_mul_u32_u24 v33, 171, v32
    v_lshrrev_b32 v33, 11, v33
    v_mul_u32_u24 v34, 12, v33
    v_sub_u32 v32, v32, v34
    v_lshrrev_b32 v34, 2, v33
    v_and_b32 v34, 2, v34
    v_xor_b32 v32, v32, v34
    v_lshl_add_u32 v32, v32, 4, s3
    v_mad_u32_u24 v10, v33, s7, v32
    s_mul_i32 s88, s42, 3072
    s_add_u32 s88, s88, 65536
    s_mov_b32 s14, 1409024
    s_mov_b32 s15, 0x00020000
    s_mov_b32 s18, 8388608
    s_mov_b32 s19, 0x00020000
    s_mov_b32 s22, 704512
    s_mov_b32 s23, 0x00020000
    s_mov_b32 s30, 2097152
    s_mov_b32 s31, 0x00020000
    s_mov_b32 s34, 256
    s_mov_b32 s35, 0x00020000
    s_mov_b32 s38, 4096
    s_mov_b32 s39, 0x00020000
    v_and_b32 v27, 15, v0
    v_lshrrev_b32 v32, 4, v0
    v_lshrrev_b32 v33, 1, v32
    v_and_b32 v34, 1, v32
    s_lshl_b32 s3, s43, 11
    s_lshl_b32 s7, s44, 8
    s_add_u32 s7, s7, s3
    v_lshl_add_u32 v35, v27, 4, s7
    v_lshl_add_u32 v35, v33, 10, v35
    v_lshl_add_u32 v21, v34, 9, v35
    s_lshl_b32 s7, s44, 9
    s_add_u32 s7, s7, s3
    v_lshl_add_u32 v35, v27, 4, s7
    v_lshl_add_u32 v35, v34, 10, v35
    v_lshl_add_u32 v22, v33, 8, v35
    v_lshlrev_b32 v35, 4, v27
    v_lshl_add_u32 v23, v32, 2, v35
    s_lshl_b32 s3, s40, 12
    s_mul_i32 s7, s40, 90112
    s_lshl_b32 s97, s45, 17
    s_add_u32 s77, s97, s3
    s_add_u32 s78, s77, 131072
    s_add_u32 s79, s77, 262144
    s_lshl_b32 s97, s45, 12
    s_add_u32 s97, s97, s7
    s_add_u32 s80, s97, 2883584
    s_add_u32 s81, s97, 2887680
    s_add_u32 s82, s97, 2891776
    s_cmp_eq_u32 s46, 2
    s_cselect_b32 s79, 1073741824, s79
    s_cselect_b32 s82, 1073741824, s82
    s_cselect_b32 s87, 0, 1.0
    s_lshl_b32 s96, s41, 1
    s_add_u32 s96, s96, s44
    s_cmp_eq_u32 s96, 15
    s_cselect_b32 s86, 0, 1.0
    s_lshl_b32 s97, s96, 17
    s_add_u32 s97, s97, s3
    s_lshl_b32 s98, s43, 11
    s_add_u32 s97, s97, s98
    s_add_u32 s83, s97, 5767168
    s_lshl_b32 s97, s40, 1
    s_add_u32 s97, s97, s43
    s_lshl_b32 s97, s97, 12
    s_add_u32 s85, s97, 8916992
    s_lshl_b32 s97, s96, 8
    s_add_u32 s84, s85, s97
    s_lshl_b32 s4, s40, 3
    s_add_u32 s4, s4, s41
    s_lshl_b32 s3, s4, 2
    s_add_u32 s3, s3, s42
    s_lshl_b32 s3, s3, 10
    s_add_u32 s99, s3, 7864320
    s_lshl_b32 s4, s40, 9
    s_add_u32 s4, s4, s41
    s_cmp_eq_u32 s42, 0
    s_cselect_b32 s4, s4, 1073741824
    v_mov_b32 v64, -1
    v_mov_b32 v65, -1
    v_mov_b32 v66, -1
    v_mov_b32 v67, -1
    v_xor_b32 v33, v24, v25
    v_and_b32 v34, 3, v25
    v_lshl_add_u32 v33, v34, 4, v33
    v_lshrrev_b32 v34, 2, v25
    v_lshlrev_b32 v34, 12, v34
    v_lshl_add_u32 v33, v33, 4, v34
    s_and_b32 s3, s41, 1
    s_lshl_b32 s3, s3, 7
    s_lshl_b32 s7, s42, 10
    s_add_u32 s3, s3, s7
    v_add_u32 v4, s3, v33
    v_xor_b32 v5, 0x80, v4
    s_add_u32 s90, s7, 73728
    s_lshl_b32 s5, s7, 2
    s_add_u32 s89, s5, 0
    v_xor_b32 v33, v27, v32
    v_lshl_add_u32 v33, v32, 4, v33
    s_lshl_b32 s3, s43, 11
    v_lshl_add_u32 v6, v33, 4, s3
    v_xor_b32 v7, 64, v6
    v_bfe_u32 v33, v0, 2, 2
    v_lshl_add_u32 v33, v32, 3, v33
    v_mul_u32_u24 v33, 192, v33
    v_and_b32 v34, 1, v32
    v_xor_b32 v34, s44, v34
    v_lshl_add_u32 v33, v34, 5, v33
    v_and_b32 v34, 3, v0
    v_lshl_add_u32 v33, v34, 3, v33
    v_add_u32 v11, 65536, v33
    v_add_u32 v12, 114688, v33
    s_lshl_b32 s3, s40, 18
    s_add_u32 s3, s3, s7
    v_lshrrev_b32 v33, 1, v24
    v_xor_b32 v33, v33, v25
    v_lshl_add_u32 v33, v33, 4, s3
    v_lshl_add_u32 v13, v26, 12, v33
    v_xor_b32 v33, 64, v13
    v_add_u32 v14, 64512, v33
    v_add_u32 v15, 14336, v13
    v_add_u32 v16, 78848, v33
    v_and_b32 v33, 31, v0
    v_bfe_u32 v34, v0, 1, 3
    v_lshrrev_b32 v35, 5, v0
    v_xor_b32 v34, v34, v35
    v_lshlrev_b32 v34, 4, v34
    v_lshl_add_u32 v33, v33, 7, v34
    v_add_u32 v17, s89, v33
    v_xor_b32 v18, 32, v17
    v_xor_b32 v19, 64, v17
    v_xor_b32 v20, 0x60, v17
    s_mov_b32 s72, 0xbdd2d3e8
    s_mov_b32 s73, 0xc0135761
    s_mov_b32 s74, 0x3f803f80
    s_mov_b32 s75, 0x00003f80
    s_mov_b32 s76, 0x3f800000
    s_mov_b32 s92, 0xaaaaaaaa
    s_mov_b32 s93, 0xaaaaaaaa
    s_mov_b32 s94, 0xcccccccc
    s_mov_b32 s95, 0xcccccccc
    s_add_u32 s97, s45, s46
    s_sub_u32 s97, s97, 1
    s_lshl_b32 s97, s97, 17
    s_lshl_b32 s3, s42, 15
    s_add_u32 s97, s97, s3
    s_lshl_b32 s6, s45, 17
    s_add_u32 s6, s6, s3
    s_lshl_b32 s98, s41, 7
    s_lshl_b32 s48, s64, 5
    s_add_u32 s48, s48, s6
    s_lshl_b32 s49, s65, 5
    s_add_u32 s49, s49, s6
    s_lshl_b32 s50, s66, 5
    s_add_u32 s50, s50, s6
    s_lshl_b32 s51, s67, 5
    s_add_u32 s51, s51, s6
    s_lshl_b32 s52, s68, 5
    s_add_u32 s52, s52, s6
    s_lshl_b32 s53, s69, 5
    s_add_u32 s53, s53, s6
    s_lshl_b32 s54, s70, 5
    s_add_u32 s54, s54, s6
    s_lshl_b32 s55, s71, 5
    s_add_u32 s55, s55, s6
    s_and_b32 s3, s41, 1
    s_lshl_b32 s3, s3, 5
    s_lshl_b32 s7, s42, 6
    s_add_u32 s3, s3, s7
    v_lshl_add_u32 v30, v24, 2, s3
    v_xor_b32 v26, 32, v30
    buffer_load_dwordx4 v[232:235], v3, s[8:11], s66 offen
    buffer_load_dwordx4 v[236:239], v3, s[8:11], s67 offen
    buffer_load_dwordx4 v[240:243], v3, s[8:11], s68 offen
    buffer_load_dwordx4 v[244:247], v3, s[8:11], s69 offen
    buffer_load_dwordx4 v[248:251], v3, s[8:11], s70 offen
    buffer_load_dwordx4 v[252:255], v3, s[8:11], s71 offen
    s_lshl_b32 s3, s43, 7
    v_lshl_add_u32 v2, v32, 4, s3
    v_lshl_add_u32 v3, v27, 2, s3
    v_mov_b32 v35, 0
    v_mov_b32 v36, 0
    s_waitcnt vmcnt(15)
    v_dot2c_f32_bf16 v35, s74, v192
    v_dot2c_f32_bf16 v35, s74, v193
    s_mov_b32 m0, s88
    s_nop 0
    buffer_load_dwordx4 v8, s[12:15], s56 offen offset:0 lds
    v_dot2c_f32_bf16 v35, s74, v194
    v_dot2c_f32_bf16 v35, s74, v195
    v_dot2c_f32_bf16 v35, s74, v196
    v_dot2c_f32_bf16 v35, s74, v197
    v_dot2c_f32_bf16 v35, s74, v198
    v_dot2c_f32_bf16 v35, s74, v199
    s_waitcnt vmcnt(14)
    v_dot2c_f32_bf16 v35, s74, v200
    v_dot2c_f32_bf16 v35, s74, v201
    v_dot2c_f32_bf16 v35, s74, v202
    v_dot2c_f32_bf16 v35, s74, v203
    v_dot2c_f32_bf16 v35, s74, v204
    v_dot2c_f32_bf16 v35, s74, v205
    v_dot2c_f32_bf16 v35, s74, v206
    v_dot2c_f32_bf16 v35, s74, v207
    s_waitcnt vmcnt(12)
    v_dot2c_f32_bf16 v35, s74, v208
    buffer_load_dwordx4 v9, s[12:15], s56 offen offset:1024 lds
    v_dot2c_f32_bf16 v35, s74, v209
    v_dot2c_f32_bf16 v35, s74, v210
    v_dot2c_f32_bf16 v35, s74, v211
    v_dot2c_f32_bf16 v35, s74, v212
    v_dot2c_f32_bf16 v35, s74, v213
    v_dot2c_f32_bf16 v35, s74, v214
    v_dot2c_f32_bf16 v35, s74, v215
    s_waitcnt vmcnt(11)
    v_dot2c_f32_bf16 v35, s74, v216
    v_dot2c_f32_bf16 v35, s74, v217
    v_dot2c_f32_bf16 v35, s74, v218
    v_dot2c_f32_bf16 v35, s74, v219
    v_dot2c_f32_bf16 v35, s74, v220
    v_dot2c_f32_bf16 v35, s74, v221
    v_dot2c_f32_bf16 v35, s74, v222
    v_dot2c_f32_bf16 v35, s74, v223
    buffer_load_dwordx4 v10, s[12:15], s56 offen offset:2048 lds
    s_nop 1
    v_add_f32_dpp v35, v35, v35 quad_perm:[1,0,3,2] row_mask:0xf bank_mask:0xf
    s_nop 1
    v_add_f32_dpp v35, v35, v35 quad_perm:[2,3,0,1] row_mask:0xf bank_mask:0xf
    s_nop 1
    v_add_f32_dpp v35, v35, v35 row_half_mirror row_mask:0xf bank_mask:0xf
    v_mul_f32 v35, 0xbb000000, v35
    s_waitcnt vmcnt(9)
    v_mov_b32 v29, 1
    buffer_store_dword v29, off, s[32:35], s91 sc1
    s_mov_b32 s91, 0
    v_dot2_f32_bf16 v40, v192, s75, v35
    v_dot2_f32_bf16 v41, v192, s76, v35
    s_add_u32 m0, s88, 12288
    s_nop 0
    buffer_load_dwordx4 v8, s[12:15], s57 offen offset:0 lds
    v_dot2_f32_bf16 v42, v193, s75, v35
    v_dot2_f32_bf16 v43, v193, s76, v35
    v_dot2_f32_bf16 v44, v194, s75, v35
    v_dot2_f32_bf16 v45, v194, s76, v35
    v_dot2_f32_bf16 v46, v195, s75, v35
    v_dot2_f32_bf16 v47, v195, s76, v35
    v_dot2_f32_bf16 v48, v196, s75, v35
    v_dot2_f32_bf16 v49, v196, s76, v35
    v_dot2_f32_bf16 v50, v197, s75, v35
    v_dot2_f32_bf16 v51, v197, s76, v35
    v_dot2_f32_bf16 v52, v198, s75, v35
    v_dot2_f32_bf16 v53, v198, s76, v35
    v_dot2_f32_bf16 v54, v199, s75, v35
    v_dot2_f32_bf16 v55, v199, s76, v35
    v_cvt_pk_bf16_f32 v192, v40, v41
    v_cvt_pk_bf16_f32 v193, v42, v43
    buffer_load_dwordx4 v9, s[12:15], s57 offen offset:1024 lds
    v_cvt_pk_bf16_f32 v194, v44, v45
    v_cvt_pk_bf16_f32 v195, v46, v47
    ds_write_b128 v4, v[192:195] offset:0
    v_dot2_f32_bf16 v40, v200, s75, v35
    v_dot2_f32_bf16 v41, v200, s76, v35
    v_dot2_f32_bf16 v42, v201, s75, v35
    v_dot2_f32_bf16 v43, v201, s76, v35
    v_dot2_f32_bf16 v44, v202, s75, v35
    v_dot2_f32_bf16 v45, v202, s76, v35
    v_dot2_f32_bf16 v46, v203, s75, v35
    v_dot2_f32_bf16 v47, v203, s76, v35
    v_cvt_pk_bf16_f32 v196, v48, v49
    v_cvt_pk_bf16_f32 v197, v50, v51
    v_cvt_pk_bf16_f32 v198, v52, v53
    v_cvt_pk_bf16_f32 v199, v54, v55
    ds_write_b128 v4, v[196:199] offset:8192
    buffer_load_dwordx4 v10, s[12:15], s57 offen offset:2048 lds
    v_dot2_f32_bf16 v48, v204, s75, v35
    v_dot2_f32_bf16 v49, v204, s76, v35
    v_dot2_f32_bf16 v50, v205, s75, v35
    v_dot2_f32_bf16 v51, v205, s76, v35
    v_dot2_f32_bf16 v52, v206, s75, v35
    v_dot2_f32_bf16 v53, v206, s76, v35
    v_dot2_f32_bf16 v54, v207, s75, v35
    v_dot2_f32_bf16 v55, v207, s76, v35
    v_cvt_pk_bf16_f32 v200, v40, v41
    v_cvt_pk_bf16_f32 v201, v42, v43
    v_cvt_pk_bf16_f32 v202, v44, v45
    v_cvt_pk_bf16_f32 v203, v46, v47
    ds_write_b128 v4, v[200:203] offset:16384
    v_dot2_f32_bf16 v40, v208, s75, v35
    v_dot2_f32_bf16 v41, v208, s76, v35
    v_dot2_f32_bf16 v42, v209, s75, v35
    s_add_u32 m0, s88, 24576
    v_nop_e64
    buffer_load_dwordx4 v8, s[12:15], s58 offen offset:0 lds
    v_dot2_f32_bf16 v43, v209, s76, v35
    v_dot2_f32_bf16 v44, v210, s75, v35
    v_dot2_f32_bf16 v45, v210, s76, v35
    v_dot2_f32_bf16 v46, v211, s75, v35
    v_dot2_f32_bf16 v47, v211, s76, v35
    v_cvt_pk_bf16_f32 v204, v48, v49
    v_cvt_pk_bf16_f32 v205, v50, v51
    v_cvt_pk_bf16_f32 v206, v52, v53
    v_cvt_pk_bf16_f32 v207, v54, v55
    ds_write_b128 v4, v[204:207] offset:24576
    v_dot2_f32_bf16 v48, v212, s75, v35
    v_dot2_f32_bf16 v49, v212, s76, v35
    v_dot2_f32_bf16 v50, v213, s75, v35
    v_dot2_f32_bf16 v51, v213, s76, v35
    v_dot2_f32_bf16 v52, v214, s75, v35
    v_dot2_f32_bf16 v53, v214, s76, v35
    buffer_load_dwordx4 v9, s[12:15], s58 offen offset:1024 lds
    v_dot2_f32_bf16 v54, v215, s75, v35
    v_dot2_f32_bf16 v55, v215, s76, v35
    v_cvt_pk_bf16_f32 v208, v40, v41
    v_cvt_pk_bf16_f32 v209, v42, v43
    v_cvt_pk_bf16_f32 v210, v44, v45
    v_cvt_pk_bf16_f32 v211, v46, v47
    ds_write_b128 v4, v[208:211] offset:32768
    v_dot2_f32_bf16 v40, v216, s75, v35
    v_dot2_f32_bf16 v41, v216, s76, v35
    v_dot2_f32_bf16 v42, v217, s75, v35
    v_dot2_f32_bf16 v43, v217, s76, v35
    v_dot2_f32_bf16 v44, v218, s75, v35
    v_dot2_f32_bf16 v45, v218, s76, v35
    v_dot2_f32_bf16 v46, v219, s75, v35
    v_dot2_f32_bf16 v47, v219, s76, v35
    v_cvt_pk_bf16_f32 v212, v48, v49
    buffer_load_dwordx4 v10, s[12:15], s58 offen offset:2048 lds
    v_cvt_pk_bf16_f32 v213, v50, v51
    v_cvt_pk_bf16_f32 v214, v52, v53
    v_cvt_pk_bf16_f32 v215, v54, v55
    ds_write_b128 v4, v[212:215] offset:40960
    v_dot2_f32_bf16 v48, v220, s75, v35
    v_dot2_f32_bf16 v49, v220, s76, v35
    v_dot2_f32_bf16 v50, v221, s75, v35
    v_dot2_f32_bf16 v51, v221, s76, v35
    v_dot2_f32_bf16 v52, v222, s75, v35
    v_dot2_f32_bf16 v53, v222, s76, v35
    v_dot2_f32_bf16 v54, v223, s75, v35
    v_dot2_f32_bf16 v55, v223, s76, v35
    v_cvt_pk_bf16_f32 v216, v40, v41
    v_cvt_pk_bf16_f32 v217, v42, v43
    v_cvt_pk_bf16_f32 v218, v44, v45
    v_cvt_pk_bf16_f32 v219, v46, v47
    s_add_u32 m0, s88, 36864
    v_nop_e64
    buffer_load_dwordx4 v8, s[12:15], s59 offen offset:0 lds
    ds_write_b128 v4, v[216:219] offset:49152
    v_cvt_pk_bf16_f32 v220, v48, v49
    v_cvt_pk_bf16_f32 v221, v50, v51
    v_cvt_pk_bf16_f32 v222, v52, v53
    v_cvt_pk_bf16_f32 v223, v54, v55
    ds_write_b128 v4, v[220:223] offset:57344
    v_dot2c_f32_bf16 v36, v192, v192
    v_dot2c_f32_bf16 v36, v193, v193
    v_dot2c_f32_bf16 v36, v194, v194
    v_dot2c_f32_bf16 v36, v195, v195
    v_dot2c_f32_bf16 v36, v196, v196
    v_dot2c_f32_bf16 v36, v197, v197
    v_dot2c_f32_bf16 v36, v198, v198
    v_dot2c_f32_bf16 v36, v199, v199
    v_dot2c_f32_bf16 v36, v200, v200
    v_dot2c_f32_bf16 v36, v201, v201
    buffer_load_dwordx4 v9, s[12:15], s59 offen offset:1024 lds
    v_dot2c_f32_bf16 v36, v202, v202
    v_dot2c_f32_bf16 v36, v203, v203
    v_dot2c_f32_bf16 v36, v204, v204
    v_dot2c_f32_bf16 v36, v205, v205
    v_dot2c_f32_bf16 v36, v206, v206
    v_dot2c_f32_bf16 v36, v207, v207
    v_dot2c_f32_bf16 v36, v208, v208
    v_dot2c_f32_bf16 v36, v209, v209
    v_dot2c_f32_bf16 v36, v210, v210
    v_dot2c_f32_bf16 v36, v211, v211
    v_dot2c_f32_bf16 v36, v212, v212
    v_dot2c_f32_bf16 v36, v213, v213
    v_dot2c_f32_bf16 v36, v214, v214
    v_dot2c_f32_bf16 v36, v215, v215
    v_dot2c_f32_bf16 v36, v216, v216
    v_dot2c_f32_bf16 v36, v217, v217
    buffer_load_dwordx4 v10, s[12:15], s59 offen offset:2048 lds
    v_dot2c_f32_bf16 v36, v218, v218
    v_dot2c_f32_bf16 v36, v219, v219
    v_dot2c_f32_bf16 v36, v220, v220
    v_dot2c_f32_bf16 v36, v221, v221
    v_dot2c_f32_bf16 v36, v222, v222
    v_dot2c_f32_bf16 v36, v223, v223
    s_nop 2
    v_add_f32_dpp v36, v36, v36 quad_perm:[1,0,3,2] row_mask:0xf bank_mask:0xf
    s_nop 1
    v_add_f32_dpp v36, v36, v36 quad_perm:[2,3,0,1] row_mask:0xf bank_mask:0xf
    s_nop 1
    v_add_f32_dpp v36, v36, v36 row_half_mirror row_mask:0xf bank_mask:0xf
    s_add_u32 m0, s88, 49152
    s_nop 0
    buffer_load_dwordx4 v8, s[12:15], s60 offen offset:0 lds
    v_mov_b32 v37, 0x3727c5ac
    v_fmac_f32 v37, 0x3b000000, v36
    v_rsq_f32 v28, v37
    v_mov_b32 v35, 0
    v_mov_b32 v36, 0
    v_dot2c_f32_bf16 v35, s74, v224
    v_dot2c_f32_bf16 v35, s74, v225
    v_dot2c_f32_bf16 v35, s74, v226
    v_dot2c_f32_bf16 v35, s74, v227
    v_dot2c_f32_bf16 v35, s74, v228
    v_dot2c_f32_bf16 v35, s74, v229
    v_dot2c_f32_bf16 v35, s74, v230
    v_dot2c_f32_bf16 v35, s74, v231
    s_waitcnt vmcnt(18)
    v_dot2c_f32_bf16 v35, s74, v232
    buffer_load_dwordx4 v9, s[12:15], s60 offen offset:1024 lds
    v_dot2c_f32_bf16 v35, s74, v233
    v_dot2c_f32_bf16 v35, s74, v234
    v_dot2c_f32_bf16 v35, s74, v235
    v_dot2c_f32_bf16 v35, s74, v236
    v_dot2c_f32_bf16 v35, s74, v237
    v_dot2c_f32_bf16 v35, s74, v238
    v_dot2c_f32_bf16 v35, s74, v239
    s_waitcnt vmcnt(17)
    v_dot2c_f32_bf16 v35, s74, v240
    v_dot2c_f32_bf16 v35, s74, v241
    v_dot2c_f32_bf16 v35, s74, v242
    v_dot2c_f32_bf16 v35, s74, v243
    v_dot2c_f32_bf16 v35, s74, v244
    v_dot2c_f32_bf16 v35, s74, v245
    v_dot2c_f32_bf16 v35, s74, v246
    v_dot2c_f32_bf16 v35, s74, v247
    buffer_load_dwordx4 v10, s[12:15], s60 offen offset:2048 lds
    s_waitcnt vmcnt(16)
    v_dot2c_f32_bf16 v35, s74, v248
    v_dot2c_f32_bf16 v35, s74, v249
    v_dot2c_f32_bf16 v35, s74, v250
    v_dot2c_f32_bf16_e64 v35, s74, v251
    v_dot2c_f32_bf16 v35, s74, v252
    v_dot2c_f32_bf16 v35, s74, v253
    v_dot2c_f32_bf16 v35, s74, v254
    v_dot2c_f32_bf16 v35, s74, v255
    s_nop 2
    v_add_f32_dpp v35, v35, v35 quad_perm:[1,0,3,2] row_mask:0xf bank_mask:0xf
    s_nop 1
    v_add_f32_dpp v35, v35, v35 quad_perm:[2,3,0,1] row_mask:0xf bank_mask:0xf
    buffer_store_dword v64, v23, s[24:27], s84 offen sc1
    s_nop 0
    v_add_f32_dpp v35, v35, v35 row_half_mirror row_mask:0xf bank_mask:0xf
    v_mul_f32 v35, 0xbb000000, v35
    v_dot2_f32_bf16 v40, v224, s75, v35
    v_dot2_f32_bf16 v41, v224, s76, v35
    v_dot2_f32_bf16 v42, v225, s75, v35
    v_dot2_f32_bf16 v43, v225, s76, v35
    v_dot2_f32_bf16 v44, v226, s75, v35
    v_dot2_f32_bf16 v45, v226, s76, v35
    v_dot2_f32_bf16 v46, v227, s75, v35
    v_dot2_f32_bf16 v47, v227, s76, v35
    v_dot2_f32_bf16 v48, v228, s75, v35
    v_dot2_f32_bf16 v49, v228, s76, v35
    v_dot2_f32_bf16 v50, v229, s75, v35
    v_dot2_f32_bf16 v51, v229, s76, v35
    v_dot2_f32_bf16 v52, v230, s75, v35
    buffer_store_dwordx4 v[64:67], v21, s[24:27], s77 offen sc1
    v_dot2_f32_bf16 v53, v230, s76, v35
    v_dot2_f32_bf16 v54, v231, s75, v35
    v_dot2_f32_bf16 v55, v231, s76, v35
    v_cvt_pk_bf16_f32 v224, v40, v41
    v_cvt_pk_bf16_f32 v225, v42, v43
    v_cvt_pk_bf16_f32 v226, v44, v45
    v_cvt_pk_bf16_f32 v227, v46, v47
    ds_write_b128 v5, v[224:227] offset:0
    v_dot2_f32_bf16 v40, v232, s75, v35
    v_dot2_f32_bf16 v41, v232, s76, v35
    v_dot2_f32_bf16 v42, v233, s75, v35
    v_dot2_f32_bf16 v43, v233, s76, v35
    v_dot2_f32_bf16 v44, v234, s75, v35
    v_dot2_f32_bf16 v45, v234, s76, v35
    v_dot2_f32_bf16 v46, v235, s75, v35
    v_dot2_f32_bf16 v47, v235, s76, v35
    buffer_store_dwordx4 v[64:67], v21, s[24:27], s78 offen sc1
    v_cvt_pk_bf16_f32 v228, v48, v49
    v_cvt_pk_bf16_f32 v229, v50, v51
    v_cvt_pk_bf16_f32 v230, v52, v53
    v_cvt_pk_bf16_f32 v231, v54, v55
    ds_write_b128 v5, v[228:231] offset:8192
    v_dot2_f32_bf16 v48, v236, s75, v35
    v_dot2_f32_bf16 v49, v236, s76, v35
    v_dot2_f32_bf16 v50, v237, s75, v35
    v_dot2_f32_bf16 v51, v237, s76, v35
    v_dot2_f32_bf16 v52, v238, s75, v35
    v_dot2_f32_bf16 v53, v238, s76, v35
    v_dot2_f32_bf16 v54, v239, s75, v35
    v_dot2_f32_bf16 v55, v239, s76, v35
    v_cvt_pk_bf16_f32 v232, v40, v41
    v_cvt_pk_bf16_f32 v233, v42, v43
    v_cvt_pk_bf16_f32 v234, v44, v45
    buffer_store_dwordx4 v[64:67], v21, s[24:27], s79 offen sc1
    v_cvt_pk_bf16_f32 v235, v46, v47
    ds_write_b128 v5, v[232:235] offset:16384
    v_dot2_f32_bf16 v40, v240, s75, v35
    v_dot2_f32_bf16 v41, v240, s76, v35
    v_dot2_f32_bf16 v42, v241, s75, v35
    v_dot2_f32_bf16 v43, v241, s76, v35
    v_dot2_f32_bf16 v44, v242, s75, v35
    v_dot2_f32_bf16 v45, v242, s76, v35
    v_dot2_f32_bf16 v46, v243, s75, v35
    v_dot2_f32_bf16 v47, v243, s76, v35
    v_cvt_pk_bf16_f32 v236, v48, v49
    v_cvt_pk_bf16_f32 v237, v50, v51
    v_cvt_pk_bf16_f32 v238, v52, v53
    v_cvt_pk_bf16_f32 v239, v54, v55
    ds_write_b128 v5, v[236:239] offset:24576
    v_dot2_f32_bf16 v48, v244, s75, v35
    buffer_store_dwordx4 v[64:67], v22, s[24:27], s80 offen sc1
    v_dot2_f32_bf16 v49, v244, s76, v35
    v_dot2_f32_bf16 v50, v245, s75, v35
    v_dot2_f32_bf16 v51, v245, s76, v35
    v_dot2_f32_bf16 v52, v246, s75, v35
    v_dot2_f32_bf16 v53, v246, s76, v35
    v_dot2_f32_bf16 v54, v247, s75, v35
    v_dot2_f32_bf16 v55, v247, s76, v35
    v_cvt_pk_bf16_f32 v240, v40, v41
    v_cvt_pk_bf16_f32 v241, v42, v43
    v_cvt_pk_bf16_f32 v242, v44, v45
    v_cvt_pk_bf16_f32 v243, v46, v47
    ds_write_b128 v5, v[240:243] offset:32768
    v_dot2_f32_bf16 v40, v248, s75, v35
    v_dot2_f32_bf16 v41, v248, s76, v35
    v_dot2_f32_bf16 v42, v249, s75, v35
    v_dot2_f32_bf16 v43, v249, s76, v35
    buffer_store_dwordx4 v[64:67], v22, s[24:27], s81 offen sc1
    v_dot2_f32_bf16 v44, v250, s75, v35
    v_dot2_f32_bf16 v45, v250, s76, v35
    v_dot2_f32_bf16 v46, v251, s75, v35
    v_dot2_f32_bf16 v47, v251, s76, v35
    v_cvt_pk_bf16_f32 v244, v48, v49
    v_cvt_pk_bf16_f32 v245, v50, v51
    v_cvt_pk_bf16_f32 v246, v52, v53
    v_cvt_pk_bf16_f32 v247, v54, v55
    ds_write_b128 v5, v[244:247] offset:40960
    v_dot2_f32_bf16 v48, v252, s75, v35
    v_dot2_f32_bf16 v49, v252, s76, v35
    v_dot2_f32_bf16 v50, v253, s75, v35
    v_dot2_f32_bf16 v51, v253, s76, v35
    v_dot2_f32_bf16 v52, v254, s75, v35
    v_dot2_f32_bf16 v53, v254, s76, v35
    v_dot2_f32_bf16 v54, v255, s75, v35
    buffer_store_dwordx4 v[64:67], v22, s[24:27], s82 offen sc1
    v_dot2_f32_bf16 v55, v255, s76, v35
    v_cvt_pk_bf16_f32 v248, v40, v41
    v_cvt_pk_bf16_f32 v249, v42, v43
    v_cvt_pk_bf16_f32 v250, v44, v45
    v_cvt_pk_bf16_f32 v251, v46, v47
    ds_write_b128 v5, v[248:251] offset:49152
    v_cvt_pk_bf16_f32 v252, v48, v49
    v_cvt_pk_bf16_f32 v253, v50, v51
    v_cvt_pk_bf16_f32 v254, v52, v53
    v_cvt_pk_bf16_f32 v255, v54, v55
    ds_write_b128 v5, v[252:255] offset:57344
    v_dot2c_f32_bf16 v36, v224, v224
    v_dot2c_f32_bf16 v36, v225, v225
    v_dot2c_f32_bf16 v36, v226, v226
    v_dot2c_f32_bf16 v36, v227, v227
    v_dot2c_f32_bf16 v36, v228, v228
    buffer_store_dwordx4 v[64:67], v1, s[24:27], s99 offen sc1
    v_dot2c_f32_bf16 v36, v229, v229
    v_dot2c_f32_bf16 v36, v230, v230
    v_dot2c_f32_bf16 v36, v231, v231
    v_dot2c_f32_bf16 v36, v232, v232
    v_dot2c_f32_bf16 v36, v233, v233
    v_dot2c_f32_bf16 v36, v234, v234
    v_dot2c_f32_bf16 v36, v235, v235
    v_dot2c_f32_bf16 v36, v236, v236
    v_dot2c_f32_bf16 v36, v237, v237
    v_dot2c_f32_bf16 v36, v238, v238
    v_dot2c_f32_bf16 v36, v239, v239
    s_add_u32 m0, s88, 61440
    s_nop 0
    buffer_load_dwordx4 v8, s[12:15], s61 offen offset:0 lds
    buffer_load_dwordx4 v9, s[12:15], s61 offen offset:1024 lds
    buffer_load_dwordx4 v10, s[12:15], s61 offen offset:2048 lds
    s_add_u32 m0, s88, 73728
    s_nop 0
    buffer_load_dwordx4 v8, s[12:15], s62 offen offset:0 lds
    buffer_load_dwordx4 v9, s[12:15], s62 offen offset:1024 lds
    buffer_load_dwordx4 v10, s[12:15], s62 offen offset:2048 lds
    buffer_load_dword v27, off, s[32:35], 0 sc1
    s_waitcnt vmcnt(21) lgkmcnt(0)
    s_barrier
    ds_read_b128 v[128:131], v6 offset:0
    ds_read_b128 v[132:135], v6 offset:1024
    ds_read_b64_tr_b16 v[80:81], v11 offset:0
    ds_read_b64_tr_b16 v[82:83], v11 offset:768
    ds_read_b64_tr_b16 v[84:85], v11 offset:64
    ds_read_b64_tr_b16 v[86:87], v11 offset:832
    ds_read_b64_tr_b16 v[88:89], v11 offset:128
    ds_read_b64_tr_b16 v[90:91], v11 offset:896
    ds_read_b128 v[136:139], v7 offset:4096
    ds_read_b128 v[140:143], v7 offset:5120
    ds_read_b64_tr_b16 v[92:93], v11 offset:6144
    ds_read_b64_tr_b16 v[94:95], v11 offset:6912
    ds_read_b64_tr_b16 v[96:97], v11 offset:6208
    ds_read_b64_tr_b16 v[98:99], v11 offset:6976
    ds_read_b64_tr_b16 v[100:101], v11 offset:6272
    ds_read_b64_tr_b16 v[102:103], v11 offset:7040
    v_dot2c_f32_bf16 v36, v240, v240
    v_dot2c_f32_bf16 v36, v241, v241
    v_dot2c_f32_bf16 v36, v242, v242
    v_dot2c_f32_bf16 v36, v243, v243
    v_dot2c_f32_bf16 v36, v244, v244
    v_dot2c_f32_bf16 v36, v245, v245
    v_dot2c_f32_bf16 v36, v246, v246
    v_dot2c_f32_bf16 v36, v247, v247
    v_dot2c_f32_bf16 v36, v248, v248
    v_dot2c_f32_bf16 v36, v249, v249
    v_dot2c_f32_bf16 v36, v250, v250
    v_dot2c_f32_bf16 v36, v251, v251
    v_dot2c_f32_bf16 v36, v252, v252
    v_dot2c_f32_bf16 v36, v253, v253
    v_dot2c_f32_bf16 v36, v254, v254
    v_dot2c_f32_bf16 v36, v255, v255
    s_nop 2
    v_add_f32_dpp v36, v36, v36 quad_perm:[1,0,3,2] row_mask:0xf bank_mask:0xf
    s_nop 1
    v_add_f32_dpp v36, v36, v36 quad_perm:[2,3,0,1] row_mask:0xf bank_mask:0xf
    s_nop 1
    v_add_f32_dpp v36, v36, v36 row_half_mirror row_mask:0xf bank_mask:0xf
    v_mov_b32 v37, 0x3727c5ac
    v_fmac_f32 v37, 0x3b000000, v36
    v_rsq_f32 v29, v37
    s_waitcnt lgkmcnt(0)
    v_mfma_f32_16x16x32_bf16 v[32:35], v[128:131], v[80:83], 0
    ds_read_b128 v[144:147], v6 offset:8192
    ds_read_b128 v[148:151], v6 offset:9216
    v_mfma_f32_16x16x32_bf16 v[36:39], v[132:135], v[80:83], 0
    ds_read_b64_tr_b16 v[104:105], v11 offset:12288
    ds_read_b64_tr_b16 v[106:107], v11 offset:13056
    v_mfma_f32_16x16x32_bf16 v[40:43], v[128:131], v[84:87], 0
    ds_read_b64_tr_b16 v[108:109], v11 offset:12352
    ds_read_b64_tr_b16 v[110:111], v11 offset:13120
    v_mfma_f32_16x16x32_bf16 v[44:47], v[132:135], v[84:87], 0
    ds_read_b64_tr_b16 v[112:113], v11 offset:12416
    ds_read_b64_tr_b16 v[114:115], v11 offset:13184
    v_mfma_f32_16x16x32_bf16 v[48:51], v[128:131], v[88:91], 0
    ds_read_b128 v[152:155], v7 offset:12288
    ds_read_b128 v[156:159], v7 offset:13312
    v_mfma_f32_16x16x32_bf16 v[52:55], v[132:135], v[88:91], 0
    ds_read_b64_tr_b16 v[116:117], v11 offset:18432
    ds_read_b64_tr_b16 v[118:119], v11 offset:19200
    v_mfma_f32_16x16x32_bf16 v[32:35], v[136:139], v[92:95], v[32:35]
    ds_read_b64_tr_b16 v[120:121], v11 offset:18496
    ds_read_b64_tr_b16 v[122:123], v11 offset:19264
    v_mfma_f32_16x16x32_bf16 v[36:39], v[140:143], v[92:95], v[36:39]
    ds_read_b64_tr_b16 v[124:125], v11 offset:18560
    ds_read_b64_tr_b16 v[126:127], v11 offset:19328
    v_mfma_f32_16x16x32_bf16 v[40:43], v[136:139], v[96:99], v[40:43]
    s_add_u32 m0, s88, 86016
    s_nop 0
    buffer_load_dwordx4 v8, s[12:15], s63 offen offset:0 lds
    v_mfma_f32_16x16x32_bf16 v[44:47], v[140:143], v[96:99], v[44:47]
    buffer_load_dwordx4 v9, s[12:15], s63 offen offset:1024 lds
    v_mfma_f32_16x16x32_bf16 v[48:51], v[136:139], v[100:103], v[48:51]
    buffer_load_dwordx4 v10, s[12:15], s63 offen offset:2048 lds
    v_mfma_f32_16x16x32_bf16 v[52:55], v[140:143], v[100:103], v[52:55]
    s_waitcnt lgkmcnt(0)
    v_mfma_f32_16x16x32_bf16 v[32:35], v[144:147], v[104:107], v[32:35]
    ds_read_b128 v[160:163], v6 offset:16384
    ds_read_b128 v[164:167], v6 offset:17408
    v_mfma_f32_16x16x32_bf16 v[36:39], v[148:151], v[104:107], v[36:39]
    ds_read_b64_tr_b16 v[80:81], v11 offset:24576
    ds_read_b64_tr_b16 v[82:83], v11 offset:25344
    v_mfma_f32_16x16x32_bf16 v[40:43], v[144:147], v[108:111], v[40:43]
    ds_read_b64_tr_b16 v[84:85], v11 offset:24640
    ds_read_b64_tr_b16 v[86:87], v11 offset:25408
    v_mfma_f32_16x16x32_bf16 v[44:47], v[148:151], v[108:111], v[44:47]
    ds_read_b64_tr_b16 v[88:89], v11 offset:24704
    ds_read_b64_tr_b16 v[90:91], v11 offset:25472
    v_mfma_f32_16x16x32_bf16 v[48:51], v[144:147], v[112:115], v[48:51]
    ds_read_b128 v[168:171], v7 offset:20480
    ds_read_b128 v[172:175], v7 offset:21504
    v_mfma_f32_16x16x32_bf16 v[52:55], v[148:151], v[112:115], v[52:55]
    ds_read_b64_tr_b16 v[92:93], v11 offset:30720
    ds_read_b64_tr_b16 v[94:95], v11 offset:31488
    v_mfma_f32_16x16x32_bf16 v[32:35], v[152:155], v[116:119], v[32:35]
    ds_read_b64_tr_b16 v[96:97], v11 offset:30784
    ds_read_b64_tr_b16 v[98:99], v11 offset:31552
    v_mfma_f32_16x16x32_bf16 v[36:39], v[156:159], v[116:119], v[36:39]
    ds_read_b64_tr_b16 v[100:101], v11 offset:30848
    ds_read_b64_tr_b16 v[102:103], v11 offset:31616
    v_mfma_f32_16x16x32_bf16 v[40:43], v[152:155], v[120:123], v[40:43]
    v_mfma_f32_16x16x32_bf16 v[44:47], v[156:159], v[120:123], v[44:47]
    v_mfma_f32_16x16x32_bf16 v[48:51], v[152:155], v[124:127], v[48:51]
    v_mfma_f32_16x16x32_bf16 v[52:55], v[156:159], v[124:127], v[52:55]
    s_waitcnt vmcnt(7) lgkmcnt(0)
    s_barrier
    v_mfma_f32_16x16x32_bf16 v[32:35], v[160:163], v[80:83], v[32:35]
    ds_read_b128 v[176:179], v6 offset:24576
    ds_read_b128 v[180:183], v6 offset:25600
    v_mfma_f32_16x16x32_bf16 v[36:39], v[164:167], v[80:83], v[36:39]
    ds_read_b64_tr_b16 v[104:105], v11 offset:36864
    ds_read_b64_tr_b16 v[106:107], v11 offset:37632
    v_mfma_f32_16x16x32_bf16 v[40:43], v[160:163], v[84:87], v[40:43]
    ds_read_b64_tr_b16 v[108:109], v11 offset:36928
    ds_read_b64_tr_b16 v[110:111], v11 offset:37696
    v_mfma_f32_16x16x32_bf16 v[44:47], v[164:167], v[84:87], v[44:47]
    ds_read_b64_tr_b16 v[112:113], v11 offset:36992
    ds_read_b64_tr_b16 v[114:115], v11 offset:37760
    v_mfma_f32_16x16x32_bf16 v[48:51], v[160:163], v[88:91], v[48:51]
    ds_read_b128 v[184:187], v7 offset:28672
    ds_read_b128 v[188:191], v7 offset:29696
    v_mfma_f32_16x16x32_bf16 v[52:55], v[164:167], v[88:91], v[52:55]
    ds_read_b64_tr_b16 v[116:117], v11 offset:43008
    ds_read_b64_tr_b16 v[118:119], v11 offset:43776
    v_mfma_f32_16x16x32_bf16 v[32:35], v[168:171], v[92:95], v[32:35]
    ds_read_b64_tr_b16 v[120:121], v11 offset:43072
    ds_read_b64_tr_b16 v[122:123], v11 offset:43840
    v_mfma_f32_16x16x32_bf16 v[36:39], v[172:175], v[92:95], v[36:39]
    ds_read_b64_tr_b16 v[124:125], v11 offset:43136
    ds_read_b64_tr_b16 v[126:127], v11 offset:43904
    v_mfma_f32_16x16x32_bf16 v[40:43], v[168:171], v[96:99], v[40:43]
    ds_write_b32 v30, v28
    ds_write_b32 v26, v29
    v_mfma_f32_16x16x32_bf16 v[44:47], v[172:175], v[96:99], v[44:47]
    s_waitcnt vmcnt(3)
L_rdy_chk:
    v_cmp_ne_u32 vcc, 1, v27
    s_cbranch_vccnz L_rdy_retry
L_rdy_ok:
    v_mfma_f32_16x16x32_bf16 v[48:51], v[168:171], v[100:103], v[48:51]
    v_subrev_u32 v8, 1376, v8
    s_mov_b32 m0, s88
    s_nop 0
    buffer_load_dwordx4 v8, s[12:15], s56 offen offset:0 lds
    v_mfma_f32_16x16x32_bf16 v[52:55], v[172:175], v[100:103], v[52:55]
    v_subrev_u32 v9, 1376, v9
    buffer_load_dwordx4 v9, s[12:15], s56 offen offset:1024 lds
    v_subrev_u32 v10, 1376, v10
    buffer_load_dwordx4 v10, s[12:15], s56 offen offset:2048 lds
    s_waitcnt lgkmcnt(2)
    v_mfma_f32_16x16x32_bf16 v[32:35], v[176:179], v[104:107], v[32:35]
    ds_read_b128 v[192:195], v6 offset:32768
    ds_read_b128 v[196:199], v6 offset:33792
    v_mfma_f32_16x16x32_bf16 v[36:39], v[180:183], v[104:107], v[36:39]
    ds_read_b64_tr_b16 v[80:81], v12 offset:0
    ds_read_b64_tr_b16 v[82:83], v12 offset:768
    v_mfma_f32_16x16x32_bf16 v[40:43], v[176:179], v[108:111], v[40:43]
    ds_read_b64_tr_b16 v[84:85], v12 offset:64
    ds_read_b64_tr_b16 v[86:87], v12 offset:832
    v_mfma_f32_16x16x32_bf16 v[44:47], v[180:183], v[108:111], v[44:47]
    ds_read_b64_tr_b16 v[88:89], v12 offset:128
    ds_read_b64_tr_b16 v[90:91], v12 offset:896
    v_mfma_f32_16x16x32_bf16 v[48:51], v[176:179], v[112:115], v[48:51]
    ds_read_b128 v[200:203], v7 offset:36864
    ds_read_b128 v[204:207], v7 offset:37888
    v_mfma_f32_16x16x32_bf16 v[52:55], v[180:183], v[112:115], v[52:55]
    ds_read_b64_tr_b16 v[92:93], v12 offset:6144
    ds_read_b64_tr_b16 v[94:95], v12 offset:6912
    v_mfma_f32_16x16x32_bf16 v[32:35], v[184:187], v[116:119], v[32:35]
    ds_read_b64_tr_b16 v[96:97], v12 offset:6208
    ds_read_b64_tr_b16 v[98:99], v12 offset:6976
    v_mfma_f32_16x16x32_bf16 v[36:39], v[188:191], v[116:119], v[36:39]
    ds_read_b64_tr_b16 v[100:101], v12 offset:6272
    ds_read_b64_tr_b16 v[102:103], v12 offset:7040
    v_mfma_f32_16x16x32_bf16 v[40:43], v[184:187], v[120:123], v[40:43]
    s_add_u32 m0, s88, 12288
    s_nop 0
    buffer_load_dwordx4 v8, s[12:15], s57 offen offset:0 lds
    v_mfma_f32_16x16x32_bf16 v[44:47], v[188:191], v[120:123], v[44:47]
    buffer_load_dwordx4 v9, s[12:15], s57 offen offset:1024 lds
    v_mfma_f32_16x16x32_bf16 v[48:51], v[184:187], v[124:127], v[48:51]
    buffer_load_dwordx4 v10, s[12:15], s57 offen offset:2048 lds
    v_mfma_f32_16x16x32_bf16 v[52:55], v[188:191], v[124:127], v[52:55]
    s_waitcnt lgkmcnt(0)
    v_mfma_f32_16x16x32_bf16 v[32:35], v[192:195], v[80:83], v[32:35]
    ds_read_b128 v[208:211], v6 offset:40960
    ds_read_b128 v[212:215], v6 offset:41984
    v_mfma_f32_16x16x32_bf16 v[36:39], v[196:199], v[80:83], v[36:39]
    ds_read_b64_tr_b16 v[104:105], v12 offset:12288
    ds_read_b64_tr_b16 v[106:107], v12 offset:13056
    v_mfma_f32_16x16x32_bf16 v[40:43], v[192:195], v[84:87], v[40:43]
    ds_read_b64_tr_b16 v[108:109], v12 offset:12352
    ds_read_b64_tr_b16 v[110:111], v12 offset:13120
    v_mfma_f32_16x16x32_bf16 v[44:47], v[196:199], v[84:87], v[44:47]
    ds_read_b64_tr_b16 v[112:113], v12 offset:12416
    ds_read_b64_tr_b16 v[114:115], v12 offset:13184
    v_mfma_f32_16x16x32_bf16 v[48:51], v[192:195], v[88:91], v[48:51]
    ds_read_b128 v[216:219], v7 offset:45056
    ds_read_b128 v[220:223], v7 offset:46080
    v_mfma_f32_16x16x32_bf16 v[52:55], v[196:199], v[88:91], v[52:55]
    ds_read_b64_tr_b16 v[116:117], v12 offset:18432
    ds_read_b64_tr_b16 v[118:119], v12 offset:19200
    v_mfma_f32_16x16x32_bf16 v[32:35], v[200:203], v[92:95], v[32:35]
    ds_read_b64_tr_b16 v[120:121], v12 offset:18496
    ds_read_b64_tr_b16 v[122:123], v12 offset:19264
    v_mfma_f32_16x16x32_bf16 v[36:39], v[204:207], v[92:95], v[36:39]
    ds_read_b64_tr_b16 v[124:125], v12 offset:18560
    ds_read_b64_tr_b16 v[126:127], v12 offset:19328
    v_mfma_f32_16x16x32_bf16 v[40:43], v[200:203], v[96:99], v[40:43]
    s_add_u32 m0, s88, 24576
    s_nop 0
    buffer_load_dwordx4 v8, s[12:15], s58 offen offset:0 lds
    v_mfma_f32_16x16x32_bf16 v[44:47], v[204:207], v[96:99], v[44:47]
    buffer_load_dwordx4 v9, s[12:15], s58 offen offset:1024 lds
    v_mfma_f32_16x16x32_bf16 v[48:51], v[200:203], v[100:103], v[48:51]
    buffer_load_dwordx4 v10, s[12:15], s58 offen offset:2048 lds
    v_mfma_f32_16x16x32_bf16 v[52:55], v[204:207], v[100:103], v[52:55]
    s_waitcnt vmcnt(9) lgkmcnt(0)
    s_barrier
    v_mfma_f32_16x16x32_bf16 v[32:35], v[208:211], v[104:107], v[32:35]
    ds_read_b128 v[224:227], v6 offset:49152
    ds_read_b128 v[228:231], v6 offset:50176
    v_mfma_f32_16x16x32_bf16 v[36:39], v[212:215], v[104:107], v[36:39]
    ds_read_b64_tr_b16 v[80:81], v12 offset:24576
    ds_read_b64_tr_b16 v[82:83], v12 offset:25344
    v_mfma_f32_16x16x32_bf16 v[40:43], v[208:211], v[108:111], v[40:43]
    ds_read_b64_tr_b16 v[84:85], v12 offset:24640
    ds_read_b64_tr_b16 v[86:87], v12 offset:25408
    v_mfma_f32_16x16x32_bf16 v[44:47], v[212:215], v[108:111], v[44:47]
    ds_read_b64_tr_b16 v[88:89], v12 offset:24704
    ds_read_b64_tr_b16 v[90:91], v12 offset:25472
    v_mfma_f32_16x16x32_bf16 v[48:51], v[208:211], v[112:115], v[48:51]
    ds_read_b128 v[232:235], v7 offset:53248
    ds_read_b128 v[236:239], v7 offset:54272
    v_mfma_f32_16x16x32_bf16 v[52:55], v[212:215], v[112:115], v[52:55]
    ds_read_b64_tr_b16 v[92:93], v12 offset:30720
    ds_read_b64_tr_b16 v[94:95], v12 offset:31488
    v_mfma_f32_16x16x32_bf16 v[32:35], v[216:219], v[116:119], v[32:35]
    ds_read_b64_tr_b16 v[96:97], v12 offset:30784
    ds_read_b64_tr_b16 v[98:99], v12 offset:31552
    v_mfma_f32_16x16x32_bf16 v[36:39], v[220:223], v[116:119], v[36:39]
    ds_read_b64_tr_b16 v[100:101], v12 offset:30848
    ds_read_b64_tr_b16 v[102:103], v12 offset:31616
    v_mfma_f32_16x16x32_bf16 v[40:43], v[216:219], v[120:123], v[40:43]
    ds_read_b128 v[56:59], v2 offset:0
    ds_read_b128 a[228:231], v2 offset:0
    ds_read_b32 a244, v3 offset:0
    ds_read_b128 v[60:63], v2 offset:64
    ds_read_b128 a[236:239], v2 offset:64
    ds_read_b32 a245, v3 offset:64
    v_mfma_f32_16x16x32_bf16 v[44:47], v[220:223], v[120:123], v[44:47]
    s_add_u32 m0, s88, 36864
    s_nop 0
    buffer_load_dwordx4 v8, s[12:15], s59 offen offset:0 lds
    v_mfma_f32_16x16x32_bf16 v[48:51], v[216:219], v[124:127], v[48:51]
    buffer_load_dwordx4 v9, s[12:15], s59 offen offset:1024 lds
    v_mfma_f32_16x16x32_bf16 v[52:55], v[220:223], v[124:127], v[52:55]
    buffer_load_dwordx4 v10, s[12:15], s59 offen offset:2048 lds
    s_waitcnt lgkmcnt(6)
    v_mfma_f32_16x16x32_bf16 v[32:35], v[224:227], v[80:83], v[32:35]
    ds_read_b128 v[240:243], v6 offset:57344
    ds_read_b128 v[244:247], v6 offset:58368
    v_mfma_f32_16x16x32_bf16 v[36:39], v[228:231], v[80:83], v[36:39]
    ds_read_b64_tr_b16 v[104:105], v12 offset:36864
    ds_read_b64_tr_b16 v[106:107], v12 offset:37632
    v_mfma_f32_16x16x32_bf16 v[40:43], v[224:227], v[84:87], v[40:43]
    ds_read_b64_tr_b16 v[108:109], v12 offset:36928
    ds_read_b64_tr_b16 v[110:111], v12 offset:37696
    v_mfma_f32_16x16x32_bf16 v[44:47], v[228:231], v[84:87], v[44:47]
    ds_read_b64_tr_b16 v[112:113], v12 offset:36992
    ds_read_b64_tr_b16 v[114:115], v12 offset:37760
    v_mfma_f32_16x16x32_bf16 v[48:51], v[224:227], v[88:91], v[48:51]
    ds_read_b128 v[248:251], v7 offset:61440
    ds_read_b128 v[252:255], v7 offset:62464
    v_mfma_f32_16x16x32_bf16 v[52:55], v[228:231], v[88:91], v[52:55]
    ds_read_b64_tr_b16 v[116:117], v12 offset:43008
    ds_read_b64_tr_b16 v[118:119], v12 offset:43776
    v_mfma_f32_16x16x32_bf16 v[32:35], v[232:235], v[92:95], v[32:35]
    ds_read_b64_tr_b16 v[120:121], v12 offset:43072
    ds_read_b64_tr_b16 v[122:123], v12 offset:43840
    v_mfma_f32_16x16x32_bf16 v[36:39], v[236:239], v[92:95], v[36:39]
    ds_read_b64_tr_b16 v[124:125], v12 offset:43136
    ds_read_b64_tr_b16 v[126:127], v12 offset:43904
    v_mfma_f32_16x16x32_bf16 v[40:43], v[232:235], v[96:99], v[40:43]
    s_add_u32 m0, s88, 49152
    s_nop 0
    buffer_load_dwordx4 v8, s[12:15], s60 offen offset:0 lds
    v_mfma_f32_16x16x32_bf16 v[44:47], v[236:239], v[96:99], v[44:47]
    buffer_load_dwordx4 v9, s[12:15], s60 offen offset:1024 lds
    v_mfma_f32_16x16x32_bf16 v[48:51], v[232:235], v[100:103], v[48:51]
    buffer_load_dwordx4 v10, s[12:15], s60 offen offset:2048 lds
    v_mfma_f32_16x16x32_bf16 v[52:55], v[236:239], v[100:103], v[52:55]
    s_waitcnt lgkmcnt(0)
    s_barrier
    v_mfma_f32_16x16x32_bf16 v[32:35], v[240:243], v[104:107], v[32:35]
    v_mov_b32 v2, 1
    v_mov_b32 v3, 9240576
    buffer_store_byte v2, v3, s[24:27], s4 offen sc1
    v_mfma_f32_16x16x32_bf16 v[36:39], v[244:247], v[104:107], v[36:39]
    v_lshrrev_b32 v24, 3, v0
    v_bfe_u32 v25, v0, 4, 1
    v_mfma_f32_16x16x32_bf16 v[40:43], v[240:243], v[108:111], v[40:43]
    s_add_u32 m0, s88, 61440
    s_nop 0
    buffer_load_dwordx4 v8, s[12:15], s61 offen offset:0 lds
    v_mfma_f32_16x16x32_bf16 v[44:47], v[244:247], v[108:111], v[44:47]
    s_lshl_b32 s3, s44, 1
    v_add_u32 v25, s3, v25
    v_mfma_f32_16x16x32_bf16 v[48:51], v[240:243], v[112:115], v[48:51]
    buffer_load_dwordx4 v9, s[12:15], s61 offen offset:1024 lds
    v_mfma_f32_16x16x32_bf16 v[52:55], v[244:247], v[112:115], v[52:55]
    v_lshlrev_b32 v25, 1, v25
    v_and_b32 v30, 7, v0
    v_mfma_f32_16x16x32_bf16 v[32:35], v[248:251], v[116:119], v[32:35]
    buffer_load_dwordx4 v10, s[12:15], s61 offen offset:2048 lds
    v_mfma_f32_16x16x32_bf16 v[36:39], v[252:255], v[116:119], v[36:39]
    v_xor_b32 v25, v25, v30
    v_lshlrev_b32 v25, 4, v25
    v_mfma_f32_16x16x32_bf16 v[40:43], v[248:251], v[120:123], v[40:43]
    s_lshl_b32 s3, s42, 13
    v_lshl_add_u32 v25, v24, 10, v25
    v_mfma_f32_16x16x32_bf16 v[44:47], v[252:255], v[120:123], v[44:47]
    v_add_u32 v6, s3, v25
    v_mfma_f32_16x16x32_bf16 v[48:51], v[248:251], v[124:127], v[48:51]
    v_mfma_f32_16x16x32_bf16 v[52:55], v[252:255], v[124:127], v[52:55]
    v_pk_mul_f32 v[32:33], v[32:33], v[56:57]
    s_add_u32 m0, s88, 73728
    v_nop_e64
    buffer_load_dwordx4 v8, s[12:15], s62 offen offset:0 lds
    v_pk_mul_f32 v[34:35], v[34:35], v[58:59]
    v_pk_mul_f32 v[36:37], v[36:37], v[60:61]
    v_pk_mul_f32 v[38:39], v[38:39], v[62:63]
    v_pk_mul_f32 v[104:105], v[32:33], v[32:33]
    v_pk_mul_f32 v[106:107], v[34:35], v[34:35]
    v_pk_mul_f32 v[108:109], v[36:37], v[36:37]
    v_pk_mul_f32 v[110:111], v[38:39], v[38:39]
    v_pk_fma_f32 v[104:105], v[104:105], s[72:73], s[72:73] op_sel:[0,0,1] op_sel_hi:[1,0,1]
    v_pk_fma_f32 v[106:107], v[106:107], s[72:73], s[72:73] op_sel:[0,0,1] op_sel_hi:[1,0,1]
    v_pk_fma_f32 v[108:109], v[108:109], s[72:73], s[72:73] op_sel:[0,0,1] op_sel_hi:[1,0,1]
    v_pk_fma_f32 v[110:111], v[110:111], s[72:73], s[72:73] op_sel:[0,0,1] op_sel_hi:[1,0,1]
    v_pk_mul_f32 v[104:105], v[104:105], v[32:33]
    v_pk_mul_f32 v[106:107], v[106:107], v[34:35]
    buffer_load_dwordx4 v9, s[12:15], s62 offen offset:1024 lds
    v_pk_mul_f32 v[108:109], v[108:109], v[36:37]
    v_pk_mul_f32 v[110:111], v[110:111], v[38:39]
    v_exp_f32 v104, v104
    v_exp_f32 v105, v105
    v_exp_f32 v106, v106
    v_exp_f32 v107, v107
    v_exp_f32 v108, v108
    v_exp_f32 v109, v109
    buffer_load_dwordx4 v10, s[12:15], s62 offen offset:2048 lds
    v_exp_f32 v110, v110
    v_exp_f32 v111, v111
    v_pk_add_f32 v[104:105], v[104:105], 1.0 op_sel_hi:[1,0]
    v_pk_add_f32 v[106:107], v[106:107], 1.0 op_sel_hi:[1,0]
    v_pk_add_f32 v[108:109], v[108:109], 1.0 op_sel_hi:[1,0]
    v_pk_add_f32 v[110:111], v[110:111], 1.0 op_sel_hi:[1,0]
    v_rcp_f32 v104, v104
    v_rcp_f32 v105, v105
    v_rcp_f32 v106, v106
    s_mov_b32 m0, s89
    s_nop 0
    buffer_load_dwordx4 v13, s[16:19], s68 offen offset:0 lds
    v_rcp_f32 v107, v107
    v_rcp_f32 v108, v108
    v_rcp_f32 v109, v109
    v_rcp_f32 v110, v110
    v_rcp_f32 v111, v111
    v_pk_mul_f32 v[32:33], v[32:33], v[104:105]
    v_pk_mul_f32 v[34:35], v[34:35], v[106:107]
    v_pk_mul_f32 v[36:37], v[36:37], v[108:109]
    buffer_load_dwordx4 v14, s[16:19], s68 offen offset:1024 lds
    v_pk_mul_f32 v[38:39], v[38:39], v[110:111]
    v_pk_mul_f32 v[72:73], v[32:33], v[32:33]
    v_pk_mul_f32 v[74:75], v[34:35], v[34:35]
    v_pk_mul_f32 v[76:77], v[36:37], v[36:37]
    v_pk_mul_f32 v[78:79], v[38:39], v[38:39]
    v_pk_mul_f32 v[56:57], v[56:57], s[86:87] op_sel:[0,0] op_sel_hi:[1,0]
    v_pk_mul_f32 v[58:59], v[58:59], s[86:87] op_sel:[0,0] op_sel_hi:[1,0]
    v_pk_mul_f32 v[60:61], v[60:61], s[86:87] op_sel:[0,0] op_sel_hi:[1,0]
    v_pk_mul_f32 v[62:63], v[62:63], s[86:87] op_sel:[0,0] op_sel_hi:[1,0]
    v_pk_mul_f32 v[40:41], v[40:41], v[56:57]
    v_pk_mul_f32 v[42:43], v[42:43], v[58:59]
    v_pk_mul_f32 v[44:45], v[44:45], v[60:61]
    v_pk_mul_f32 v[46:47], v[46:47], v[62:63]
    buffer_load_dwordx4 v15, s[16:19], s68 offen offset:2048 lds
    v_pk_mul_f32 v[104:105], v[40:41], v[40:41]
    v_pk_mul_f32 v[106:107], v[42:43], v[42:43]
    v_pk_mul_f32 v[108:109], v[44:45], v[44:45]
    v_pk_mul_f32 v[110:111], v[46:47], v[46:47]
    v_pk_fma_f32 v[104:105], v[104:105], s[72:73], s[72:73] op_sel:[0,0,1] op_sel_hi:[1,0,1]
    v_pk_fma_f32 v[106:107], v[106:107], s[72:73], s[72:73] op_sel:[0,0,1] op_sel_hi:[1,0,1]
    v_pk_fma_f32 v[108:109], v[108:109], s[72:73], s[72:73] op_sel:[0,0,1] op_sel_hi:[1,0,1]
    v_pk_fma_f32 v[110:111], v[110:111], s[72:73], s[72:73] op_sel:[0,0,1] op_sel_hi:[1,0,1]
    v_pk_mul_f32 v[104:105], v[104:105], v[40:41]
    v_pk_mul_f32 v[106:107], v[106:107], v[42:43]
    v_pk_mul_f32 v[108:109], v[108:109], v[44:45]
    v_pk_mul_f32 v[110:111], v[110:111], v[46:47]
    v_exp_f32 v104, v104
    buffer_load_dwordx4 v16, s[16:19], s68 offen offset:3072 lds
    v_exp_f32 v105, v105
    v_exp_f32_e64 v106, v106
    v_exp_f32 v107, v107
    v_exp_f32 v108, v108
    v_exp_f32 v109, v109
    v_exp_f32 v110, v110
    v_exp_f32 v111, v111
    v_pk_add_f32 v[104:105], v[104:105], 1.0 op_sel_hi:[1,0]
    v_pk_add_f32 v[106:107], v[106:107], 1.0 op_sel_hi:[1,0]
    v_pk_add_f32 v[108:109], v[108:109], 1.0 op_sel_hi:[1,0]
    v_pk_add_f32 v[110:111], v[110:111], 1.0 op_sel_hi:[1,0]
    v_rcp_f32 v104, v104
    v_rcp_f32 v105, v105
    v_rcp_f32 v106, v106
    v_rcp_f32 v107, v107
    v_rcp_f32 v108, v108
    s_add_u32 m0, s88, 86016
    s_nop 0
    buffer_load_dwordx4 v8, s[12:15], s63 offen offset:0 lds
    v_rcp_f32 v109, v109
    v_rcp_f32 v110, v110
    v_rcp_f32 v111, v111
    v_pk_mul_f32 v[40:41], v[40:41], v[104:105]
    v_pk_mul_f32 v[42:43], v[42:43], v[106:107]
    v_pk_mul_f32 v[44:45], v[44:45], v[108:109]
    v_pk_mul_f32 v[46:47], v[46:47], v[110:111]
    v_pk_fma_f32 v[72:73], v[40:41], v[40:41], v[72:73]
    v_pk_add_f32 v[64:65], v[40:41], v[32:33]
    v_pk_fma_f32 v[74:75], v[42:43], v[42:43], v[74:75]
    buffer_load_dwordx4 v9, s[12:15], s63 offen offset:1024 lds
    v_pk_add_f32 v[66:67], v[42:43], v[34:35]
    v_pk_fma_f32 v[76:77], v[44:45], v[44:45], v[76:77]
    v_pk_add_f32 v[68:69], v[44:45], v[36:37]
    v_pk_fma_f32 v[78:79], v[46:47], v[46:47], v[78:79]
    v_pk_add_f32 v[70:71], v[46:47], v[38:39]
    v_pk_mul_f32 v[56:57], v[56:57], s[86:87] op_sel:[0,1] op_sel_hi:[1,1]
    v_pk_mul_f32 v[58:59], v[58:59], s[86:87] op_sel:[0,1] op_sel_hi:[1,1]
    v_pk_mul_f32 v[60:61], v[60:61], s[86:87] op_sel:[0,1] op_sel_hi:[1,1]
    v_pk_mul_f32 v[62:63], v[62:63], s[86:87] op_sel:[0,1] op_sel_hi:[1,1]
    v_pk_mul_f32 v[48:49], v[48:49], v[56:57]
    v_pk_mul_f32 v[50:51], v[50:51], v[58:59]
    v_pk_mul_f32 v[52:53], v[52:53], v[60:61]
    v_pk_mul_f32 v[54:55], v[54:55], v[62:63]
    buffer_load_dwordx4 v10, s[12:15], s63 offen offset:2048 lds
    v_pk_mul_f32 v[104:105], v[48:49], v[48:49]
    v_pk_mul_f32 v[106:107], v[50:51], v[50:51]
    v_pk_mul_f32 v[108:109], v[52:53], v[52:53]
    v_pk_mul_f32 v[110:111], v[54:55], v[54:55]
    v_pk_fma_f32 v[104:105], v[104:105], s[72:73], s[72:73] op_sel:[0,0,1] op_sel_hi:[1,0,1]
    v_pk_fma_f32 v[106:107], v[106:107], s[72:73], s[72:73] op_sel:[0,0,1] op_sel_hi:[1,0,1]
    v_pk_fma_f32 v[108:109], v[108:109], s[72:73], s[72:73] op_sel:[0,0,1] op_sel_hi:[1,0,1]
    v_pk_fma_f32 v[110:111], v[110:111], s[72:73], s[72:73] op_sel:[0,0,1] op_sel_hi:[1,0,1]
    v_pk_mul_f32 v[104:105], v[104:105], v[48:49]
    v_pk_mul_f32 v[106:107], v[106:107], v[50:51]
    v_pk_mul_f32 v[108:109], v[108:109], v[52:53]
    v_pk_mul_f32 v[110:111], v[110:111], v[54:55]
    v_exp_f32 v104, v104
    s_add_u32 m0, s89, 16384
    s_nop 0
    buffer_load_dwordx4 v13, s[16:19], s65 offen offset:0 lds
    v_exp_f32 v105, v105
    v_exp_f32 v106, v106
    v_exp_f32 v107, v107
    v_exp_f32 v108, v108
    v_exp_f32 v109, v109
    v_exp_f32 v110, v110
    v_exp_f32 v111, v111
    buffer_load_dwordx4 v14, s[16:19], s65 offen offset:1024 lds
    v_pk_add_f32 v[104:105], v[104:105], 1.0 op_sel_hi:[1,0]
    v_pk_add_f32 v[106:107], v[106:107], 1.0 op_sel_hi:[1,0]
    v_pk_add_f32 v[108:109], v[108:109], 1.0 op_sel_hi:[1,0]
    v_pk_add_f32 v[110:111], v[110:111], 1.0 op_sel_hi:[1,0]
    v_rcp_f32 v104, v104
    v_rcp_f32 v105, v105
    v_rcp_f32 v106, v106
    v_rcp_f32 v107, v107
    v_rcp_f32 v108, v108
    buffer_load_dwordx4 v15, s[16:19], s65 offen offset:2048 lds
    v_rcp_f32 v109, v109
    v_rcp_f32 v110, v110
    v_rcp_f32_e64 v111, v111
    v_pk_mul_f32 v[48:49], v[48:49], v[104:105]
    v_pk_mul_f32 v[50:51], v[50:51], v[106:107]
    v_pk_mul_f32 v[52:53], v[52:53], v[108:109]
    v_pk_mul_f32 v[54:55], v[54:55], v[110:111]
    v_pk_fma_f32 v[72:73], v[48:49], v[48:49], v[72:73]
    v_pk_add_f32 v[64:65], v[48:49], v[64:65]
    v_pk_fma_f32 v[74:75], v[50:51], v[50:51], v[74:75]
    buffer_load_dwordx4 v16, s[16:19], s65 offen offset:3072 lds
    v_pk_add_f32 v[66:67], v[50:51], v[66:67]
    v_pk_fma_f32 v[76:77], v[52:53], v[52:53], v[76:77]
    v_pk_add_f32 v[68:69], v[52:53], v[68:69]
    v_pk_fma_f32 v[78:79], v[54:55], v[54:55], v[78:79]
    v_pk_add_f32 v[70:71], v[54:55], v[70:71]
    s_waitcnt vmcnt(14)
    s_barrier
    ds_read_b64_tr_b16 v[80:81], v11 offset:0
    ds_read_b64_tr_b16 v[82:83], v11 offset:768
    ds_read_b64_tr_b16 v[84:85], v11 offset:64
    ds_read_b64_tr_b16 v[86:87], v11 offset:832
    ds_read_b64_tr_b16 v[88:89], v11 offset:128
    ds_read_b64_tr_b16 v[90:91], v11 offset:896
    ds_read_b64_tr_b16 v[92:93], v11 offset:6144
    ds_read_b64_tr_b16 v[94:95], v11 offset:6912
    ds_read_b64_tr_b16 v[96:97], v11 offset:6208
    ds_read_b64_tr_b16 v[98:99], v11 offset:6976
    ds_read_b64_tr_b16 v[100:101], v11 offset:6272
    ds_read_b64_tr_b16 v[102:103], v11 offset:7040
    v_add_f32_dpp v64, v64, v64 row_ror:8 row_mask:0xf bank_mask:0x3
    v_add_f32_dpp v65, v65, v65 row_ror:8 row_mask:0xf bank_mask:0x3
    v_add_f32_dpp v66, v66, v66 row_ror:8 row_mask:0xf bank_mask:0x3
    v_add_f32_dpp v67, v67, v67 row_ror:8 row_mask:0xf bank_mask:0x3
    v_add_f32_dpp v68, v68, v68 row_ror:8 row_mask:0xf bank_mask:0x3
    v_add_f32_dpp v69, v69, v69 row_ror:8 row_mask:0xf bank_mask:0x3
    v_add_f32_dpp v70, v70, v70 row_ror:8 row_mask:0xf bank_mask:0x3
    v_add_f32_dpp v71, v71, v71 row_ror:8 row_mask:0xf bank_mask:0x3
    v_add_f32_dpp v64, v72, v72 row_ror:8 row_mask:0xf bank_mask:0xc
    v_add_f32_dpp v65, v73, v73 row_ror:8 row_mask:0xf bank_mask:0xc
    v_add_f32_dpp v66, v74, v74 row_ror:8 row_mask:0xf bank_mask:0xc
    v_add_f32_dpp v67, v75, v75 row_ror:8 row_mask:0xf bank_mask:0xc
    v_add_f32_dpp v68, v76, v76 row_ror:8 row_mask:0xf bank_mask:0xc
    v_add_f32_dpp v69, v77, v77 row_ror:8 row_mask:0xf bank_mask:0xc
    v_add_f32_dpp v70, v78, v78 row_ror:8 row_mask:0xf bank_mask:0xc
    v_add_f32_dpp v71, v79, v79 row_ror:8 row_mask:0xf bank_mask:0xc
    v_add_f32_dpp v64, v64, v64 row_half_mirror row_mask:0xf bank_mask:0x5
    v_add_f32_dpp v65, v65, v65 row_half_mirror row_mask:0xf bank_mask:0x5
    v_add_f32_dpp v66, v66, v66 row_half_mirror row_mask:0xf bank_mask:0x5
    v_add_f32_dpp v67, v67, v67 row_half_mirror row_mask:0xf bank_mask:0x5
    v_add_f32_dpp v64, v68, v68 row_half_mirror row_mask:0xf bank_mask:0xa
    v_add_f32_dpp v65, v69, v69 row_half_mirror row_mask:0xf bank_mask:0xa
    v_add_f32_dpp v66, v70, v70 row_half_mirror row_mask:0xf bank_mask:0xa
    v_add_f32_dpp v67, v71, v71 row_half_mirror row_mask:0xf bank_mask:0xa
    v_add_f32_dpp v64, v64, v64 quad_perm:[1,0,3,2] row_mask:0xf bank_mask:0xf
    v_add_f32_dpp v65, v65, v65 quad_perm:[1,0,3,2] row_mask:0xf bank_mask:0xf
    v_add_f32_dpp v66, v66, v66 quad_perm:[1,0,3,2] row_mask:0xf bank_mask:0xf
    v_add_f32_dpp v67, v67, v67 quad_perm:[1,0,3,2] row_mask:0xf bank_mask:0xf
    v_add_f32_dpp v64, v64, v64 quad_perm:[2,3,0,1] row_mask:0xf bank_mask:0xf
    v_add_f32_dpp v65, v65, v65 quad_perm:[2,3,0,1] row_mask:0xf bank_mask:0xf
    v_add_f32_dpp v66, v66, v66 quad_perm:[2,3,0,1] row_mask:0xf bank_mask:0xf
    v_add_f32_dpp v67, v67, v67 quad_perm:[2,3,0,1] row_mask:0xf bank_mask:0xf
    v_cndmask_b32 v64, v64, v65, s[92:93]
    v_cndmask_b32 v66, v66, v67, s[92:93]
    v_cndmask_b32 v26, v64, v66, s[94:95]
    buffer_store_dword v26, v23, s[24:27], s84 offen sc1
    s_waitcnt lgkmcnt(0)
    v_mfma_f32_16x16x32_bf16 v[56:59], v[80:83], v[128:131], 0
    ds_read_b64_tr_b16 v[104:105], v11 offset:12288
    ds_read_b64_tr_b16 v[106:107], v11 offset:13056
    v_mfma_f32_16x16x32_bf16 v[60:63], v[80:83], v[132:135], 0
    ds_read_b64_tr_b16 v[108:109], v11 offset:12352
    ds_read_b64_tr_b16 v[110:111], v11 offset:13120
    v_mfma_f32_16x16x32_bf16 v[64:67], v[84:87], v[128:131], 0
    ds_read_b64_tr_b16 v[112:113], v11 offset:12416
    ds_read_b64_tr_b16 v[114:115], v11 offset:13184
    v_mfma_f32_16x16x32_bf16 v[68:71], v[84:87], v[132:135], 0
    ds_read_b64_tr_b16 v[116:117], v11 offset:18432
    ds_read_b64_tr_b16 v[118:119], v11 offset:19200
    v_mfma_f32_16x16x32_bf16 v[72:75], v[88:91], v[128:131], 0
    ds_read_b64_tr_b16 v[120:121], v11 offset:18496
    ds_read_b64_tr_b16 v[122:123], v11 offset:19264
    v_mfma_f32_16x16x32_bf16 v[76:79], v[88:91], v[132:135], 0
    ds_read_b64_tr_b16 v[124:125], v11 offset:18560
    ds_read_b64_tr_b16 v[126:127], v11 offset:19328
    v_mfma_f32_16x16x32_bf16 v[56:59], v[92:95], v[136:139], v[56:59]
    s_add_u32 m0, s89, 32768
    s_nop 0
    buffer_load_dwordx4 v13, s[16:19], s64 offen offset:0 lds
    v_mfma_f32_16x16x32_bf16 v[60:63], v[92:95], v[140:143], v[60:63]
    buffer_load_dwordx4 v14, s[16:19], s64 offen offset:1024 lds
    v_mfma_f32_16x16x32_bf16 v[64:67], v[96:99], v[136:139], v[64:67]
    buffer_load_dwordx4 v15, s[16:19], s64 offen offset:2048 lds
    v_mfma_f32_16x16x32_bf16 v[68:71], v[96:99], v[140:143], v[68:71]
    buffer_load_dwordx4 v16, s[16:19], s64 offen offset:3072 lds
    v_mfma_f32_16x16x32_bf16 v[72:75], v[100:103], v[136:139], v[72:75]
    v_mfma_f32_16x16x32_bf16 v[76:79], v[100:103], v[140:143], v[76:79]
    s_waitcnt lgkmcnt(0)
    v_mfma_f32_16x16x32_bf16 v[56:59], v[104:107], v[144:147], v[56:59]
    ds_read_b64_tr_b16 v[80:81], v11 offset:24576
    ds_read_b64_tr_b16 v[82:83], v11 offset:25344
    v_mfma_f32_16x16x32_bf16 v[60:63], v[104:107], v[148:151], v[60:63]
    ds_read_b64_tr_b16 v[84:85], v11 offset:24640
    ds_read_b64_tr_b16 v[86:87], v11 offset:25408
    v_mfma_f32_16x16x32_bf16 v[64:67], v[108:111], v[144:147], v[64:67]
    ds_read_b64_tr_b16 v[88:89], v11 offset:24704
    ds_read_b64_tr_b16 v[90:91], v11 offset:25472
    v_mfma_f32_16x16x32_bf16 v[68:71], v[108:111], v[148:151], v[68:71]
    ds_read_b64_tr_b16 v[92:93], v11 offset:30720
    ds_read_b64_tr_b16 v[94:95], v11 offset:31488
    v_mfma_f32_16x16x32_bf16 v[72:75], v[112:115], v[144:147], v[72:75]
    ds_read_b64_tr_b16 v[96:97], v11 offset:30784
    ds_read_b64_tr_b16 v[98:99], v11 offset:31552
    v_mfma_f32_16x16x32_bf16 v[76:79], v[112:115], v[148:151], v[76:79]
    ds_read_b64_tr_b16 v[100:101], v11 offset:30848
    ds_read_b64_tr_b16 v[102:103], v11 offset:31616
    v_mfma_f32_16x16x32_bf16 v[56:59], v[116:119], v[152:155], v[56:59]
    v_mfma_f32_16x16x32_bf16 v[60:63], v[116:119], v[156:159], v[60:63]
    v_mfma_f32_16x16x32_bf16 v[64:67], v[120:123], v[152:155], v[64:67]
    v_mfma_f32_16x16x32_bf16 v[68:71], v[120:123], v[156:159], v[68:71]
    v_mfma_f32_16x16x32_bf16 v[72:75], v[124:127], v[152:155], v[72:75]
    v_mfma_f32_16x16x32_bf16 v[76:79], v[124:127], v[156:159], v[76:79]
    s_waitcnt lgkmcnt(0)
    v_mfma_f32_16x16x32_bf16 v[56:59], v[80:83], v[160:163], v[56:59]
    ds_read_b64_tr_b16 v[104:105], v11 offset:36864
    ds_read_b64_tr_b16 v[106:107], v11 offset:37632
    v_mfma_f32_16x16x32_bf16 v[60:63], v[80:83], v[164:167], v[60:63]
    ds_read_b64_tr_b16 v[108:109], v11 offset:36928
    ds_read_b64_tr_b16 v[110:111], v11 offset:37696
    v_mfma_f32_16x16x32_bf16 v[64:67], v[84:87], v[160:163], v[64:67]
    ds_read_b64_tr_b16 v[112:113], v11 offset:36992
    ds_read_b64_tr_b16 v[114:115], v11 offset:37760
    v_mfma_f32_16x16x32_bf16 v[68:71], v[84:87], v[164:167], v[68:71]
    ds_read_b64_tr_b16 v[116:117], v11 offset:43008
    ds_read_b64_tr_b16 v[118:119], v11 offset:43776
    v_mfma_f32_16x16x32_bf16 v[72:75], v[88:91], v[160:163], v[72:75]
    ds_read_b64_tr_b16 v[120:121], v11 offset:43072
    ds_read_b64_tr_b16 v[122:123], v11 offset:43840
    v_mfma_f32_16x16x32_bf16 v[76:79], v[88:91], v[164:167], v[76:79]
    ds_read_b64_tr_b16 v[124:125], v11 offset:43136
    ds_read_b64_tr_b16 v[126:127], v11 offset:43904
    v_mfma_f32_16x16x32_bf16 v[56:59], v[92:95], v[168:171], v[56:59]
    s_add_u32 m0, s89, 49152
    s_nop 0
    buffer_load_dwordx4 v13, s[16:19], s66 offen offset:0 lds
    v_mfma_f32_16x16x32_bf16 v[60:63], v[92:95], v[172:175], v[60:63]
    buffer_load_dwordx4 v14, s[16:19], s66 offen offset:1024 lds
    v_mfma_f32_16x16x32_bf16 v[64:67], v[96:99], v[168:171], v[64:67]
    buffer_load_dwordx4 v15, s[16:19], s66 offen offset:2048 lds
    v_mfma_f32_16x16x32_bf16 v[68:71], v[96:99], v[172:175], v[68:71]
    buffer_load_dwordx4 v16, s[16:19], s66 offen offset:3072 lds
    v_mfma_f32_16x16x32_bf16 v[72:75], v[100:103], v[168:171], v[72:75]
    v_mfma_f32_16x16x32_bf16 v[76:79], v[100:103], v[172:175], v[76:79]
    s_waitcnt vmcnt(13) lgkmcnt(0)
    s_barrier
    v_mfma_f32_16x16x32_bf16 v[56:59], v[104:107], v[176:179], v[56:59]
    ds_read_b64_tr_b16 v[80:81], v12 offset:0
    ds_read_b64_tr_b16 v[82:83], v12 offset:768
    v_mfma_f32_16x16x32_bf16 v[60:63], v[104:107], v[180:183], v[60:63]
    ds_read_b64_tr_b16 v[84:85], v12 offset:64
    ds_read_b64_tr_b16 v[86:87], v12 offset:832
    v_mfma_f32_16x16x32_bf16 v[64:67], v[108:111], v[176:179], v[64:67]
    ds_read_b64_tr_b16 v[88:89], v12 offset:128
    ds_read_b64_tr_b16 v[90:91], v12 offset:896
    v_mfma_f32_16x16x32_bf16 v[68:71], v[108:111], v[180:183], v[68:71]
    ds_read_b64_tr_b16 v[92:93], v12 offset:6144
    ds_read_b64_tr_b16 v[94:95], v12 offset:6912
    v_mfma_f32_16x16x32_bf16 v[72:75], v[112:115], v[176:179], v[72:75]
    ds_read_b64_tr_b16 v[96:97], v12 offset:6208
    ds_read_b64_tr_b16 v[98:99], v12 offset:6976
    v_mfma_f32_16x16x32_bf16 v[76:79], v[112:115], v[180:183], v[76:79]
    ds_read_b64_tr_b16 v[100:101], v12 offset:6272
    ds_read_b64_tr_b16 v[102:103], v12 offset:7040
    v_mfma_f32_16x16x32_bf16 v[56:59], v[116:119], v[184:187], v[56:59]
    s_add_u32 m0, s89, 65536
    s_nop 0
    buffer_load_dwordx4 v13, s[16:19], s70 offen offset:0 lds
    v_mfma_f32_16x16x32_bf16 v[60:63], v[116:119], v[188:191], v[60:63]
    s_mul_i32 s56, s64, 96
    s_min_u32 s56, s56, 81920
    v_mfma_f32_16x16x32_bf16 v[64:67], v[120:123], v[184:187], v[64:67]
    buffer_load_dwordx4 v14, s[16:19], s70 offen offset:1024 lds
    v_mfma_f32_16x16x32_bf16 v[68:71], v[120:123], v[188:191], v[68:71]
    s_mul_i32 s57, s65, 96
    s_min_u32 s57, s57, 81920
    v_mfma_f32_16x16x32_bf16 v[72:75], v[124:127], v[184:187], v[72:75]
    buffer_load_dwordx4 v15, s[16:19], s70 offen offset:2048 lds
    v_mfma_f32_16x16x32_bf16 v[76:79], v[124:127], v[188:191], v[76:79]
    s_mul_i32 s58, s66, 96
    s_min_u32 s58, s58, 81920
    buffer_load_dwordx4 v16, s[16:19], s70 offen offset:3072 lds
    s_mul_i32 s59, s67, 96
    s_min_u32 s59, s59, 81920
    s_add_u32 m0, s89, 81920
    v_nop_e64
    buffer_load_dwordx4 v13, s[16:19], s67 offen offset:0 lds
    buffer_load_dwordx4 v14, s[16:19], s67 offen offset:1024 lds
    buffer_load_dwordx4 v15, s[16:19], s67 offen offset:2048 lds
    buffer_load_dwordx4 v16, s[16:19], s67 offen offset:3072 lds
    s_add_u32 m0, s89, 98304
    s_add_u32 s5, s64, 0x20000
    buffer_load_dwordx4 v13, s[16:19], s5 offen offset:0 lds
    s_add_u32 s5, s64, 0x20000
    buffer_load_dwordx4 v14, s[16:19], s5 offen offset:1024 lds
    s_add_u32 s5, s64, 0x20000
    buffer_load_dwordx4 v15, s[16:19], s5 offen offset:2048 lds
    s_add_u32 s5, s64, 0x20000
    buffer_load_dwordx4 v16, s[16:19], s5 offen offset:3072 lds
    s_waitcnt lgkmcnt(0)
    v_mfma_f32_16x16x32_bf16 v[56:59], v[80:83], v[192:195], v[56:59]
    ds_read_b64_tr_b16 v[104:105], v12 offset:12288
    ds_read_b64_tr_b16 v[106:107], v12 offset:13056
    v_mfma_f32_16x16x32_bf16 v[60:63], v[80:83], v[196:199], v[60:63]
    ds_read_b64_tr_b16 v[108:109], v12 offset:12352
    ds_read_b64_tr_b16 v[110:111], v12 offset:13120
    v_mfma_f32_16x16x32_bf16 v[64:67], v[84:87], v[192:195], v[64:67]
    ds_read_b64_tr_b16 v[112:113], v12 offset:12416
    ds_read_b64_tr_b16 v[114:115], v12 offset:13184
    v_mfma_f32_16x16x32_bf16 v[68:71], v[84:87], v[196:199], v[68:71]
    ds_read_b64_tr_b16 v[116:117], v12 offset:18432
    ds_read_b64_tr_b16 v[118:119], v12 offset:19200
    v_mfma_f32_16x16x32_bf16 v[72:75], v[88:91], v[192:195], v[72:75]
    ds_read_b64_tr_b16 v[120:121], v12 offset:18496
    ds_read_b64_tr_b16 v[122:123], v12 offset:19264
    v_mfma_f32_16x16x32_bf16 v[76:79], v[88:91], v[196:199], v[76:79]
    ds_read_b64_tr_b16 v[124:125], v12 offset:18560
    ds_read_b64_tr_b16 v[126:127], v12 offset:19328
    v_mfma_f32_16x16x32_bf16 v[56:59], v[92:95], v[200:203], v[56:59]
    ds_read_b128 a[128:131], v17 offset:0
    ds_read_b128 a[136:139], v18 offset:0
    v_mfma_f32_16x16x32_bf16 v[60:63], v[92:95], v[204:207], v[60:63]
    v_add_u32 v8, 0x10000, v17
    v_add_u32 v9, 0x10000, v18
    v_mfma_f32_16x16x32_bf16 v[64:67], v[96:99], v[200:203], v[64:67]
    ds_read_b128 a[144:147], v19 offset:0
    ds_read_b128 a[152:155], v20 offset:0
    v_mfma_f32_16x16x32_bf16 v[68:71], v[96:99], v[204:207], v[68:71]
    v_add_u32 v10, 0x10000, v19
    v_add_u32 v4, 0x10000, v20
    v_mfma_f32_16x16x32_bf16 v[72:75], v[100:103], v[200:203], v[72:75]
    s_mul_i32 s60, s68, 96
    s_min_u32 s60, s60, 81920
    v_mfma_f32_16x16x32_bf16 v[76:79], v[100:103], v[204:207], v[76:79]
    s_mul_i32 s61, s69, 96
    s_min_u32 s61, s61, 81920
    s_mul_i32 s62, s70, 96
    s_min_u32 s62, s62, 81920
    s_mul_i32 s63, s71, 96
    s_min_u32 s63, s63, 81920
    s_waitcnt lgkmcnt(4)
    v_mfma_f32_16x16x32_bf16 v[56:59], v[104:107], v[208:211], v[56:59]
    ds_read_b64_tr_b16 v[80:81], v12 offset:24576
    ds_read_b64_tr_b16 v[82:83], v12 offset:25344
    v_mfma_f32_16x16x32_bf16 v[60:63], v[104:107], v[212:215], v[60:63]
    ds_read_b64_tr_b16 v[84:85], v12 offset:24640
    ds_read_b64_tr_b16 v[86:87], v12 offset:25408
    v_mfma_f32_16x16x32_bf16 v[64:67], v[108:111], v[208:211], v[64:67]
    ds_read_b64_tr_b16 v[88:89], v12 offset:24704
    ds_read_b64_tr_b16 v[90:91], v12 offset:25472
    v_mfma_f32_16x16x32_bf16 v[68:71], v[108:111], v[212:215], v[68:71]
    ds_read_b64_tr_b16 v[92:93], v12 offset:30720
    ds_read_b64_tr_b16 v[94:95], v12 offset:31488
    v_mfma_f32_16x16x32_bf16 v[72:75], v[112:115], v[208:211], v[72:75]
    ds_read_b64_tr_b16 v[96:97], v12 offset:30784
    ds_read_b64_tr_b16 v[98:99], v12 offset:31552
    v_mfma_f32_16x16x32_bf16 v[76:79], v[112:115], v[212:215], v[76:79]
    ds_read_b64_tr_b16 v[100:101], v12 offset:30848
    ds_read_b64_tr_b16 v[102:103], v12 offset:31616
    v_mfma_f32_16x16x32_bf16 v[56:59], v[116:119], v[216:219], v[56:59]
    v_mul_u32_u24 v2, 260, v0
    v_and_b32 v2, 0x3e04, v2
    v_or_b32 v2, 9240576, v2
    buffer_load_dword v3, v2, s[24:27], 0 offen sc1
    v_mfma_f32_16x16x32_bf16 v[60:63], v[116:119], v[220:223], v[60:63]
    v_lshrrev_b32 v24, 2, v0
    v_lshlrev_b32 v24, 11, v24
    v_mfma_f32_16x16x32_bf16 v[64:67], v[120:123], v[216:219], v[64:67]
    s_waitcnt vmcnt(22)
    ds_read_b128 a[32:35], v17 offset:16384
    ds_read_b128 a[40:43], v18 offset:16384
    v_mfma_f32_16x16x32_bf16 v[68:71], v[120:123], v[220:223], v[68:71]
    v_bfe_u32 v25, v0, 1, 1
    v_lshl_add_u32 v7, v25, 8, v24
    v_mfma_f32_16x16x32_bf16 v[72:75], v[124:127], v[216:219], v[72:75]
    ds_read_b128 a[48:51], v19 offset:16384
    ds_read_b128 a[56:59], v20 offset:16384
    v_mfma_f32_16x16x32_bf16 v[76:79], v[124:127], v[220:223], v[76:79]
    v_and_b32 v24, 12, v0
    v_lshrrev_b32 v25, 4, v0
    v_add_u32_e64 v24, v24, v25
    v_and_b32_e64 v25, 3, v0
    v_lshl_add_u32 v24, v24, 2, v25
    v_lshlrev_b32 v23, 4, v24
    s_waitcnt lgkmcnt(4)
    v_mfma_f32_16x16x32_bf16 v[56:59], v[80:83], v[224:227], v[56:59]
    ds_read_b64_tr_b16 v[104:105], v12 offset:36864
    ds_read_b64_tr_b16 v[106:107], v12 offset:37632
    v_mfma_f32_16x16x32_bf16 v[60:63], v[80:83], v[228:231], v[60:63]
    ds_read_b64_tr_b16 v[108:109], v12 offset:36928
    ds_read_b64_tr_b16 v[110:111], v12 offset:37696
    v_mfma_f32_16x16x32_bf16 v[64:67], v[84:87], v[224:227], v[64:67]
    ds_read_b64_tr_b16 v[112:113], v12 offset:36992
    ds_read_b64_tr_b16 v[114:115], v12 offset:37760
    v_mfma_f32_16x16x32_bf16 v[68:71], v[84:87], v[228:231], v[68:71]
    ds_read_b64_tr_b16 v[116:117], v12 offset:43008
    ds_read_b64_tr_b16 v[118:119], v12 offset:43776
    v_mfma_f32_16x16x32_bf16 v[72:75], v[88:91], v[224:227], v[72:75]
    ds_read_b64_tr_b16 v[120:121], v12 offset:43072
    ds_read_b64_tr_b16 v[122:123], v12 offset:43840
    v_mfma_f32_16x16x32_bf16 v[76:79], v[88:91], v[228:231], v[76:79]
    ds_read_b64_tr_b16 v[124:125], v12 offset:43136
    ds_read_b64_tr_b16 v[126:127], v12 offset:43904
    v_mfma_f32_16x16x32_bf16 v[56:59], v[92:95], v[232:235], v[56:59]
    s_waitcnt vmcnt(17)
    ds_read_b128 a[0:3], v17 offset:32768
    ds_read_b128 a[8:11], v18 offset:32768
    v_mfma_f32_16x16x32_bf16 v[60:63], v[92:95], v[236:239], v[60:63]
    s_cmp_ge_u32 s64, 768
    s_cselect_b32 s6, 768, 0
    s_sub_u32 s74, s64, s6
    v_mfma_f32_16x16x32_bf16 v[64:67], v[96:99], v[232:235], v[64:67]
    ds_read_b128 a[16:19], v19 offset:32768
    ds_read_b128 a[24:27], v20 offset:32768
    v_mfma_f32_16x16x32_bf16 v[68:71], v[96:99], v[236:239], v[68:71]
    s_mul_i32 s6, s74, 96
    s_add_u32 s74, s6, 8192
    v_mfma_f32_16x16x32_bf16 v[72:75], v[100:103], v[232:235], v[72:75]
    s_mov_b32 m0, s89
    v_nop_e64
    buffer_load_dwordx4 v13, s[16:19], s69 offen offset:0 lds
    v_mfma_f32_16x16x32_bf16 v[76:79], v[100:103], v[236:239], v[76:79]
    s_add_u32 s6, s74, 12288
    s_cmp_ge_u32 s6, 81920
    s_cselect_b32 s75, 8192, s6
    buffer_load_dwordx4 v14, s[16:19], s69 offen offset:1024 lds
    s_add_u32 s6, s75, 12288
    s_cmp_ge_u32 s6, 81920
    s_cselect_b32 s76, 8192, s6
    buffer_load_dwordx4 v15, s[16:19], s69 offen offset:2048 lds
    s_add_u32 s6, s76, 12288
    s_cmp_ge_u32 s6, 81920
    s_cselect_b32 s84, 8192, s6
    buffer_load_dwordx4 v16, s[16:19], s69 offen offset:3072 lds
    s_add_u32 s6, s84, 12288
    s_cmp_ge_u32 s6, 81920
    s_cselect_b32 s88, 8192, s6
    s_waitcnt vmcnt(17)
    ds_read_b128 a[64:67], v17 offset:49152
    ds_read_b128 a[72:75], v18 offset:49152
    s_add_u32 s6, s88, 12288
    s_cmp_ge_u32 s6, 81920
    s_cselect_b32 s45, 8192, s6
    ds_read_b128 a[80:83], v19 offset:49152
    ds_read_b128 a[88:91], v20 offset:49152
    v_and_b32 v28, 12, v0
    v_and_b32 v29, 15, v0
    s_lshl1_add_u32 s6, s40, s43
    v_add_lshl_u32 v29, v28, v29, 1
    s_lshl_b32 s6, s6, 6
    buffer_load_short_d16_hi v28, v29, s[36:39], s6 offen
    buffer_load_short_d16_hi v29, v29, s[36:39], s6 offen offset:8
    s_waitcnt lgkmcnt(8)
    s_barrier
    v_mfma_f32_16x16x32_bf16 v[56:59], v[104:107], v[240:243], v[56:59]
    v_accvgpr_read_b32 v26, a244
    v_accvgpr_read_b32 v27, a245
    v_mfma_f32_16x16x32_bf16 v[60:63], v[104:107], v[244:247], v[60:63]
    v_mfma_f32_16x16x32_bf16 v[64:67], v[108:111], v[240:243], v[64:67]
    v_mfma_f32_16x16x32_bf16 v[68:71], v[108:111], v[244:247], v[68:71]
    v_mfma_f32_16x16x32_bf16 v[72:75], v[112:115], v[240:243], v[72:75]
    v_mfma_f32_16x16x32_bf16 v[76:79], v[112:115], v[244:247], v[76:79]
    v_mfma_f32_16x16x32_bf16 v[56:59], v[116:119], v[248:251], v[56:59]
    v_mfma_f32_16x16x32_bf16 v[60:63], v[116:119], v[252:255], v[60:63]
    v_mfma_f32_16x16x32_bf16 v[64:67], v[120:123], v[248:251], v[64:67]
    v_mfma_f32_16x16x32_bf16 v[68:71], v[120:123], v[252:255], v[68:71]
    v_mfma_f32_16x16x32_bf16 v[72:75], v[124:127], v[248:251], v[72:75]
    v_mfma_f32_16x16x32_bf16 v[76:79], v[124:127], v[252:255], v[76:79]
    s_nop 2
    v_pk_mul_f32 v[56:57], v[56:57], v[26:27] op_sel:[0,0] op_sel_hi:[1,0]
    s_waitcnt vmcnt(6)
L_dbg_chk:
    v_and_b32 v3, 0x01010101, v3
    v_cmp_ne_u32 vcc, 0x01010101, v3
    s_cbranch_vccnz L_dbg_retry
L_dbg_ok:
    v_pk_mul_f32 v[58:59], v[58:59], v[26:27] op_sel:[0,0] op_sel_hi:[1,0]
    v_pk_mul_f32 v[60:61], v[60:61], v[26:27] op_sel:[0,1] op_sel_hi:[1,1]
    v_pk_mul_f32 v[62:63], v[62:63], v[26:27] op_sel:[0,1] op_sel_hi:[1,1]
    v_pk_mul_f32 v[104:105], v[56:57], v[56:57]
    v_pk_mul_f32 v[106:107], v[58:59], v[58:59]
    v_pk_mul_f32 v[108:109], v[60:61], v[60:61]
    v_pk_mul_f32 v[110:111], v[62:63], v[62:63]
    v_pk_fma_f32 v[104:105], v[104:105], s[72:73], s[72:73] op_sel:[0,0,1] op_sel_hi:[1,0,1]
    v_pk_fma_f32 v[106:107], v[106:107], s[72:73], s[72:73] op_sel:[0,0,1] op_sel_hi:[1,0,1]
    v_pk_fma_f32 v[108:109], v[108:109], s[72:73], s[72:73] op_sel:[0,0,1] op_sel_hi:[1,0,1]
    v_pk_fma_f32 v[110:111], v[110:111], s[72:73], s[72:73] op_sel:[0,0,1] op_sel_hi:[1,0,1]
    v_pk_mul_f32 v[104:105], v[104:105], v[56:57]
    v_pk_mul_f32 v[106:107], v[106:107], v[58:59]
    v_pk_mul_f32 v[108:109], v[108:109], v[60:61]
    buffer_load_dwordx4 v[80:83], v1, s[24:27], s85 offen offset:0 sc1
    v_pk_mul_f32 v[110:111], v[110:111], v[62:63]
    v_exp_f32 v104, v104
    v_exp_f32 v105, v105
    v_exp_f32 v106, v106
    buffer_load_dwordx4 v[84:87], v1, s[24:27], s85 offen offset:1024 sc1
    v_exp_f32 v107, v107
    v_exp_f32 v108, v108
    v_exp_f32 v109, v109
    buffer_load_dwordx4 v[88:91], v1, s[24:27], s85 offen offset:2048 sc1
    v_exp_f32 v110, v110
    v_exp_f32 v111, v111
    v_pk_add_f32 v[104:105], v[104:105], 1.0 op_sel_hi:[1,0]
    v_pk_add_f32 v[106:107], v[106:107], 1.0 op_sel_hi:[1,0]
    buffer_load_dwordx4 v[92:95], v1, s[24:27], s85 offen offset:3072 sc1
    v_pk_add_f32 v[108:109], v[108:109], 1.0 op_sel_hi:[1,0]
    v_pk_add_f32 v[110:111], v[110:111], 1.0 op_sel_hi:[1,0]
    v_rcp_f32 v104, v104
    v_rcp_f32 v105, v105
    s_add_u32 m0, s89, 16384
    s_add_u32 s5, s68, 0x20000
    buffer_load_dwordx4 v13, s[16:19], s5 offen offset:0 lds
    v_rcp_f32 v106, v106
    v_rcp_f32 v107, v107
    v_rcp_f32 v108, v108
    v_rcp_f32 v109, v109
    v_rcp_f32 v110, v110
    v_rcp_f32 v111, v111
    v_pk_mul_f32 v[56:57], v[56:57], v[104:105]
    v_pk_mul_f32 v[58:59], v[58:59], v[106:107]
    s_add_u32 s5, s68, 0x20000
    buffer_load_dwordx4 v14, s[16:19], s5 offen offset:1024 lds
    v_pk_mul_f32 v[60:61], v[60:61], v[108:109]
    v_pk_mul_f32 v[62:63], v[62:63], v[110:111]
    v_pk_mul_f32 v[26:27], v[26:27], s[86:87] op_sel:[0,0] op_sel_hi:[1,0]
    v_pk_mul_f32 v[64:65], v[64:65], v[26:27] op_sel:[0,0] op_sel_hi:[1,0]
    v_pk_mul_f32 v[66:67], v[66:67], v[26:27] op_sel:[0,0] op_sel_hi:[1,0]
    v_pk_mul_f32 v[68:69], v[68:69], v[26:27] op_sel:[0,1] op_sel_hi:[1,1]
    v_pk_mul_f32 v[70:71], v[70:71], v[26:27] op_sel:[0,1] op_sel_hi:[1,1]
    v_pk_mul_f32 v[104:105], v[64:65], v[64:65]
    v_pk_mul_f32 v[106:107], v[66:67], v[66:67]
    v_pk_mul_f32 v[108:109], v[68:69], v[68:69]
    v_pk_mul_f32 v[110:111], v[70:71], v[70:71]
    v_pk_fma_f32 v[104:105], v[104:105], s[72:73], s[72:73] op_sel:[0,0,1] op_sel_hi:[1,0,1]
    v_pk_fma_f32 v[106:107], v[106:107], s[72:73], s[72:73] op_sel:[0,0,1] op_sel_hi:[1,0,1]
    v_pk_fma_f32 v[108:109], v[108:109], s[72:73], s[72:73] op_sel:[0,0,1] op_sel_hi:[1,0,1]
    s_add_u32 s5, s68, 0x20000
    buffer_load_dwordx4 v15, s[16:19], s5 offen offset:2048 lds
    v_pk_fma_f32 v[110:111], v[110:111], s[72:73], s[72:73] op_sel:[0,0,1] op_sel_hi:[1,0,1]
    v_pk_mul_f32 v[104:105], v[104:105], v[64:65]
    v_pk_mul_f32 v[106:107], v[106:107], v[66:67]
    v_pk_mul_f32 v[108:109], v[108:109], v[68:69]
    v_pk_mul_f32 v[110:111], v[110:111], v[70:71]
    v_exp_f32 v104, v104
    v_exp_f32 v105, v105
    v_exp_f32 v106, v106
    v_exp_f32 v107, v107
    v_exp_f32 v108, v108
    s_add_u32 s5, s68, 0x20000
    buffer_load_dwordx4 v16, s[16:19], s5 offen offset:3072 lds
    v_exp_f32 v109, v109
    v_exp_f32 v110, v110
    v_exp_f32 v111, v111
    v_pk_add_f32 v[104:105], v[104:105], 1.0 op_sel_hi:[1,0]
    v_pk_add_f32 v[106:107], v[106:107], 1.0 op_sel_hi:[1,0]
    v_pk_add_f32 v[108:109], v[108:109], 1.0 op_sel_hi:[1,0]
    v_pk_add_f32 v[110:111], v[110:111], 1.0 op_sel_hi:[1,0]
    v_rcp_f32 v104, v104
    v_rcp_f32 v105, v105
    ds_read_b128 a[192:195], v8 offset:0
    ds_read_b128 a[200:203], v9 offset:0
    v_rcp_f32 v106, v106
    ds_read_b128 a[208:211], v10 offset:0
    ds_read_b128 a[216:219], v4 offset:0
    v_rcp_f32 v107, v107
    s_add_u32 m0, s89, 32768
    s_waitcnt lgkmcnt(8)
    s_add_u32 s5, s66, 0x20000
    buffer_load_dwordx4 v13, s[16:19], s5 offen offset:0 lds
    v_rcp_f32 v108, v108
    v_rcp_f32 v109, v109
    v_rcp_f32 v110, v110
    v_rcp_f32_e64 v111, v111
    v_pk_mul_f32 v[64:65], v[64:65], v[104:105]
    v_pk_mul_f32 v[66:67], v[66:67], v[106:107]
    v_pk_mul_f32 v[68:69], v[68:69], v[108:109]
    v_pk_mul_f32 v[70:71], v[70:71], v[110:111]
    v_pk_mul_f32 v[26:27], v[26:27], s[86:87] op_sel:[0,1] op_sel_hi:[1,1]
    v_pk_mul_f32 v[72:73], v[72:73], v[26:27] op_sel:[0,0] op_sel_hi:[1,0]
    s_add_u32 s5, s66, 0x20000
    buffer_load_dwordx4 v14, s[16:19], s5 offen offset:1024 lds
    v_pk_mul_f32 v[74:75], v[74:75], v[26:27] op_sel:[0,0] op_sel_hi:[1,0]
    v_pk_mul_f32 v[76:77], v[76:77], v[26:27] op_sel:[0,1] op_sel_hi:[1,1]
    v_pk_mul_f32 v[78:79], v[78:79], v[26:27] op_sel:[0,1] op_sel_hi:[1,1]
    v_pk_mul_f32 v[104:105], v[72:73], v[72:73]
    v_pk_mul_f32 v[106:107], v[74:75], v[74:75]
    v_pk_mul_f32 v[108:109], v[76:77], v[76:77]
    v_pk_mul_f32 v[110:111], v[78:79], v[78:79]
    v_pk_fma_f32 v[104:105], v[104:105], s[72:73], s[72:73] op_sel:[0,0,1] op_sel_hi:[1,0,1]
    v_pk_fma_f32 v[106:107], v[106:107], s[72:73], s[72:73] op_sel:[0,0,1] op_sel_hi:[1,0,1]
    v_pk_fma_f32 v[108:109], v[108:109], s[72:73], s[72:73] op_sel:[0,0,1] op_sel_hi:[1,0,1]
    v_pk_fma_f32 v[110:111], v[110:111], s[72:73], s[72:73] op_sel:[0,0,1] op_sel_hi:[1,0,1]
    v_pk_mul_f32 v[104:105], v[104:105], v[72:73]
    v_pk_mul_f32 v[106:107], v[106:107], v[74:75]
    v_pk_mul_f32 v[108:109], v[108:109], v[76:77]
    s_add_u32 s5, s66, 0x20000
    buffer_load_dwordx4 v15, s[16:19], s5 offen offset:2048 lds
    v_pk_mul_f32 v[110:111], v[110:111], v[78:79]
    v_exp_f32 v104, v104
    v_exp_f32 v105, v105
    v_exp_f32 v106, v106
    v_exp_f32 v107, v107
    v_exp_f32 v108, v108
    v_exp_f32 v109, v109
    v_exp_f32 v110, v110
    s_add_u32 s5, s66, 0x20000
    buffer_load_dwordx4 v16, s[16:19], s5 offen offset:3072 lds
    v_exp_f32 v111, v111
    v_pk_add_f32 v[104:105], v[104:105], 1.0 op_sel_hi:[1,0]
    v_pk_add_f32 v[106:107], v[106:107], 1.0 op_sel_hi:[1,0]
    v_pk_add_f32 v[108:109], v[108:109], 1.0 op_sel_hi:[1,0]
    v_pk_add_f32 v[110:111], v[110:111], 1.0 op_sel_hi:[1,0]
    v_rcp_f32 v104, v104
    v_rcp_f32 v105, v105
    v_rcp_f32 v106, v106
    v_rcp_f32 v107, v107
    s_add_u32 m0, s89, 49152
    s_waitcnt lgkmcnt(4)
    buffer_load_dwordx4 v13, s[16:19], s71 offen offset:0 lds
    v_rcp_f32 v108, v108
    v_rcp_f32 v109, v109
    v_rcp_f32 v110, v110
    v_rcp_f32 v111, v111
    v_pk_mul_f32 v[72:73], v[72:73], v[104:105]
    v_pk_mul_f32 v[74:75], v[74:75], v[106:107]
    v_pk_mul_f32 v[76:77], v[76:77], v[108:109]
    v_pk_mul_f32 v[78:79], v[78:79], v[110:111]
    s_waitcnt vmcnt(9)
L_st_chk:
    v_pk_add_f32 v[80:81], v[80:81], v[84:85]
    v_pk_add_f32 v[82:83], v[82:83], v[86:87]
    v_pk_add_f32 v[88:89], v[88:89], v[92:93]
    v_pk_add_f32 v[90:91], v[90:91], v[94:95]
    v_pk_add_f32 v[80:81], v[80:81], v[88:89]
    v_pk_add_f32 v[82:83], v[82:83], v[90:91]
    s_nop 1
    v_permlane32_swap_b32 v80, v82
    v_permlane32_swap_b32 v81, v83
    v_pk_add_f32 v[80:81], v[80:81], v[82:83]
    s_nop 1
    v_permlane16_swap_b32 v80, v81
    v_add_f32 v80, v80, v81
    v_cmp_u_f32 vcc, v80, v80
    s_cbranch_vccnz L_st_retry
L_st_ok:
    v_mul_f32 v80, 0x3abe82fa, v80
    buffer_load_dwordx4 v14, s[16:19], s71 offen offset:1024 lds
    v_mul_f32 v82, v80, v80
    s_nop 1
    v_sub_f32_dpp v81, v80, v82 row_ror:8 row_mask:0xf bank_mask:0xf
    v_max_f32 v81, 0, v81
    v_add_f32 v81, 0x3727c5ac, v81
    v_rsq_f32_e64 v81, v81
    s_nop 0
    v_mul_f32_e64 v82, -v80, v81
    v_mov_b32_dpp v88, v81 row_newbcast:0 row_mask:0xf bank_mask:0xf
    v_mov_b32_dpp v89, v81 row_newbcast:1 row_mask:0xf bank_mask:0xf
    v_mov_b32_dpp v90, v81 row_newbcast:2 row_mask:0xf bank_mask:0xf
    v_mov_b32_dpp v91, v81 row_newbcast:3 row_mask:0xf bank_mask:0xf
    buffer_load_dwordx4 v15, s[16:19], s71 offen offset:2048 lds
    v_mov_b32_dpp v92, v81 row_newbcast:4 row_mask:0xf bank_mask:0xf
    v_mov_b32_dpp v93, v81 row_newbcast:5 row_mask:0xf bank_mask:0xf
    v_mov_b32_dpp v94, v81 row_newbcast:6 row_mask:0xf bank_mask:0xf
    v_mov_b32_dpp v95, v81 row_newbcast:7 row_mask:0xf bank_mask:0xf
    v_mov_b32_dpp v96, v82 row_newbcast:0 row_mask:0xf bank_mask:0xf
    v_mov_b32_dpp v97, v82 row_newbcast:1 row_mask:0xf bank_mask:0xf
    v_mov_b32_dpp v98, v82 row_newbcast:2 row_mask:0xf bank_mask:0xf
    v_mov_b32_dpp v99, v82 row_newbcast:3 row_mask:0xf bank_mask:0xf
    v_mov_b32_dpp v100, v82 row_newbcast:4 row_mask:0xf bank_mask:0xf
    v_mov_b32_dpp v101, v82 row_newbcast:5 row_mask:0xf bank_mask:0xf
    v_mov_b32_dpp v102, v82 row_newbcast:6 row_mask:0xf bank_mask:0xf
    v_mov_b32_dpp v103, v82 row_newbcast:7 row_mask:0xf bank_mask:0xf
    v_pk_fma_f32 v[32:33], v[32:33], v[88:89], v[96:97]
    v_pk_fma_f32 v[34:35], v[34:35], v[90:91], v[98:99]
    v_pk_fma_f32 v[36:37], v[36:37], v[92:93], v[100:101]
    v_pk_fma_f32 v[38:39], v[38:39], v[94:95], v[102:103]
    v_cvt_pk_bf16_f32 v104, v32, v33
    v_cvt_pk_bf16_f32 v105, v34, v35
    v_cvt_pk_bf16_f32 v106, v36, v37
    v_cvt_pk_bf16_f32 v107, v38, v39
    buffer_store_dwordx4 v[104:107], v21, s[24:27], s77 offen sc1
    v_pk_fma_f32 v[40:41], v[40:41], v[88:89], v[96:97]
    v_pk_fma_f32 v[42:43], v[42:43], v[90:91], v[98:99]
    v_pk_fma_f32 v[44:45], v[44:45], v[92:93], v[100:101]
    v_pk_fma_f32 v[46:47], v[46:47], v[94:95], v[102:103]
    v_cvt_pk_bf16_f32 v108, v40, v41
    v_cvt_pk_bf16_f32 v109, v42, v43
    v_cvt_pk_bf16_f32 v110, v44, v45
    v_cvt_pk_bf16_f32 v111, v46, v47
    buffer_store_dwordx4 v[108:111], v21, s[24:27], s78 offen sc1
    v_pk_fma_f32 v[48:49], v[48:49], v[88:89], v[96:97]
    v_pk_fma_f32 v[50:51], v[50:51], v[90:91], v[98:99]
    v_pk_fma_f32 v[52:53], v[52:53], v[92:93], v[100:101]
    v_pk_fma_f32 v[54:55], v[54:55], v[94:95], v[102:103]
    v_cvt_pk_bf16_f32 v112, v48, v49
    v_cvt_pk_bf16_f32 v113, v50, v51
    v_cvt_pk_bf16_f32 v114, v52, v53
    v_cvt_pk_bf16_f32 v115, v54, v55
    buffer_store_dwordx4 v[112:115], v21, s[24:27], s79 offen sc1
    v_and_b32_e64 v24, 15, v0
    buffer_load_dwordx4 v16, s[16:19], s71 offen offset:3072 lds
    s_lshl_b32 s3, s96, 4
    s_add_u32 s3, s3, 1
    v_add_u32 v24, s3, v24
    v_cvt_f32_u32 v24, v24
    v_mul_f32 v24, 0x3b000000, v24
    s_lshl_b32 s3, s47, 6
    v_lshrrev_b32 v25, 4, v0
    v_lshl_add_u32 v25, v25, 3, s3
    v_cvt_f32_u32 v25, v25
    v_mul_f32 v25, v25, v24
    v_fract_f32 v88, v25
    v_mul_f32 v25, 0x42000000, v24
    v_add_f32 v89, v88, v24
    v_add_f32 v90, v89, v24
    ds_read_b128 a[96:99], v8 offset:16384
    ds_read_b128 a[104:107], v9 offset:16384
    v_add_f32 v91, v90, v24
    v_add_f32 v92, v91, v24
    ds_read_b128 a[112:115], v10 offset:16384
    ds_read_b128 a[120:123], v4 offset:16384
    v_add_f32 v93, v92, v24
    v_add_f32 v94, v93, v24
    ds_read_b128 a[4:7], v8 offset:32768
    ds_read_b128 a[12:15], v9 offset:32768
    v_add_f32 v95, v94, v24
    v_add_f32 v104, v88, v25
    ds_read_b128 a[20:23], v10 offset:32768
    ds_read_b128 a[28:31], v4 offset:32768
    v_add_f32 v105, v89, v25
    v_add_f32 v106, v90, v25
    s_add_u32 m0, s89, 65536
    s_waitcnt lgkmcnt(8)
    s_add_u32 s5, s65, 0x20000
    buffer_load_dwordx4 v13, s[16:19], s5 offen offset:0 lds
    v_add_f32 v107, v91, v25
    v_add_f32 v108, v92, v25
    v_add_f32 v109, v93, v25
    v_add_f32 v110, v94, v25
    v_add_f32 v111, v95, v25
    v_cos_f32 v25, v25
    v_cos_f32 v80, v88
    v_cos_f32 v81, v89
    v_cos_f32 v82, v90
    v_cos_f32 v83, v91
    s_add_u32 s5, s65, 0x20000
    buffer_load_dwordx4 v14, s[16:19], s5 offen offset:1024 lds
    v_cos_f32 v84, v92
    v_cos_f32 v85, v93
    v_cos_f32 v86, v94
    v_cos_f32 v87, v95
    v_add_f32 v25, v25, v25
    v_cvt_pk_bf16_f32 v112, v80, v81
    v_cvt_pk_bf16_f32 v113, v82, v83
    v_cvt_pk_bf16_f32 v114, v84, v85
    v_cvt_pk_bf16_f32 v115, v86, v87
    s_nop 1
    v_mfma_f32_16x16x32_bf16 v[32:35], v[128:131], v[112:115], 0
    s_add_u32 s5, s65, 0x20000
    buffer_load_dwordx4 v15, s[16:19], s5 offen offset:2048 lds
    v_sin_f32 v88, v88
    v_sin_f32 v89, v89
    v_sin_f32 v90, v90
    v_sin_f32 v91, v91
    v_mfma_f32_16x16x32_bf16 v[36:39], v[132:135], v[112:115], 0
    v_sin_f32 v92, v92
    v_sin_f32 v93, v93
    s_add_u32 s5, s65, 0x20000
    buffer_load_dwordx4 v16, s[16:19], s5 offen offset:3072 lds
    v_sin_f32 v94, v94
    v_sin_f32 v95, v95
    v_mfma_f32_16x16x32_bf16 v[48:51], v[192:195], v[112:115], 0
    v_cvt_pk_bf16_f32 v124, v88, v89
    v_cvt_pk_bf16_f32 v125, v90, v91
    v_cvt_pk_bf16_f32 v126, v92, v93
    v_cvt_pk_bf16_f32 v127, v94, v95
    v_mfma_f32_16x16x32_bf16 v[52:55], v[196:199], v[112:115], 0
    s_nop 0
    v_mfma_f32_16x16x32_bf16 v[40:43], v[128:131], v[124:127], 0
    ds_read_b128 a[160:163], v17 offset:0
    ds_read_b128 a[168:171], v18 offset:0
    v_cos_f32 v96, v104
    ds_read_b128 a[176:179], v19 offset:0
    ds_read_b128 a[184:187], v20 offset:0
    v_cos_f32 v97, v105
    s_waitcnt vmcnt(15)
    ds_read_b128 a[132:135], v17 offset:16384
    ds_read_b128 a[140:143], v18 offset:16384
    v_cos_f32 v98, v106
    ds_read_b128 a[148:151], v19 offset:16384
    ds_read_b128 a[156:159], v20 offset:16384
    v_cos_f32 v99, v107
    s_add_u32 m0, s90, 45056
    s_lshl3_add_u32 s5, s56, s98
    buffer_load_dwordx4 v6, s[20:23], s5 offen lds
    v_mfma_f32_16x16x32_bf16 v[44:47], v[132:135], v[124:127], 0
    v_cos_f32 v100, v108
    v_cos_f32 v101, v109
    v_cos_f32 v102, v110
    v_cos_f32 v103, v111
    v_mfma_f32_16x16x32_bf16 v[116:119], v[192:195], v[124:127], 0
    v_cvt_pk_bf16_f32 v112, v96, v97
    v_cvt_pk_bf16_f32 v113, v98, v99
    s_add_u32 m0, s90, 77824
    s_lshl3_add_u32 s5, s56, s98
    s_add_u32 s5, s5, 32768
    buffer_load_dwordx4 v6, s[20:23], s5 offen lds
    v_cvt_pk_bf16_f32 v114, v100, v101
    v_cvt_pk_bf16_f32 v115, v102, v103
    v_mfma_f32_16x16x32_bf16 v[120:123], v[196:199], v[124:127], 0
    s_nop 0
    v_mfma_f32_16x16x32_bf16 v[32:35], v[136:139], v[112:115], v[32:35]
    v_sin_f32 v104, v104
    v_sin_f32 v105, v105
    v_sin_f32_e64 v106, v106
    s_add_u32 m0, s90, 40960
    s_lshl3_add_u32 s5, s74, s98
    buffer_load_dwordx4 v6, s[20:23], s5 offen lds
    v_sin_f32 v107, v107
    v_mfma_f32_16x16x32_bf16 v[36:39], v[140:143], v[112:115], v[36:39]
    v_sin_f32_e64 v108, v108
    v_sin_f32_e64 v109, v109
    v_sin_f32 v110, v110
    v_sin_f32 v111, v111
    v_mfma_f32_16x16x32_bf16 v[48:51], v[200:203], v[112:115], v[48:51]
    s_add_u32 m0, s89, 81920
    s_waitcnt lgkmcnt(12)
    s_add_u32 s5, s70, 0x20000
    buffer_load_dwordx4 v13, s[16:19], s5 offen offset:0 lds
    v_cvt_pk_bf16_f32 v124, v104, v105
    v_cvt_pk_bf16_f32 v125, v106, v107
    v_cvt_pk_bf16_f32 v126, v108, v109
    v_cvt_pk_bf16_f32 v127, v110, v111
    v_mfma_f32_16x16x32_bf16 v[52:55], v[204:207], v[112:115], v[52:55]
    s_nop 0
    v_mfma_f32_16x16x32_bf16 v[40:43], v[136:139], v[124:127], v[40:43]
    v_fma_f32 v80, v25, v96, -v80
    v_fma_f32 v81, v25, v97, -v81
    v_fma_f32 v82, v25, v98, -v82
    v_fma_f32 v83, v25, v99, -v83
    s_add_u32 s5, s70, 0x20000
    buffer_load_dwordx4 v14, s[16:19], s5 offen offset:1024 lds
    v_mfma_f32_16x16x32_bf16 v[44:47], v[140:143], v[124:127], v[44:47]
    v_fma_f32 v84, v25, v100, -v84
    v_fma_f32 v85, v25, v101, -v85
    v_fma_f32 v86, v25, v102, -v86
    v_fma_f32 v87, v25, v103, -v87
    v_mfma_f32_16x16x32_bf16 v[116:119], v[200:203], v[124:127], v[116:119]
    v_cvt_pk_bf16_f32 v112, v80, v81
    v_cvt_pk_bf16_f32 v113, v82, v83
    v_cvt_pk_bf16_f32 v114, v84, v85
    v_cvt_pk_bf16_f32 v115, v86, v87
    v_mfma_f32_16x16x32_bf16 v[120:123], v[204:207], v[124:127], v[120:123]
    s_add_u32 s5, s70, 0x20000
    buffer_load_dwordx4 v15, s[16:19], s5 offen offset:2048 lds
    v_mfma_f32_16x16x32_bf16 v[32:35], v[144:147], v[112:115], v[32:35]
    v_fma_f32 v88, v25, v104, -v88
    v_fma_f32 v89, v25, v105, -v89
    v_fma_f32 v90, v25, v106, -v90
    v_fma_f32 v91, v25, v107, -v91
    v_mfma_f32_16x16x32_bf16 v[36:39], v[148:151], v[112:115], v[36:39]
    v_fma_f32 v92, v25, v108, -v92
    v_fma_f32 v93, v25, v109, -v93
    v_fma_f32 v94, v25, v110, -v94
    v_fma_f32 v95, v25, v111, -v95
    v_mfma_f32_16x16x32_bf16 v[48:51], v[208:211], v[112:115], v[48:51]
    s_add_u32 s5, s70, 0x20000
    buffer_load_dwordx4 v16, s[16:19], s5 offen offset:3072 lds
    v_cvt_pk_bf16_f32 v124, v88, v89
    v_cvt_pk_bf16_f32 v125, v90, v91
    v_cvt_pk_bf16_f32 v126, v92, v93
    v_cvt_pk_bf16_f32 v127, v94, v95
    v_mfma_f32_16x16x32_bf16 v[52:55], v[212:215], v[112:115], v[52:55]
    s_nop 0
    v_mfma_f32_16x16x32_bf16 v[40:43], v[144:147], v[124:127], v[40:43]
    v_fma_f32 v96, v25, v80, -v96
    v_fma_f32 v97, v25, v81, -v97
    v_fma_f32 v98, v25, v82, -v98
    v_fma_f32 v99, v25, v83, -v99
    s_add_u32 m0, s89, 98304
    s_waitcnt lgkmcnt(8)
    s_add_u32 s5, s67, 0x20000
    buffer_load_dwordx4 v13, s[16:19], s5 offen offset:0 lds
    v_mfma_f32_16x16x32_bf16 v[44:47], v[148:151], v[124:127], v[44:47]
    v_fma_f32 v100, v25, v84, -v100
    v_fma_f32 v101, v25, v85, -v101
    v_fma_f32 v102, v25, v86, -v102
    v_fma_f32 v103, v25, v87, -v103
    v_mfma_f32_16x16x32_bf16 v[116:119], v[208:211], v[124:127], v[116:119]
    v_cvt_pk_bf16_f32 v112, v96, v97
    v_cvt_pk_bf16_f32 v113, v98, v99
    v_cvt_pk_bf16_f32 v114, v100, v101
    v_cvt_pk_bf16_f32 v115, v102, v103
    v_mfma_f32_16x16x32_bf16 v[120:123], v[212:215], v[124:127], v[120:123]
    s_add_u32 s5, s67, 0x20000
    buffer_load_dwordx4 v14, s[16:19], s5 offen offset:1024 lds
    v_mfma_f32_16x16x32_bf16 v[32:35], v[152:155], v[112:115], v[32:35]
    v_fma_f32 v104, v25, v88, -v104
    v_fma_f32 v105, v25, v89, -v105
    v_fma_f32 v106, v25, v90, -v106
    v_fma_f32 v107, v25, v91, -v107
    v_mfma_f32_16x16x32_bf16 v[36:39], v[156:159], v[112:115], v[36:39]
    v_fma_f32 v108, v25, v92, -v108
    v_fma_f32 v109, v25, v93, -v109
    v_fma_f32 v110, v25, v94, -v110
    v_fma_f32 v111, v25, v95, -v111
    v_mfma_f32_16x16x32_bf16 v[48:51], v[216:219], v[112:115], v[48:51]
    s_add_u32 s5, s67, 0x20000
    buffer_load_dwordx4 v15, s[16:19], s5 offen offset:2048 lds
    v_cvt_pk_bf16_f32 v124, v104, v105
    v_cvt_pk_bf16_f32 v125, v106, v107
    v_cvt_pk_bf16_f32 v126, v108, v109
    v_cvt_pk_bf16_f32 v127, v110, v111
    v_mfma_f32_16x16x32_bf16 v[52:55], v[220:223], v[112:115], v[52:55]
    s_nop 0
    v_mfma_f32_16x16x32_bf16 v[40:43], v[152:155], v[124:127], v[40:43]
    v_fma_f32 v80, v25, v96, -v80
    v_fma_f32 v81, v25, v97, -v81
    v_fma_f32 v82, v25, v98, -v82
    v_fma_f32 v83, v25, v99, -v83
    s_add_u32 s5, s67, 0x20000
    buffer_load_dwordx4 v16, s[16:19], s5 offen offset:3072 lds
    v_mfma_f32_16x16x32_bf16 v[44:47], v[156:159], v[124:127], v[44:47]
    v_fma_f32 v84, v25, v100, -v84
    v_fma_f32 v85, v25, v101, -v85
    v_fma_f32 v86, v25, v102, -v86
    v_fma_f32 v87, v25, v103, -v87
    v_mfma_f32_16x16x32_bf16 v[116:119], v[216:219], v[124:127], v[116:119]
    v_cvt_pk_bf16_f32 v112, v80, v81
    v_cvt_pk_bf16_f32 v113, v82, v83
    v_cvt_pk_bf16_f32 v114, v84, v85
    v_cvt_pk_bf16_f32 v115, v86, v87
    v_mfma_f32_16x16x32_bf16 v[120:123], v[220:223], v[124:127], v[120:123]
    s_waitcnt vmcnt(22)
    ds_read_b128 a[68:71], v17 offset:32768
    ds_read_b128 a[76:79], v18 offset:32768
    v_mfma_f32_16x16x32_bf16 v[32:35], v[160:163], v[112:115], v[32:35]
    ds_read_b128 a[84:87], v19 offset:32768
    ds_read_b128 a[92:95], v20 offset:32768
    v_fma_f32 v88, v25, v104, -v88
    v_fma_f32 v89, v25, v105, -v89
    s_mov_b32 m0, s89
    s_waitcnt lgkmcnt(8)
    s_add_u32 s5, s69, 0x20000
    buffer_load_dwordx4 v13, s[16:19], s5 offen offset:0 lds
    v_fma_f32 v90, v25, v106, -v90
    v_fma_f32 v91, v25, v107, -v91
    v_mfma_f32_16x16x32_bf16 v[36:39], v[164:167], v[112:115], v[36:39]
    v_fma_f32 v92, v25, v108, -v92
    v_fma_f32 v93, v25, v109, -v93
    v_fma_f32 v94, v25, v110, -v94
    v_fma_f32 v95, v25, v111, -v95
    v_mfma_f32_16x16x32_bf16 v[48:51], v[224:227], v[112:115], v[48:51]
    v_cvt_pk_bf16_f32 v124, v88, v89
    v_cvt_pk_bf16_f32 v125, v90, v91
    v_cvt_pk_bf16_f32 v126, v92, v93
    v_cvt_pk_bf16_f32 v127, v94, v95
    s_add_u32 s5, s69, 0x20000
    buffer_load_dwordx4 v14, s[16:19], s5 offen offset:1024 lds
    v_mfma_f32_16x16x32_bf16 v[52:55], v[228:231], v[112:115], v[52:55]
    v_mfma_f32_16x16x32_bf16 v[40:43], v[160:163], v[124:127], v[40:43]
    v_fma_f32 v96, v25, v80, -v96
    v_fma_f32 v97, v25, v81, -v97
    v_fma_f32 v98, v25, v82, -v98
    v_fma_f32 v99, v25, v83, -v99
    v_mfma_f32_16x16x32_bf16 v[44:47], v[164:167], v[124:127], v[44:47]
    v_fma_f32 v100, v25, v84, -v100
    v_fma_f32 v101, v25, v85, -v101
    s_add_u32 s5, s69, 0x20000
    buffer_load_dwordx4 v15, s[16:19], s5 offen offset:2048 lds
    v_fma_f32 v102, v25, v86, -v102
    v_fma_f32 v103, v25, v87, -v103
    v_mfma_f32_16x16x32_bf16 v[116:119], v[224:227], v[124:127], v[116:119]
    v_cvt_pk_bf16_f32 v112, v96, v97
    v_cvt_pk_bf16_f32 v113, v98, v99
    v_cvt_pk_bf16_f32 v114, v100, v101
    v_cvt_pk_bf16_f32 v115, v102, v103
    v_mfma_f32_16x16x32_bf16 v[120:123], v[228:231], v[124:127], v[120:123]
    s_nop 0
    v_mfma_f32_16x16x32_bf16 v[32:35], v[168:171], v[112:115], v[32:35]
    s_add_u32 s5, s69, 0x20000
    buffer_load_dwordx4 v16, s[16:19], s5 offen offset:3072 lds
    v_fma_f32 v104, v25, v88, -v104
    v_fma_f32 v105, v25, v89, -v105
    v_fma_f32 v106, v25, v90, -v106
    v_fma_f32 v107, v25, v91, -v107
    v_mfma_f32_16x16x32_bf16 v[36:39], v[172:175], v[112:115], v[36:39]
    v_fma_f32 v108, v25, v92, -v108
    v_fma_f32 v109, v25, v93, -v109
    v_fma_f32 v110, v25, v94, -v110
    v_fma_f32 v111, v25, v95, -v111
    v_mfma_f32_16x16x32_bf16 v[48:51], v[232:235], v[112:115], v[48:51]
    v_cvt_pk_bf16_f32 v124, v104, v105
    v_cvt_pk_bf16_f32 v125, v106, v107
    s_add_u32 m0, s89, 16384
    s_waitcnt lgkmcnt(4)
    s_add_u32 s5, s71, 0x20000
    buffer_load_dwordx4 v13, s[16:19], s5 offen offset:0 lds
    v_cvt_pk_bf16_f32 v126, v108, v109
    v_cvt_pk_bf16_f32 v127, v110, v111
    v_mfma_f32_16x16x32_bf16 v[52:55], v[236:239], v[112:115], v[52:55]
    s_nop 0
    v_mfma_f32_16x16x32_bf16 v[40:43], v[168:171], v[124:127], v[40:43]
    v_fma_f32 v80, v25, v96, -v80
    v_fma_f32 v81, v25, v97, -v81
    v_fma_f32 v82, v25, v98, -v82
    v_fma_f32 v83, v25, v99, -v83
    v_mfma_f32_16x16x32_bf16 v[44:47], v[172:175], v[124:127], v[44:47]
    s_add_u32 s5, s71, 0x20000
    buffer_load_dwordx4 v14, s[16:19], s5 offen offset:1024 lds
    v_fma_f32 v84, v25, v100, -v84
    v_fma_f32 v85, v25, v101, -v85
    v_fma_f32 v86, v25, v102, -v86
    v_fma_f32 v87, v25, v103, -v87
    v_mfma_f32_16x16x32_bf16 v[116:119], v[232:235], v[124:127], v[116:119]
    v_cvt_pk_bf16_f32 v112, v80, v81
    v_cvt_pk_bf16_f32 v113, v82, v83
    v_cvt_pk_bf16_f32 v114, v84, v85
    v_cvt_pk_bf16_f32 v115, v86, v87
    v_mfma_f32_16x16x32_bf16 v[120:123], v[236:239], v[124:127], v[120:123]
    s_nop 0
    v_mfma_f32_16x16x32_bf16 v[32:35], v[176:179], v[112:115], v[32:35]
    s_add_u32 s5, s71, 0x20000
    buffer_load_dwordx4 v15, s[16:19], s5 offen offset:2048 lds
    v_fma_f32 v88, v25, v104, -v88
    v_fma_f32 v89, v25, v105, -v89
    v_fma_f32 v90, v25, v106, -v90
    v_fma_f32 v91, v25, v107, -v91
    v_mfma_f32_16x16x32_bf16 v[36:39], v[180:183], v[112:115], v[36:39]
    v_fma_f32 v92, v25, v108, -v92
    v_fma_f32 v93, v25, v109, -v93
    v_fma_f32 v94, v25, v110, -v94
    v_fma_f32 v95, v25, v111, -v95
    v_mfma_f32_16x16x32_bf16 v[48:51], v[240:243], v[112:115], v[48:51]
    v_cvt_pk_bf16_f32 v124, v88, v89
    v_cvt_pk_bf16_f32 v125, v90, v91
    s_add_u32 s5, s71, 0x20000
    buffer_load_dwordx4 v16, s[16:19], s5 offen offset:3072 lds
    v_cvt_pk_bf16_f32 v126, v92, v93
    v_cvt_pk_bf16_f32 v127, v94, v95
    v_mfma_f32_16x16x32_bf16 v[52:55], v[244:247], v[112:115], v[52:55]
    s_nop 0
    v_mfma_f32_16x16x32_bf16 v[40:43], v[176:179], v[124:127], v[40:43]
    v_fma_f32 v96, v25, v80, -v96
    v_fma_f32 v97, v25, v81, -v97
    v_fma_f32 v98, v25, v82, -v98
    v_fma_f32 v99, v25, v83, -v99
    v_mfma_f32_16x16x32_bf16 v[44:47], v[180:183], v[124:127], v[44:47]
    s_add_u32 m0, s90, 49152
    s_lshl3_add_u32 s5, s57, s98
    buffer_load_dwordx4 v6, s[20:23], s5 offen lds
    v_fma_f32 v100, v25, v84, -v100
    v_fma_f32 v101, v25, v85, -v101
    v_fma_f32 v102, v25, v86, -v102
    v_fma_f32 v103, v25, v87, -v103
    v_mfma_f32_16x16x32_bf16 v[116:119], v[240:243], v[124:127], v[116:119]
    v_cvt_pk_bf16_f32 v112, v96, v97
    v_cvt_pk_bf16_f32 v113, v98, v99
    v_cvt_pk_bf16_f32 v114, v100, v101
    v_cvt_pk_bf16_f32 v115, v102, v103
    v_mfma_f32_16x16x32_bf16 v[120:123], v[244:247], v[124:127], v[120:123]
    s_nop 0
    v_mfma_f32_16x16x32_bf16 v[32:35], v[184:187], v[112:115], v[32:35]
    s_add_u32 m0, s90, 53248
    s_lshl3_add_u32 s5, s58, s98
    buffer_load_dwordx4 v6, s[20:23], s5 offen lds
    v_fma_f32 v104, v25, v88, -v104
    v_fma_f32 v105, v25, v89, -v105
    v_fma_f32 v106, v25, v90, -v106
    v_fma_f32 v107, v25, v91, -v107
    v_mfma_f32_16x16x32_bf16 v[36:39], v[188:191], v[112:115], v[36:39]
    v_fma_f32 v108, v25, v92, -v108
    v_fma_f32 v109, v25, v93, -v109
    v_fma_f32 v110, v25, v94, -v110
    v_fma_f32 v111, v25, v95, -v111
    v_mfma_f32_16x16x32_bf16 v[48:51], v[248:251], v[112:115], v[48:51]
    v_cvt_pk_bf16_f32 v124, v104, v105
    v_cvt_pk_bf16_f32 v125, v106, v107
    s_add_u32 m0, s90, 57344
    s_lshl3_add_u32 s5, s59, s98
    buffer_load_dwordx4 v6, s[20:23], s5 offen lds
    v_cvt_pk_bf16_f32 v126, v108, v109
    v_cvt_pk_bf16_f32 v127, v110, v111
    v_mfma_f32_16x16x32_bf16 v[52:55], v[252:255], v[112:115], v[52:55]
    s_nop 0
    v_mfma_f32_16x16x32_bf16 v[40:43], v[184:187], v[124:127], v[40:43]
    v_accvgpr_read_b32 v96, a228
    v_accvgpr_read_b32 v97, a229
    v_accvgpr_read_b32 v98, a230
    v_accvgpr_read_b32 v99, a231
    v_mfma_f32_16x16x32_bf16 v[44:47], v[188:191], v[124:127], v[44:47]
    s_add_u32 m0, s90, 61440
    s_lshl3_add_u32 s5, s60, s98
    buffer_load_dwordx4 v6, s[20:23], s5 offen lds
    v_accvgpr_read_b32 v100, a236
    v_accvgpr_read_b32 v101, a237
    v_accvgpr_read_b32 v102, a238
    v_accvgpr_read_b32 v103, a239
    v_mfma_f32_16x16x32_bf16 v[116:119], v[248:251], v[124:127], v[116:119]
    v_cndmask_b32 v24, -1.0, 1.0, s[92:93]
    v_mfma_f32_16x16x32_bf16 v[120:123], v[252:255], v[124:127], v[120:123]
    v_pk_fma_f32 v[32:33], v[48:49], v[24:25], v[32:33] op_sel_hi:[1,0,1]
    buffer_load_dword v30, v7, s[24:27], s97 offen sc1
    v_pk_fma_f32 v[34:35], v[50:51], v[24:25], v[34:35] op_sel_hi:[1,0,1]
    v_pk_fma_f32 v[36:37], v[52:53], v[24:25], v[36:37] op_sel_hi:[1,0,1]
    v_pk_fma_f32 v[38:39], v[54:55], v[24:25], v[38:39] op_sel_hi:[1,0,1]
    v_pk_mul_f32 v[32:33], v[32:33], v[96:97]
    v_pk_mul_f32 v[34:35], v[34:35], v[98:99]
    v_pk_mul_f32 v[36:37], v[36:37], v[100:101]
    buffer_load_dwordx4 v[128:131], v1, s[24:27], s48 offen offset:0 sc1
    v_pk_mul_f32 v[38:39], v[38:39], v[102:103]
    v_cvt_pk_bf16_f32 v80, v32, v33
    v_cvt_pk_bf16_f32 v81, v34, v35
    v_cvt_pk_bf16_f32 v82, v36, v37
    v_cvt_pk_bf16_f32 v83, v38, v39
    v_pk_fma_f32 v[40:41], v[116:117], v[24:25], v[40:41] op_sel_hi:[1,0,1]
    buffer_load_dwordx4 v[132:135], v1, s[24:27], s48 offen offset:1024 sc1
    v_pk_fma_f32 v[42:43], v[118:119], v[24:25], v[42:43] op_sel_hi:[1,0,1]
    v_pk_fma_f32 v[44:45], v[120:121], v[24:25], v[44:45] op_sel_hi:[1,0,1]
    v_pk_fma_f32 v[46:47], v[122:123], v[24:25], v[46:47] op_sel_hi:[1,0,1]
    v_pk_mul_f32 v[40:41], v[40:41], v[96:97]
    v_pk_mul_f32 v[42:43], v[42:43], v[98:99]
    v_pk_mul_f32 v[44:45], v[44:45], v[100:101]
    buffer_load_dwordx4 v[136:139], v1, s[24:27], s48 offen offset:2048 sc1
    v_pk_mul_f32 v[46:47], v[46:47], v[102:103]
    v_cvt_pk_bf16_f32 v84, v40, v41
    v_cvt_pk_bf16_f32 v85, v42, v43
    v_cvt_pk_bf16_f32 v86, v44, v45
    v_cvt_pk_bf16_f32 v87, v46, v47
    buffer_load_dwordx4 v[140:143], v1, s[24:27], s48 offen offset:3072 sc1
    buffer_load_dwordx4 v[144:147], v1, s[24:27], s49 offen offset:0 sc1
    buffer_load_dwordx4 v[148:151], v1, s[24:27], s49 offen offset:1024 sc1
    buffer_load_dwordx4 v[152:155], v1, s[24:27], s49 offen offset:2048 sc1
    buffer_load_dwordx4 v[156:159], v1, s[24:27], s49 offen offset:3072 sc1
    buffer_load_dwordx4 v[160:163], v1, s[24:27], s50 offen offset:0 sc1
    buffer_store_dwordx4 v[80:83], v23, s[24:27], s83 offen offset:0 sc1
    buffer_store_dwordx4 v[84:87], v23, s[24:27], s83 offen offset:1024 sc1
    s_add_u32 m0, s90, 65536
    s_lshl3_add_u32 s5, s61, s98
    buffer_load_dwordx4 v6, s[20:23], s5 offen lds
    s_waitcnt vmcnt(40)
    ds_read_b128 a[224:227], v17 offset:49152
    ds_read_b128 a[232:235], v18 offset:49152
    ds_read_b128 a[240:243], v19 offset:49152
    ds_read_b128 a[248:251], v20 offset:49152
    s_waitcnt vmcnt(36)
    ds_read_b128 a[36:39], v8 offset:0
    ds_read_b128 a[44:47], v9 offset:0
    ds_read_b128 a[52:55], v10 offset:0
    ds_read_b128 a[60:63], v4 offset:0
    s_waitcnt vmcnt(29)
    ds_read_b128 a[196:199], v8 offset:16384
    ds_read_b128 a[204:207], v9 offset:16384
    ds_read_b128 a[212:215], v10 offset:16384
    ds_read_b128 a[220:223], v4 offset:16384
    s_waitcnt vmcnt(25)
    ds_read_b128 a[100:103], v8 offset:32768
    ds_read_b128 a[108:111], v9 offset:32768
    ds_read_b128 a[116:119], v10 offset:32768
    ds_read_b128 a[124:127], v4 offset:32768
    s_waitcnt vmcnt(21)
    ds_read_b128 a[164:167], v17 offset:0
    ds_read_b128 a[172:175], v18 offset:0
    ds_read_b128 a[180:183], v19 offset:0
    ds_read_b128 a[188:191], v20 offset:0
    s_waitcnt vmcnt(17)
    ds_read_b128 a[228:231], v17 offset:16384
    ds_read_b128 a[236:239], v18 offset:16384
    ds_read_b128 a[244:247], v19 offset:16384
    ds_read_b128 a[252:255], v20 offset:16384
    s_waitcnt vmcnt(12)
L_pr_chk:
    v_cmp_eq_u32 vcc, -1, v30
    s_cbranch_vccnz L_pr_retry
L_pr_ok:
    s_cmp_eq_u32 s46, 2
    s_cbranch_scc1 L_pathB
    s_waitcnt lgkmcnt(0)
    s_waitcnt vmcnt(11)
    v_mfma_f32_32x32x16_bf16 v[224:239], v[128:131], a[0:3], 0
    buffer_load_dwordx4 v[164:167], v1, s[24:27], s50 offen offset:1024 sc1
    v_add_u32 v2, 0x20000, v1
    v_add_u32 v3, 0x40000, v1
    v_mfma_f32_32x32x16_bf16 v[240:255], v[128:131], a[4:7], 0
    s_lshl_b32 s3, s42, 13
    s_waitcnt vmcnt(11)
    v_max_u32 v26, v128, v132
    v_mfma_f32_32x32x16_bf16 v[224:239], v[132:135], a[8:11], v[224:239]
    buffer_load_dwordx4 v[128:131], v1, s[24:27], s50 offen offset:2048 sc1
    s_add_u32 s3, s3, 32768
    v_mfma_f32_32x32x16_bf16 v[240:255], v[132:135], a[12:15], v[240:255]
    v_add_u32 v4, s3, v1
    s_waitcnt vmcnt(11)
    v_mfma_f32_32x32x16_bf16 v[224:239], v[136:139], a[16:19], v[224:239]
    buffer_load_dwordx4 v[132:135], v1, s[24:27], s50 offen offset:3072 sc1
    s_lshl_b32 s3, s42, 11
    v_mfma_f32_32x32x16_bf16 v[240:255], v[136:139], a[20:23], v[240:255]
    s_add_u32 s3, s3, 32768
    v_lshrrev_b32 v40, 4, v0
    s_waitcnt vmcnt(11)
    v_max3_u32 v26, v136, v140, v26
    v_mfma_f32_32x32x16_bf16 v[224:239], v[140:143], a[24:27], v[224:239]
    buffer_load_dwordx4 v[136:139], v1, s[24:27], s51 offen offset:0 sc1
    v_lshl_add_u32 v40, v40, 8, s3
    v_mfma_f32_32x32x16_bf16 v[240:255], v[140:143], a[28:31], v[240:255]
    v_add_u32 v5, v40, v1
    s_waitcnt vmcnt(11)
    v_mfma_f32_32x32x16_bf16 v[224:239], v[144:147], a[32:35], v[224:239]
    buffer_load_dwordx4 v[140:143], v1, s[24:27], s51 offen offset:1024 sc1
    v_and_b32 v40, 12, v0
    v_mfma_f32_32x32x16_bf16 v[240:255], v[144:147], a[36:39], v[240:255]
    v_and_b32 v41, 15, v0
    s_waitcnt vmcnt(11)
    v_max3_u32 v26, v144, v148, v26
    v_mfma_f32_32x32x16_bf16 v[224:239], v[148:151], a[40:43], v[224:239]
    buffer_load_dwordx4 v[144:147], v1, s[24:27], s51 offen offset:2048 sc1
    v_add_u32 v40, v40, v41
    v_mfma_f32_32x32x16_bf16 v[240:255], v[148:151], a[44:47], v[240:255]
    s_lshl_b32 s3, s43, 5
    s_lshl_b32 s7, s44, 2
    s_waitcnt vmcnt(11)
    v_mfma_f32_32x32x16_bf16 v[224:239], v[152:155], a[48:51], v[224:239]
    buffer_load_dwordx4 v[148:151], v1, s[24:27], s51 offen offset:3072 sc1
    s_add_u32 s3, s3, s7
    v_mfma_f32_32x32x16_bf16 v[240:255], v[152:155], a[52:55], v[240:255]
    v_add_u32 v40, s3, v40
    s_waitcnt vmcnt(11)
    v_max3_u32 v26, v152, v156, v26
    v_mfma_f32_32x32x16_bf16 v[224:239], v[156:159], a[56:59], v[224:239]
    buffer_load_dwordx4 v[152:155], v1, s[24:27], s52 offen offset:0 sc1
    v_lshrrev_b32 v41, 4, v0
    v_mfma_f32_32x32x16_bf16 v[240:255], v[156:159], a[60:63], v[240:255]
    v_lshlrev_b32 v42, 10, v40
    s_waitcnt vmcnt(11)
    v_mfma_f32_32x32x16_bf16 v[224:239], v[160:163], a[64:67], v[224:239]
    buffer_load_dwordx4 v[156:159], v1, s[24:27], s52 offen offset:1024 sc1
    v_and_b32 v43, 1, v41
    v_lshl_add_u32 v42, v43, 5, v42
    v_mfma_f32_32x32x16_bf16 v[240:255], v[160:163], a[68:71], v[240:255]
    v_lshrrev_b32 v44, 1, v41
    s_waitcnt vmcnt(8)
    v_max3_u32 v26, v160, v164, v26
    v_mfma_f32_32x32x16_bf16 v[224:239], v[164:167], a[72:75], v[224:239]
    buffer_load_dwordx4 v[160:163], v1, s[24:27], s52 offen offset:2048 sc1
    v_lshl_add_u32 v9, v44, 4, v42
    v_mfma_f32_32x32x16_bf16 v[240:255], v[164:167], a[76:79], v[240:255]
    s_lshl_b32 s64, s40, 16
    s_waitcnt vmcnt(8)
    v_mfma_f32_32x32x16_bf16 v[224:239], v[128:131], a[80:83], v[224:239]
    buffer_load_dwordx4 v[164:167], v1, s[24:27], s52 offen offset:3072 sc1
    s_barrier
    v_mov_b32 v24, 3
    v_mov_b32 v25, 9240576
    buffer_store_byte v24, v25, s[24:27], s4 offen sc1
    s_add_u32 s64, s64, s98
    v_mfma_f32_32x32x16_bf16 v[240:255], v[128:131], a[84:87], v[240:255]
    s_mul_i32 s65, s40, 90112
    s_waitcnt vmcnt(9)
    v_max3_u32 v26, v128, v132, v26
    v_mfma_f32_32x32x16_bf16 v[224:239], v[132:135], a[88:91], v[224:239]
    buffer_load_dwordx4 v[128:131], v1, s[24:27], s53 offen offset:0 sc1
    s_lshl_b32 s3, s42, 10
    s_add_u32 s65, s65, s3
    v_mfma_f32_32x32x16_bf16 v[240:255], v[132:135], a[92:95], v[240:255]
    s_add_u32 s65, s65, 2883584
    s_waitcnt vmcnt(9)
    v_mfma_f32_32x32x16_bf16 v[224:239], v[136:139], a[96:99], v[224:239]
    buffer_load_dwordx4 v[132:135], v1, s[24:27], s53 offen offset:1024 sc1
    s_add_u32 s79, s65, 4096
    v_mfma_f32_32x32x16_bf16 v[240:255], v[136:139], a[100:103], v[240:255]
    s_lshl_b32 s3, s41, 4
    s_waitcnt vmcnt(9)
    v_max3_u32 v26, v136, v140, v26
    v_mfma_f32_32x32x16_bf16 v[224:239], v[140:143], a[104:107], v[224:239]
    buffer_load_dwordx4 v[136:139], v1, s[24:27], s53 offen offset:2048 sc1
    s_sub_u32 s7, 124, s3
    v_mfma_f32_32x32x16_bf16 v[240:255], v[140:143], a[108:111], v[240:255]
    s_cmp_ge_u32 s41, 4
    s_cselect_b32 s3, s7, s3
    s_cselect_b32 s7, -1, 0
    s_cselect_b32 s68, 0, 0xffffc000
    s_waitcnt vmcnt(9)
    v_mfma_f32_32x32x16_bf16 v[224:239], v[144:147], a[112:115], v[224:239]
    buffer_load_dwordx4 v[140:143], v1, s[24:27], s53 offen offset:3072 sc1
    s_xor_b32 s67, s7, 0x10000
    s_sub_u32 s67, s67, s7
    v_mfma_f32_32x32x16_bf16 v[240:255], v[144:147], a[116:119], v[240:255]
    s_lshl_b32 s3, s3, 14
    s_waitcnt vmcnt(9)
    v_max3_u32 v26, v144, v148, v26
    v_mfma_f32_32x32x16_bf16 v[224:239], v[148:151], a[120:123], v[224:239]
    buffer_load_dwordx4 v[144:147], v1, s[24:27], s54 offen offset:0 sc1
    s_add_u32 s66, s3, 7864320
    v_mfma_f32_32x32x16_bf16 v[240:255], v[148:151], a[124:127], v[240:255]
    s_lshl_b32 s3, s40, 6
    s_waitcnt vmcnt(9)
    v_mfma_f32_32x32x16_bf16 v[224:239], v[152:155], a[128:131], v[224:239]
    buffer_load_dwordx4 v[148:151], v1, s[24:27], s54 offen offset:1024 sc1
    v_add_u32 v40, s3, v40
    v_mfma_f32_32x32x16_bf16 v[240:255], v[152:155], a[132:135], v[240:255]
    v_xor_b32 v40, s7, v40
    v_subrev_u32 v40, s7, v40
    s_waitcnt vmcnt(9)
    v_max3_u32 v26, v152, v156, v26
    v_mfma_f32_32x32x16_bf16 v[224:239], v[156:159], a[136:139], v[224:239]
    buffer_load_dwordx4 v[152:155], v1, s[24:27], s54 offen offset:2048 sc1
    v_and_b32 v40, 0x7ff, v40
    v_mfma_f32_32x32x16_bf16 v[240:255], v[156:159], a[140:143], v[240:255]
    v_xor_b32 v42, s7, v41
    s_waitcnt vmcnt(9)
    v_mfma_f32_32x32x16_bf16 v[224:239], v[160:163], a[144:147], v[224:239]
    buffer_load_dwordx4 v[156:159], v1, s[24:27], s54 offen offset:3072 sc1
    v_and_b32 v42, 3, v42
    v_mfma_f32_32x32x16_bf16 v[240:255], v[160:163], a[148:151], v[240:255]
    v_lshlrev_b32 v42, 14, v42
    s_waitcnt vmcnt(9)
    v_max3_u32 v26, v160, v164, v26
    v_mfma_f32_32x32x16_bf16 v[224:239], v[164:167], a[152:155], v[224:239]
    buffer_load_dwordx4 v[160:163], v1, s[24:27], s55 offen offset:0 sc1
    v_lshrrev_b32 v44, 6, v40
    v_mfma_f32_32x32x16_bf16 v[240:255], v[164:167], a[156:159], v[240:255]
    v_lshl_add_u32 v42, v44, 9, v42
    v_and_b32 v44, 3, v40
    s_waitcnt vmcnt(8)
    v_mfma_f32_32x32x16_bf16 v[224:239], v[128:131], a[160:163], v[224:239]
    buffer_load_dwordx4 v[164:167], v1, s[24:27], s55 offen offset:1024 sc1
    v_lshl_add_u32 v42, v44, 3, v42
    v_mfma_f32_32x32x16_bf16 v[240:255], v[128:131], a[164:167], v[240:255]
    v_bfe_u32 v44, v40, 2, 1
    s_waitcnt vmcnt(8)
    v_max3_u32 v26, v128, v132, v26
    v_mfma_f32_32x32x16_bf16 v[224:239], v[132:135], a[168:171], v[224:239]
    buffer_load_dwordx4 v[128:131], v1, s[24:27], s55 offen offset:2048 sc1
    v_lshl_add_u32 v42, v44, 7, v42
    v_mfma_f32_32x32x16_bf16 v[240:255], v[132:135], a[172:175], v[240:255]
    v_bfe_u32 v44, v40, 3, 2
    s_waitcnt vmcnt(8)
    v_mfma_f32_32x32x16_bf16 v[224:239], v[136:139], a[176:179], v[224:239]
    buffer_load_dwordx4 v[132:135], v1, s[24:27], s55 offen offset:3072 sc1
    v_lshl_add_u32 v42, v44, 5, v42
    v_mfma_f32_32x32x16_bf16 v[240:255], v[136:139], a[180:183], v[240:255]
    v_bfe_u32 v44, v40, 5, 1
    v_lshl_add_u32 v10, v44, 8, v42
    s_waitcnt vmcnt(8)
    v_max3_u32 v26, v136, v140, v26
    v_mfma_f32_32x32x16_bf16 v[224:239], v[140:143], a[184:187], v[224:239]
    buffer_load_dwordx4 v[136:139], v2, s[24:27], s48 offen offset:0 sc1
    v_bfe_u32 v40, v0, 2, 2
    v_mfma_f32_32x32x16_bf16 v[240:255], v[140:143], a[188:191], v[240:255]
    v_lshl_add_u32 v42, v41, 3, v40
    s_waitcnt vmcnt(8)
    v_mfma_f32_32x32x16_bf16 v[224:239], v[144:147], a[192:195], v[224:239]
    buffer_load_dwordx4 v[140:143], v2, s[24:27], s48 offen offset:1024 sc1
    v_lshlrev_b32 v42, 7, v42
    v_mfma_f32_32x32x16_bf16 v[240:255], v[144:147], a[196:199], v[240:255]
    v_lshrrev_b32 v44, 1, v40
    s_waitcnt vmcnt(8)
    v_max3_u32 v26, v144, v148, v26
    v_mfma_f32_32x32x16_bf16 v[224:239], v[148:151], a[200:203], v[224:239]
    buffer_load_dwordx4 v[144:147], v2, s[24:27], s48 offen offset:2048 sc1
    v_lshl_add_u32 v44, v43, 1, v44
    v_lshl_add_u32 v42, v44, 5, v42
    v_mfma_f32_32x32x16_bf16 v[240:255], v[148:151], a[204:207], v[240:255]
    v_and_b32 v44, 3, v0
    s_waitcnt vmcnt(8)
    v_mfma_f32_32x32x16_bf16 v[224:239], v[152:155], a[208:211], v[224:239]
    buffer_load_dwordx4 v[148:151], v2, s[24:27], s48 offen offset:3072 sc1
    v_lshl_add_u32 v42, v44, 3, v42
    v_mfma_f32_32x32x16_bf16 v[240:255], v[152:155], a[212:215], v[240:255]
    v_add_u32 v13, 114688, v42
    s_waitcnt vmcnt(8)
    v_max3_u32 v26, v152, v156, v26
    v_mfma_f32_32x32x16_bf16 v[224:239], v[156:159], a[216:219], v[224:239]
    buffer_load_dwordx4 v[152:155], v2, s[24:27], s49 offen offset:0 sc1
    v_xor_b32 v14, 32, v13
    v_mfma_f32_32x32x16_bf16 v[240:255], v[156:159], a[220:223], v[240:255]
    v_xor_b32 v15, 64, v13
    s_waitcnt vmcnt(8)
    v_mfma_f32_32x32x16_bf16 v[224:239], v[160:163], a[224:227], v[224:239]
    buffer_load_dwordx4 v[156:159], v2, s[24:27], s49 offen offset:1024 sc1
    v_xor_b32 v16, 0x60, v13
    s_and_b32 s70, s7, 0x04040000
    v_mfma_f32_32x32x16_bf16 v[240:255], v[160:163], a[228:231], v[240:255]
    s_xor_b32 s70, s70, 0x01000c0c
    s_waitcnt vmcnt(8)
    v_max3_u32 v26, v160, v164, v26
    v_mfma_f32_32x32x16_bf16 v[224:239], v[164:167], a[232:235], v[224:239]
    buffer_load_dwordx4 v[160:163], v2, s[24:27], s49 offen offset:2048 sc1
    s_xor_b32 s71, s70, 0x04040000
    v_mfma_f32_32x32x16_bf16 v[240:255], v[164:167], a[236:239], v[240:255]
    s_cmp_eq_u32 s41, 0
    s_cselect_b32 s3, 16, 0
    s_waitcnt vmcnt(8)
    v_mfma_f32_32x32x16_bf16 v[224:239], v[128:131], a[240:243], v[224:239]
    buffer_load_dwordx4 v[164:167], v2, s[24:27], s49 offen offset:3072 sc1
    v_mov_b32 v11, 1073741824
    v_mfma_f32_32x32x16_bf16 v[240:255], v[128:131], a[244:247], v[240:255]
    v_cmp_le_u32 vcc, s3, v0
    s_nop 1
    v_cndmask_b32 v11, v11, v10, vcc
    s_waitcnt vmcnt(8)
    v_max3_u32 v26, v128, v132, v26
    v_mfma_f32_32x32x16_bf16 v[224:239], v[132:135], a[248:251], v[224:239]
    buffer_load_dwordx4 v[128:131], v2, s[24:27], s50 offen offset:0 sc1
    v_mfma_f32_32x32x16_bf16 v[240:255], v[132:135], a[252:255], v[240:255]
    v_cmp_eq_u32 vcc, -1, v26
    s_cbranch_vccnz L_slowA0
L_retA0:
    s_waitcnt vmcnt(8)
    v_mfma_f32_32x32x16_bf16 v[192:207], v[136:139], a[0:3], 0
    buffer_load_dwordx4 v[132:135], v2, s[24:27], s50 offen offset:1024 sc1
    v_mfma_f32_32x32x16_bf16 v[208:223], v[136:139], a[4:7], 0
    s_waitcnt vmcnt(8)
    v_max_u32 v27, v136, v140
    v_mfma_f32_32x32x16_bf16 v[192:207], v[140:143], a[8:11], v[192:207]
    buffer_load_dwordx4 v[136:139], v2, s[24:27], s50 offen offset:2048 sc1
    ds_write_b128 v4, v[224:227] offset:0
    v_mfma_f32_32x32x16_bf16 v[208:223], v[140:143], a[12:15], v[208:223]
    ds_write_b128 v4, v[228:231] offset:1024
    s_waitcnt vmcnt(8)
    v_mfma_f32_32x32x16_bf16 v[192:207], v[144:147], a[16:19], v[192:207]
    buffer_load_dwordx4 v[140:143], v2, s[24:27], s50 offen offset:3072 sc1
    ds_write_b128 v4, v[232:235] offset:2048
    v_mfma_f32_32x32x16_bf16 v[208:223], v[144:147], a[20:23], v[208:223]
    ds_write_b128 v4, v[236:239] offset:3072
    s_waitcnt vmcnt(8)
    v_max3_u32 v27, v144, v148, v27
    v_mfma_f32_32x32x16_bf16 v[192:207], v[148:151], a[24:27], v[192:207]
    buffer_load_dwordx4 v[144:147], v2, s[24:27], s51 offen offset:0 sc1
    ds_write_b128 v4, v[240:243] offset:4096
    v_mfma_f32_32x32x16_bf16 v[208:223], v[148:151], a[28:31], v[208:223]
    ds_write_b128 v4, v[244:247] offset:5120
    s_waitcnt vmcnt(8)
    v_mfma_f32_32x32x16_bf16 v[192:207], v[152:155], a[32:35], v[192:207]
    buffer_load_dwordx4 v[148:151], v2, s[24:27], s51 offen offset:1024 sc1
    ds_write_b128 v4, v[248:251] offset:6144
    v_mfma_f32_32x32x16_bf16 v[208:223], v[152:155], a[36:39], v[208:223]
    ds_write_b128 v4, v[252:255] offset:7168
    s_waitcnt vmcnt(8)
    v_max3_u32 v27, v152, v156, v27
    v_mfma_f32_32x32x16_bf16 v[192:207], v[156:159], a[40:43], v[192:207]
    buffer_load_dwordx4 v[152:155], v2, s[24:27], s51 offen offset:2048 sc1
    v_mfma_f32_32x32x16_bf16 v[208:223], v[156:159], a[44:47], v[208:223]
    s_waitcnt vmcnt(8)
    v_mfma_f32_32x32x16_bf16 v[192:207], v[160:163], a[48:51], v[192:207]
    buffer_load_dwordx4 v[156:159], v2, s[24:27], s51 offen offset:3072 sc1
    v_mfma_f32_32x32x16_bf16 v[208:223], v[160:163], a[52:55], v[208:223]
    s_waitcnt vmcnt(8)
    v_max3_u32 v27, v160, v164, v27
    v_mfma_f32_32x32x16_bf16 v[192:207], v[164:167], a[56:59], v[192:207]
    buffer_load_dwordx4 v[160:163], v2, s[24:27], s52 offen offset:0 sc1
    s_waitcnt lgkmcnt(0)
    s_barrier
    ds_read_b128 v[80:83], v5 offset:0
    v_mfma_f32_32x32x16_bf16 v[208:223], v[164:167], a[60:63], v[208:223]
    ds_read_b128 v[84:87], v5 offset:256
    s_waitcnt vmcnt(8)
    v_mfma_f32_32x32x16_bf16 v[192:207], v[128:131], a[64:67], v[192:207]
    buffer_load_dwordx4 v[164:167], v2, s[24:27], s52 offen offset:1024 sc1
    ds_read_b128 v[88:91], v5 offset:8192
    v_mfma_f32_32x32x16_bf16 v[208:223], v[128:131], a[68:71], v[208:223]
    ds_read_b128 v[92:95], v5 offset:8448
    s_waitcnt vmcnt(8)
    v_max3_u32 v27, v128, v132, v27
    v_mfma_f32_32x32x16_bf16 v[192:207], v[132:135], a[72:75], v[192:207]
    buffer_load_dwordx4 v[128:131], v2, s[24:27], s52 offen offset:2048 sc1
    ds_read_b128 v[96:99], v5 offset:16384
    v_mfma_f32_32x32x16_bf16 v[208:223], v[132:135], a[76:79], v[208:223]
    ds_read_b128 v[100:103], v5 offset:16640
    s_waitcnt vmcnt(8)
    v_mfma_f32_32x32x16_bf16 v[192:207], v[136:139], a[80:83], v[192:207]
    buffer_load_dwordx4 v[132:135], v2, s[24:27], s52 offen offset:3072 sc1
    ds_read_b128 v[104:107], v5 offset:24576
    v_mfma_f32_32x32x16_bf16 v[208:223], v[136:139], a[84:87], v[208:223]
    ds_read_b128 v[108:111], v5 offset:24832
    s_waitcnt vmcnt(8)
    v_max3_u32 v27, v136, v140, v27
    v_mfma_f32_32x32x16_bf16 v[192:207], v[140:143], a[88:91], v[192:207]
    buffer_load_dwordx4 v[136:139], v2, s[24:27], s53 offen offset:0 sc1
    s_waitcnt lgkmcnt(4)
    v_add_f32 v80, v80, v88
    v_mfma_f32_32x32x16_bf16 v[208:223], v[140:143], a[92:95], v[208:223]
    v_add_f32 v81, v81, v89
    v_add_f32 v82, v82, v90
    s_waitcnt vmcnt(8)
    v_mfma_f32_32x32x16_bf16 v[192:207], v[144:147], a[96:99], v[192:207]
    buffer_load_dwordx4 v[140:143], v2, s[24:27], s53 offen offset:1024 sc1
    v_add_f32 v83, v83, v91
    v_add_f32 v84, v84, v92
    v_mfma_f32_32x32x16_bf16 v[208:223], v[144:147], a[100:103], v[208:223]
    v_add_f32 v85, v85, v93
    v_add_f32 v86, v86, v94
    s_waitcnt vmcnt(8)
    v_max3_u32 v27, v144, v148, v27
    v_mfma_f32_32x32x16_bf16 v[192:207], v[148:151], a[104:107], v[192:207]
    buffer_load_dwordx4 v[144:147], v2, s[24:27], s53 offen offset:2048 sc1
    v_add_f32 v87, v87, v95
    v_add_f32 v80, v80, v28
    v_mfma_f32_32x32x16_bf16 v[208:223], v[148:151], a[108:111], v[208:223]
    v_add_f32 v81, v81, v28
    v_add_f32 v82, v82, v28
    s_waitcnt vmcnt(8)
    v_mfma_f32_32x32x16_bf16 v[192:207], v[152:155], a[112:115], v[192:207]
    buffer_load_dwordx4 v[148:151], v2, s[24:27], s53 offen offset:3072 sc1
    v_add_f32 v83, v83, v28
    v_add_f32 v84, v84, v29
    v_mfma_f32_32x32x16_bf16 v[208:223], v[152:155], a[116:119], v[208:223]
    v_add_f32 v85, v85, v29
    v_add_f32 v86, v86, v29
    s_waitcnt vmcnt(8)
    v_max3_u32 v27, v152, v156, v27
    v_mfma_f32_32x32x16_bf16 v[192:207], v[156:159], a[120:123], v[192:207]
    buffer_load_dwordx4 v[152:155], v2, s[24:27], s54 offen offset:0 sc1
    v_add_f32 v87, v87, v29
    s_waitcnt lgkmcnt(0)
    v_mfma_f32_32x32x16_bf16 v[208:223], v[156:159], a[124:127], v[208:223]
    v_add_f32 v96, v96, v104
    v_add_f32 v97, v97, v105
    s_waitcnt vmcnt(8)
    v_mfma_f32_32x32x16_bf16 v[192:207], v[160:163], a[128:131], v[192:207]
    buffer_load_dwordx4 v[156:159], v2, s[24:27], s54 offen offset:1024 sc1
    v_add_f32 v98, v98, v106
    v_add_f32 v99, v99, v107
    v_mfma_f32_32x32x16_bf16 v[208:223], v[160:163], a[132:135], v[208:223]
    v_add_f32 v100, v100, v108
    v_add_f32 v101, v101, v109
    s_waitcnt vmcnt(8)
    v_max3_u32 v27, v160, v164, v27
    v_mfma_f32_32x32x16_bf16 v[192:207], v[164:167], a[136:139], v[192:207]
    buffer_load_dwordx4 v[160:163], v2, s[24:27], s54 offen offset:2048 sc1
    v_add_f32 v102, v102, v110
    v_add_f32 v103, v103, v111
    v_mfma_f32_32x32x16_bf16 v[208:223], v[164:167], a[140:143], v[208:223]
    v_add_f32 v80, v80, v96
    v_add_f32 v81, v81, v97
    s_waitcnt vmcnt(8)
    v_mfma_f32_32x32x16_bf16 v[192:207], v[128:131], a[144:147], v[192:207]
    buffer_load_dwordx4 v[164:167], v2, s[24:27], s54 offen offset:3072 sc1
    v_add_f32 v82, v82, v98
    v_add_f32 v83, v83, v99
    v_mfma_f32_32x32x16_bf16 v[208:223], v[128:131], a[148:151], v[208:223]
    v_add_f32 v84, v84, v100
    v_add_f32 v85, v85, v101
    s_waitcnt vmcnt(8)
    v_max3_u32 v27, v128, v132, v27
    v_mfma_f32_32x32x16_bf16 v[192:207], v[132:135], a[152:155], v[192:207]
    buffer_load_dwordx4 v[128:131], v2, s[24:27], s55 offen offset:0 sc1
    v_add_f32 v86, v86, v102
    v_add_f32 v87, v87, v103
    v_mfma_f32_32x32x16_bf16 v[208:223], v[132:135], a[156:159], v[208:223]
    v_mul_f32 v80, v80, v56
    v_mul_f32 v81, v81, v57
    s_waitcnt vmcnt(8)
    v_mfma_f32_32x32x16_bf16 v[192:207], v[136:139], a[160:163], v[192:207]
    buffer_load_dwordx4 v[132:135], v2, s[24:27], s55 offen offset:1024 sc1
    v_mul_f32 v82, v82, v58
    v_mul_f32 v83, v83, v59
    v_mfma_f32_32x32x16_bf16 v[208:223], v[136:139], a[164:167], v[208:223]
    v_mul_f32 v84, v84, v60
    v_mul_f32 v85, v85, v61
    s_waitcnt vmcnt(8)
    v_max3_u32 v27, v136, v140, v27
    v_mfma_f32_32x32x16_bf16 v[192:207], v[140:143], a[168:171], v[192:207]
    buffer_load_dwordx4 v[136:139], v2, s[24:27], s55 offen offset:2048 sc1
    v_mul_f32 v86, v86, v62
    v_mul_f32 v87, v87, v63
    v_mfma_f32_32x32x16_bf16 v[208:223], v[140:143], a[172:175], v[208:223]
    v_cvt_pk_bf16_f32 v112, v80, v81
    v_cvt_pk_bf16_f32 v113, v82, v83
    s_waitcnt vmcnt(8)
    v_mfma_f32_32x32x16_bf16 v[192:207], v[144:147], a[176:179], v[192:207]
    buffer_load_dwordx4 v[140:143], v2, s[24:27], s55 offen offset:3072 sc1
    v_cvt_pk_bf16_f32 v114, v84, v85
    v_cvt_pk_bf16_f32 v115, v86, v87
    v_mfma_f32_32x32x16_bf16 v[208:223], v[144:147], a[180:183], v[208:223]
    v_permlane16_swap_b32 v112, v114
    v_permlane16_swap_b32 v113, v115
    s_waitcnt vmcnt(8)
    v_max3_u32 v27, v144, v148, v27
    v_mfma_f32_32x32x16_bf16 v[192:207], v[148:151], a[184:187], v[192:207]
    buffer_load_dwordx4 v[144:147], v3, s[24:27], s48 offen offset:0 sc1
    buffer_store_dwordx4 v[112:115], v22, s[24:27], s80 offen sc1
    v_mfma_f32_32x32x16_bf16 v[208:223], v[148:151], a[188:191], v[208:223]
    s_waitcnt vmcnt(9)
    v_mfma_f32_32x32x16_bf16 v[192:207], v[152:155], a[192:195], v[192:207]
    buffer_load_dwordx4 v[148:151], v3, s[24:27], s48 offen offset:1024 sc1
    v_mfma_f32_32x32x16_bf16 v[208:223], v[152:155], a[196:199], v[208:223]
    s_waitcnt vmcnt(9)
    v_max3_u32 v27, v152, v156, v27
    v_mfma_f32_32x32x16_bf16 v[192:207], v[156:159], a[200:203], v[192:207]
    buffer_load_dwordx4 v[152:155], v3, s[24:27], s48 offen offset:2048 sc1
    v_mfma_f32_32x32x16_bf16 v[208:223], v[156:159], a[204:207], v[208:223]
    s_waitcnt vmcnt(9)
    v_mfma_f32_32x32x16_bf16 v[192:207], v[160:163], a[208:211], v[192:207]
    buffer_load_dwordx4 v[156:159], v3, s[24:27], s48 offen offset:3072 sc1
    v_mfma_f32_32x32x16_bf16 v[208:223], v[160:163], a[212:215], v[208:223]
    s_waitcnt vmcnt(9)
    v_max3_u32 v27, v160, v164, v27
    v_mfma_f32_32x32x16_bf16 v[192:207], v[164:167], a[216:219], v[192:207]
    buffer_load_dwordx4 v[160:163], v3, s[24:27], s49 offen offset:0 sc1
    v_mfma_f32_32x32x16_bf16 v[208:223], v[164:167], a[220:223], v[208:223]
    s_waitcnt vmcnt(9)
    v_mfma_f32_32x32x16_bf16 v[192:207], v[128:131], a[224:227], v[192:207]
    buffer_load_dwordx4 v[164:167], v3, s[24:27], s49 offen offset:1024 sc1
    v_mfma_f32_32x32x16_bf16 v[208:223], v[128:131], a[228:231], v[208:223]
    s_waitcnt vmcnt(9)
    v_max3_u32 v27, v128, v132, v27
    v_mfma_f32_32x32x16_bf16 v[192:207], v[132:135], a[232:235], v[192:207]
    buffer_load_dwordx4 v[128:131], v3, s[24:27], s49 offen offset:2048 sc1
    v_mfma_f32_32x32x16_bf16 v[208:223], v[132:135], a[236:239], v[208:223]
    s_waitcnt vmcnt(9)
    v_mfma_f32_32x32x16_bf16 v[192:207], v[136:139], a[240:243], v[192:207]
    buffer_load_dwordx4 v[132:135], v3, s[24:27], s49 offen offset:3072 sc1
    v_mfma_f32_32x32x16_bf16 v[208:223], v[136:139], a[244:247], v[208:223]
    s_barrier
    s_waitcnt vmcnt(9)
    v_max3_u32 v27, v136, v140, v27
    v_mfma_f32_32x32x16_bf16 v[192:207], v[140:143], a[248:251], v[192:207]
    buffer_load_dwordx4 v[136:139], v3, s[24:27], s50 offen offset:0 sc1
    v_mfma_f32_32x32x16_bf16 v[208:223], v[140:143], a[252:255], v[208:223]
    v_cmp_eq_u32 vcc, -1, v27
    s_cbranch_vccnz L_slowA1
L_retA1:
    s_waitcnt vmcnt(9)
    v_mfma_f32_32x32x16_bf16 v[224:239], v[144:147], a[0:3], 0
    buffer_load_dwordx4 v[140:143], v3, s[24:27], s50 offen offset:1024 sc1
    v_mfma_f32_32x32x16_bf16 v[240:255], v[144:147], a[4:7], 0
    s_waitcnt vmcnt(8)
    v_max_u32 v26, v144, v148
    v_mfma_f32_32x32x16_bf16 v[224:239], v[148:151], a[8:11], v[224:239]
    buffer_load_dwordx4 v[144:147], v3, s[24:27], s50 offen offset:2048 sc1
    ds_write_b128 v4, v[192:195] offset:0
    v_mfma_f32_32x32x16_bf16 v[240:255], v[148:151], a[12:15], v[240:255]
    ds_write_b128 v4, v[196:199] offset:1024
    s_waitcnt vmcnt(8)
    v_mfma_f32_32x32x16_bf16 v[224:239], v[152:155], a[16:19], v[224:239]
    buffer_load_dwordx4 v[148:151], v3, s[24:27], s50 offen offset:3072 sc1
    ds_write_b128 v4, v[200:203] offset:2048
    v_mfma_f32_32x32x16_bf16 v[240:255], v[152:155], a[20:23], v[240:255]
    ds_write_b128 v4, v[204:207] offset:3072
    s_waitcnt vmcnt(8)
    v_max3_u32 v26, v152, v156, v26
    v_mfma_f32_32x32x16_bf16 v[224:239], v[156:159], a[24:27], v[224:239]
    buffer_load_dwordx4 v[152:155], v3, s[24:27], s51 offen offset:0 sc1
    ds_write_b128 v4, v[208:211] offset:4096
    v_mfma_f32_32x32x16_bf16 v[240:255], v[156:159], a[28:31], v[240:255]
    ds_write_b128 v4, v[212:215] offset:5120
    s_waitcnt vmcnt(8)
    v_mfma_f32_32x32x16_bf16 v[224:239], v[160:163], a[32:35], v[224:239]
    buffer_load_dwordx4 v[156:159], v3, s[24:27], s51 offen offset:1024 sc1
    ds_write_b128 v4, v[216:219] offset:6144
    v_mfma_f32_32x32x16_bf16 v[240:255], v[160:163], a[36:39], v[240:255]
    ds_write_b128 v4, v[220:223] offset:7168
    s_waitcnt vmcnt(8)
    v_max3_u32 v26, v160, v164, v26
    v_mfma_f32_32x32x16_bf16 v[224:239], v[164:167], a[40:43], v[224:239]
    buffer_load_dwordx4 v[160:163], v3, s[24:27], s51 offen offset:2048 sc1
    v_mfma_f32_32x32x16_bf16 v[240:255], v[164:167], a[44:47], v[240:255]
    s_waitcnt vmcnt(8)
    v_mfma_f32_32x32x16_bf16 v[224:239], v[128:131], a[48:51], v[224:239]
    buffer_load_dwordx4 v[164:167], v3, s[24:27], s51 offen offset:3072 sc1
    v_mfma_f32_32x32x16_bf16 v[240:255], v[128:131], a[52:55], v[240:255]
    s_waitcnt vmcnt(8)
    v_max3_u32 v26, v128, v132, v26
    v_mfma_f32_32x32x16_bf16 v[224:239], v[132:135], a[56:59], v[224:239]
    buffer_load_dwordx4 v[128:131], v3, s[24:27], s52 offen offset:0 sc1
    s_waitcnt lgkmcnt(0)
    s_barrier
    ds_read_b128 v[80:83], v5 offset:0
    v_mfma_f32_32x32x16_bf16 v[240:255], v[132:135], a[60:63], v[240:255]
    ds_read_b128 v[84:87], v5 offset:256
    s_waitcnt vmcnt(8)
    v_mfma_f32_32x32x16_bf16 v[224:239], v[136:139], a[64:67], v[224:239]
    buffer_load_dwordx4 v[132:135], v3, s[24:27], s52 offen offset:1024 sc1
    ds_read_b128 v[88:91], v5 offset:8192
    v_mfma_f32_32x32x16_bf16 v[240:255], v[136:139], a[68:71], v[240:255]
    ds_read_b128 v[92:95], v5 offset:8448
    s_waitcnt vmcnt(8)
    v_max3_u32 v26, v136, v140, v26
    v_mfma_f32_32x32x16_bf16 v[224:239], v[140:143], a[72:75], v[224:239]
    buffer_load_dwordx4 v[136:139], v3, s[24:27], s52 offen offset:2048 sc1
    ds_read_b128 v[96:99], v5 offset:16384
    v_mfma_f32_32x32x16_bf16 v[240:255], v[140:143], a[76:79], v[240:255]
    ds_read_b128 v[100:103], v5 offset:16640
    s_waitcnt vmcnt(8)
    v_mfma_f32_32x32x16_bf16 v[224:239], v[144:147], a[80:83], v[224:239]
    buffer_load_dwordx4 v[140:143], v3, s[24:27], s52 offen offset:3072 sc1
    ds_read_b128 v[104:107], v5 offset:24576
    v_mfma_f32_32x32x16_bf16 v[240:255], v[144:147], a[84:87], v[240:255]
    ds_read_b128 v[108:111], v5 offset:24832
    s_waitcnt vmcnt(8)
    v_max3_u32 v26, v144, v148, v26
    v_mfma_f32_32x32x16_bf16 v[224:239], v[148:151], a[88:91], v[224:239]
    buffer_load_dwordx4 v[144:147], v3, s[24:27], s53 offen offset:0 sc1
    s_waitcnt lgkmcnt(4)
    v_add_f32 v80, v80, v88
    v_mfma_f32_32x32x16_bf16 v[240:255], v[148:151], a[92:95], v[240:255]
    v_add_f32 v81, v81, v89
    v_add_f32 v82, v82, v90
    s_waitcnt vmcnt(8)
    v_mfma_f32_32x32x16_bf16 v[224:239], v[152:155], a[96:99], v[224:239]
    buffer_load_dwordx4 v[148:151], v3, s[24:27], s53 offen offset:1024 sc1
    v_add_f32 v83, v83, v91
    v_add_f32 v84, v84, v92
    v_mfma_f32_32x32x16_bf16 v[240:255], v[152:155], a[100:103], v[240:255]
    v_add_f32 v85, v85, v93
    v_add_f32 v86, v86, v94
    s_waitcnt vmcnt(8)
    v_max3_u32 v26, v152, v156, v26
    v_mfma_f32_32x32x16_bf16 v[224:239], v[156:159], a[104:107], v[224:239]
    buffer_load_dwordx4 v[152:155], v3, s[24:27], s53 offen offset:2048 sc1
    v_add_f32 v87, v87, v95
    v_add_f32 v80, v80, v28
    v_mfma_f32_32x32x16_bf16 v[240:255], v[156:159], a[108:111], v[240:255]
    v_add_f32 v81, v81, v28
    v_add_f32 v82, v82, v28
    s_waitcnt vmcnt(8)
    v_mfma_f32_32x32x16_bf16 v[224:239], v[160:163], a[112:115], v[224:239]
    buffer_load_dwordx4 v[156:159], v3, s[24:27], s53 offen offset:3072 sc1
    v_add_f32 v83, v83, v28
    v_add_f32 v84, v84, v29
    v_mfma_f32_32x32x16_bf16 v[240:255], v[160:163], a[116:119], v[240:255]
    v_add_f32 v85, v85, v29
    v_add_f32 v86, v86, v29
    s_waitcnt vmcnt(8)
    v_max3_u32 v26, v160, v164, v26
    v_mfma_f32_32x32x16_bf16 v[224:239], v[164:167], a[120:123], v[224:239]
    buffer_load_dwordx4 v[160:163], v3, s[24:27], s54 offen offset:0 sc1
    v_add_f32 v87, v87, v29
    s_waitcnt lgkmcnt(0)
    v_mfma_f32_32x32x16_bf16 v[240:255], v[164:167], a[124:127], v[240:255]
    v_add_f32 v96, v96, v104
    v_add_f32 v97, v97, v105
    s_waitcnt vmcnt(8)
    v_mfma_f32_32x32x16_bf16 v[224:239], v[128:131], a[128:131], v[224:239]
    buffer_load_dwordx4 v[164:167], v3, s[24:27], s54 offen offset:1024 sc1
    v_add_f32 v98, v98, v106
    v_add_f32 v99, v99, v107
    v_mfma_f32_32x32x16_bf16 v[240:255], v[128:131], a[132:135], v[240:255]
    v_add_f32 v100, v100, v108
    v_add_f32 v101, v101, v109
    s_waitcnt vmcnt(8)
    v_max3_u32 v26, v128, v132, v26
    v_mfma_f32_32x32x16_bf16 v[224:239], v[132:135], a[136:139], v[224:239]
    buffer_load_dwordx4 v[128:131], v3, s[24:27], s54 offen offset:2048 sc1
    v_add_f32 v102, v102, v110
    v_add_f32 v103, v103, v111
    v_mfma_f32_32x32x16_bf16 v[240:255], v[132:135], a[140:143], v[240:255]
    v_add_f32 v80, v80, v96
    v_add_f32 v81, v81, v97
    s_waitcnt vmcnt(8)
    v_mfma_f32_32x32x16_bf16 v[224:239], v[136:139], a[144:147], v[224:239]
    buffer_load_dwordx4 v[132:135], v3, s[24:27], s54 offen offset:3072 sc1
    v_add_f32 v82, v82, v98
    v_add_f32 v83, v83, v99
    v_mfma_f32_32x32x16_bf16 v[240:255], v[136:139], a[148:151], v[240:255]
    v_add_f32 v84, v84, v100
    v_add_f32 v85, v85, v101
    s_waitcnt vmcnt(8)
    v_max3_u32 v26, v136, v140, v26
    v_mfma_f32_32x32x16_bf16 v[224:239], v[140:143], a[152:155], v[224:239]
    buffer_load_dwordx4 v[136:139], v3, s[24:27], s55 offen offset:0 sc1
    v_add_f32 v86, v86, v102
    v_add_f32 v87, v87, v103
    v_mfma_f32_32x32x16_bf16 v[240:255], v[140:143], a[156:159], v[240:255]
    v_mul_f32 v80, v80, v64
    v_mul_f32 v81, v81, v65
    s_waitcnt vmcnt(8)
    v_mfma_f32_32x32x16_bf16 v[224:239], v[144:147], a[160:163], v[224:239]
    buffer_load_dwordx4 v[140:143], v3, s[24:27], s55 offen offset:1024 sc1
    v_mul_f32 v82, v82, v66
    v_mul_f32 v83, v83, v67
    v_mfma_f32_32x32x16_bf16 v[240:255], v[144:147], a[164:167], v[240:255]
    v_mul_f32 v84, v84, v68
    v_mul_f32 v85, v85, v69
    s_waitcnt vmcnt(8)
    v_max3_u32 v26, v144, v148, v26
    v_mfma_f32_32x32x16_bf16 v[224:239], v[148:151], a[168:171], v[224:239]
    buffer_load_dwordx4 v[144:147], v3, s[24:27], s55 offen offset:2048 sc1
    v_mul_f32 v86, v86, v70
    v_mul_f32 v87, v87, v71
    v_mfma_f32_32x32x16_bf16 v[240:255], v[148:151], a[172:175], v[240:255]
    v_cvt_pk_bf16_f32 v112, v80, v81
    v_cvt_pk_bf16_f32 v113, v82, v83
    s_waitcnt vmcnt(8)
    v_mfma_f32_32x32x16_bf16 v[224:239], v[152:155], a[176:179], v[224:239]
    buffer_load_dwordx4 v[148:151], v3, s[24:27], s55 offen offset:3072 sc1
    v_cvt_pk_bf16_f32 v114, v84, v85
    v_cvt_pk_bf16_f32 v115, v86, v87
    v_mfma_f32_32x32x16_bf16 v[240:255], v[152:155], a[180:183], v[240:255]
    v_permlane16_swap_b32 v112, v114
    v_permlane16_swap_b32 v113, v115
    s_waitcnt vmcnt(8)
    v_max3_u32 v26, v152, v156, v26
    v_mfma_f32_32x32x16_bf16 v[224:239], v[156:159], a[184:187], v[224:239]
    s_add_u32 m0, s90, 69632
    s_lshl3_add_u32 s5, s62, s98
    buffer_load_dwordx4 v6, s[20:23], s5 offen lds
    buffer_store_dwordx4 v[112:115], v22, s[24:27], s81 offen sc1
    v_mfma_f32_32x32x16_bf16 v[240:255], v[156:159], a[188:191], v[240:255]
    s_add_u32 m0, s90, 73728
    s_lshl3_add_u32 s5, s63, s98
    buffer_load_dwordx4 v6, s[20:23], s5 offen lds
    s_waitcnt vmcnt(10)
    v_mfma_f32_32x32x16_bf16 v[224:239], v[160:163], a[192:195], v[224:239]
    s_add_u32 m0, s90, 81920
    s_lshl3_add_u32 s5, s57, s98
    s_add_u32 s5, s5, 32768
    buffer_load_dwordx4 v6, s[20:23], s5 offen lds
    v_mfma_f32_32x32x16_bf16 v[240:255], v[160:163], a[196:199], v[240:255]
    s_add_u32 m0, s90, 86016
    s_lshl3_add_u32 s5, s58, s98
    s_add_u32 s5, s5, 32768
    buffer_load_dwordx4 v6, s[20:23], s5 offen lds
    s_waitcnt vmcnt(11)
    v_max3_u32 v26, v160, v164, v26
    v_mfma_f32_32x32x16_bf16 v[224:239], v[164:167], a[200:203], v[224:239]
    s_mov_b32 m0, s90
    s_lshl3_add_u32 s5, s59, s98
    s_add_u32 s5, s5, 32768
    buffer_load_dwordx4 v6, s[20:23], s5 offen lds
    v_mfma_f32_32x32x16_bf16 v[240:255], v[164:167], a[204:207], v[240:255]
    s_add_u32 m0, s90, 4096
    s_lshl3_add_u32 s5, s60, s98
    s_add_u32 s5, s5, 32768
    buffer_load_dwordx4 v6, s[20:23], s5 offen lds
    s_waitcnt vmcnt(12)
    v_mfma_f32_32x32x16_bf16 v[224:239], v[128:131], a[208:211], v[224:239]
    s_add_u32 m0, s90, 8192
    s_lshl3_add_u32 s5, s61, s98
    s_add_u32 s5, s5, 32768
    buffer_load_dwordx4 v6, s[20:23], s5 offen lds
    v_mfma_f32_32x32x16_bf16 v[240:255], v[128:131], a[212:215], v[240:255]
    s_add_u32 m0, s90, 12288
    s_lshl3_add_u32 s5, s62, s98
    s_add_u32 s5, s5, 32768
    buffer_load_dwordx4 v6, s[20:23], s5 offen lds
    s_waitcnt vmcnt(13)
    v_max3_u32 v26, v128, v132, v26
    v_mfma_f32_32x32x16_bf16 v[224:239], v[132:135], a[216:219], v[224:239]
    s_add_u32 m0, s90, 16384
    s_lshl3_add_u32 s5, s63, s98
    s_add_u32 s5, s5, 32768
    buffer_load_dwordx4 v6, s[20:23], s5 offen lds
    v_mfma_f32_32x32x16_bf16 v[240:255], v[132:135], a[220:223], v[240:255]
    s_add_u32 m0, s90, 20480
    s_lshl3_add_u32 s5, s75, s98
    buffer_load_dwordx4 v6, s[20:23], s5 offen lds
    s_waitcnt vmcnt(14)
    v_mfma_f32_32x32x16_bf16 v[224:239], v[136:139], a[224:227], v[224:239]
    s_add_u32 m0, s90, 24576
    s_lshl3_add_u32 s5, s76, s98
    buffer_load_dwordx4 v6, s[20:23], s5 offen lds
    v_mfma_f32_32x32x16_bf16 v[240:255], v[136:139], a[228:231], v[240:255]
    s_waitcnt vmcnt(14)
    v_max3_u32 v26, v136, v140, v26
    v_mfma_f32_32x32x16_bf16 v[224:239], v[140:143], a[232:235], v[224:239]
    s_add_u32 m0, s90, 28672
    s_lshl3_add_u32 s5, s84, s98
    buffer_load_dwordx4 v6, s[20:23], s5 offen lds
    v_mfma_f32_32x32x16_bf16 v[240:255], v[140:143], a[236:239], v[240:255]
    s_waitcnt vmcnt(14)
    v_mfma_f32_32x32x16_bf16 v[224:239], v[144:147], a[240:243], v[224:239]
    s_add_u32 m0, s90, 32768
    s_lshl3_add_u32 s5, s88, s98
    buffer_load_dwordx4 v6, s[20:23], s5 offen lds
    v_mfma_f32_32x32x16_bf16 v[240:255], v[144:147], a[244:247], v[240:255]
    s_barrier
    s_waitcnt vmcnt(14)
    v_max3_u32 v26, v144, v148, v26
    v_mfma_f32_32x32x16_bf16 v[224:239], v[148:151], a[248:251], v[224:239]
    s_add_u32 m0, s90, 36864
    s_lshl3_add_u32 s5, s45, s98
    buffer_load_dwordx4 v6, s[20:23], s5 offen lds
    v_mfma_f32_32x32x16_bf16 v[240:255], v[148:151], a[252:255], v[240:255]
    v_cmp_eq_u32 vcc, -1, v26
    s_cbranch_vccnz L_slowA2
L_retA2:
    s_nop 5
    ds_write_b128 v4, v[224:227] offset:0
    ds_write_b128 v4, v[228:231] offset:1024
    ds_write_b128 v4, v[232:235] offset:2048
    s_add_u32 s3, s65, s56
    buffer_load_dwordx4 v[128:131], v1, s[24:27], s3 offen sc1
    ds_write_b128 v4, v[236:239] offset:3072
    s_add_u32 s3, s65, s57
    buffer_load_dwordx4 v[132:135], v1, s[24:27], s3 offen sc1
    ds_write_b128 v4, v[240:243] offset:4096
    s_add_u32 s3, s65, s58
    buffer_load_dwordx4 v[136:139], v1, s[24:27], s3 offen sc1
    ds_write_b128 v4, v[244:247] offset:5120
    s_add_u32 s3, s65, s59
    buffer_load_dwordx4 v[140:143], v1, s[24:27], s3 offen sc1
    ds_write_b128 v4, v[248:251] offset:6144
    s_add_u32 s3, s65, s60
    buffer_load_dwordx4 v[144:147], v1, s[24:27], s3 offen sc1
    ds_write_b128 v4, v[252:255] offset:7168
    s_add_u32 s3, s65, s61
    buffer_load_dwordx4 v[148:151], v1, s[24:27], s3 offen sc1
    s_waitcnt lgkmcnt(0)
    s_barrier
    ds_read_b128 v[80:83], v5 offset:0
    ds_read_b128 v[84:87], v5 offset:256
    ds_read_b128 v[88:91], v5 offset:8192
    ds_read_b128 v[92:95], v5 offset:8448
    ds_read_b128 v[96:99], v5 offset:16384
    ds_read_b128 v[100:103], v5 offset:16640
    ds_read_b128 v[104:107], v5 offset:24576
    ds_read_b128 v[108:111], v5 offset:24832
    s_add_u32 s3, s65, s62
    buffer_load_dwordx4 v[152:155], v1, s[24:27], s3 offen sc1
    s_add_u32 s3, s65, s63
    buffer_load_dwordx4 v[156:159], v1, s[24:27], s3 offen sc1
    s_waitcnt lgkmcnt(4)
    v_pk_add_f32 v[80:81], v[80:81], v[88:89]
    v_pk_add_f32 v[82:83], v[82:83], v[90:91]
    v_pk_add_f32 v[84:85], v[84:85], v[92:93]
    v_pk_add_f32 v[86:87], v[86:87], v[94:95]
    v_pk_add_f32 v[80:81], v[80:81], v[28:29] op_sel:[0,0] op_sel_hi:[1,0]
    v_pk_add_f32 v[82:83], v[82:83], v[28:29] op_sel:[0,0] op_sel_hi:[1,0]
    v_pk_add_f32 v[84:85], v[84:85], v[28:29] op_sel:[0,1] op_sel_hi:[1,1]
    v_pk_add_f32 v[86:87], v[86:87], v[28:29] op_sel:[0,1] op_sel_hi:[1,1]
    s_waitcnt lgkmcnt(0)
    v_pk_add_f32 v[96:97], v[96:97], v[104:105]
    v_pk_add_f32 v[98:99], v[98:99], v[106:107]
    v_pk_add_f32 v[100:101], v[100:101], v[108:109]
    v_pk_add_f32 v[102:103], v[102:103], v[110:111]
    v_pk_add_f32 v[80:81], v[80:81], v[96:97]
    v_pk_add_f32 v[82:83], v[82:83], v[98:99]
    v_pk_add_f32 v[84:85], v[84:85], v[100:101]
    v_pk_add_f32 v[86:87], v[86:87], v[102:103]
    v_pk_mul_f32 v[80:81], v[80:81], v[72:73]
    v_pk_mul_f32 v[82:83], v[82:83], v[74:75]
    v_pk_mul_f32 v[84:85], v[84:85], v[76:77]
    v_pk_mul_f32 v[86:87], v[86:87], v[78:79]
    v_cvt_pk_bf16_f32 v112, v80, v81
    v_cvt_pk_bf16_f32 v113, v82, v83
    v_cvt_pk_bf16_f32 v114, v84, v85
    v_cvt_pk_bf16_f32 v115, v86, v87
    s_nop 0
    v_permlane16_swap_b32 v112, v114
    v_permlane16_swap_b32 v113, v115
    buffer_store_dwordx4 v[112:115], v22, s[24:27], s82 offen sc1
    ds_read_b64_tr_b16 a[0:1], v13 offset:4096
    ds_read_b64_tr_b16 a[2:3], v13 offset:4608
    ds_read_b64_tr_b16 a[4:5], v14 offset:4096
    ds_read_b64_tr_b16 a[6:7], v14 offset:4608
    ds_read_b64_tr_b16 a[8:9], v15 offset:4096
    ds_read_b64_tr_b16 a[10:11], v15 offset:4608
    ds_read_b64_tr_b16 a[12:13], v16 offset:4096
    ds_read_b64_tr_b16 a[14:15], v16 offset:4608
    ds_read_b64_tr_b16 a[16:17], v13 offset:8192
    ds_read_b64_tr_b16 a[18:19], v13 offset:8704
    ds_read_b64_tr_b16 a[20:21], v14 offset:8192
    ds_read_b64_tr_b16 a[22:23], v14 offset:8704
    ds_read_b64_tr_b16 a[24:25], v15 offset:8192
    ds_read_b64_tr_b16 a[26:27], v15 offset:8704
    ds_read_b64_tr_b16 a[28:29], v16 offset:8192
    ds_read_b64_tr_b16 a[30:31], v16 offset:8704
    s_waitcnt vmcnt(1)
L_hA0_chk:
    v_max_u32 v24, v128, v132
    v_max3_u32 v24, v136, v140, v24
    v_max3_u32 v24, v144, v148, v24
    v_max3_u32 v24, v152, v156, v24
    v_cmp_eq_u32 vcc, -1, v24
    s_cbranch_vccnz L_hA0_retry
L_hA0_ok:
    s_waitcnt lgkmcnt(8)
    v_mfma_f32_16x16x32_bf16 v[32:35], a[0:3], v[128:131], 0
    ds_read_b64_tr_b16 a[32:33], v13 offset:12288
    ds_read_b64_tr_b16 a[34:35], v13 offset:12800
    v_mfma_f32_16x16x32_bf16 v[36:39], a[4:7], v[128:131], 0
    s_add_u32 s3, s79, s56
    buffer_load_dwordx4 v[160:163], v1, s[24:27], s3 offen sc1
    ds_read_b64_tr_b16 a[36:37], v14 offset:12288
    ds_read_b64_tr_b16 a[38:39], v14 offset:12800
    v_mfma_f32_16x16x32_bf16 v[40:43], a[8:11], v[128:131], 0
    ds_read_b64_tr_b16 a[40:41], v15 offset:12288
    ds_read_b64_tr_b16 a[42:43], v15 offset:12800
    v_mfma_f32_16x16x32_bf16 v[44:47], a[12:15], v[128:131], 0
    s_add_u32 s3, s79, s57
    buffer_load_dwordx4 v[164:167], v1, s[24:27], s3 offen sc1
    ds_read_b64_tr_b16 a[44:45], v16 offset:12288
    ds_read_b64_tr_b16 a[46:47], v16 offset:12800
    s_waitcnt lgkmcnt(8)
    v_mfma_f32_16x16x32_bf16 v[32:35], a[16:19], v[132:135], v[32:35]
    ds_read_b64_tr_b16 a[48:49], v13 offset:16384
    ds_read_b64_tr_b16 a[50:51], v13 offset:16896
    v_mfma_f32_16x16x32_bf16 v[36:39], a[20:23], v[132:135], v[36:39]
    s_add_u32 s3, s79, s58
    buffer_load_dwordx4 v[168:171], v1, s[24:27], s3 offen sc1
    ds_read_b64_tr_b16 a[52:53], v14 offset:16384
    ds_read_b64_tr_b16 a[54:55], v14 offset:16896
    v_mfma_f32_16x16x32_bf16 v[40:43], a[24:27], v[132:135], v[40:43]
    ds_read_b64_tr_b16 a[56:57], v15 offset:16384
    ds_read_b64_tr_b16 a[58:59], v15 offset:16896
    v_mfma_f32_16x16x32_bf16 v[44:47], a[28:31], v[132:135], v[44:47]
    s_add_u32 s3, s79, s59
    buffer_load_dwordx4 v[172:175], v1, s[24:27], s3 offen sc1
    ds_read_b64_tr_b16 a[60:61], v16 offset:16384
    ds_read_b64_tr_b16 a[62:63], v16 offset:16896
    s_waitcnt lgkmcnt(8)
    v_mfma_f32_16x16x32_bf16 v[32:35], a[32:35], v[136:139], v[32:35]
    ds_read_b64_tr_b16 a[64:65], v13 offset:20480
    ds_read_b64_tr_b16 a[66:67], v13 offset:20992
    v_mfma_f32_16x16x32_bf16 v[36:39], a[36:39], v[136:139], v[36:39]
    s_add_u32 s3, s79, s60
    buffer_load_dwordx4 v[176:179], v1, s[24:27], s3 offen sc1
    ds_read_b64_tr_b16 a[68:69], v14 offset:20480
    ds_read_b64_tr_b16 a[70:71], v14 offset:20992
    v_mfma_f32_16x16x32_bf16 v[40:43], a[40:43], v[136:139], v[40:43]
    ds_read_b64_tr_b16 a[72:73], v15 offset:20480
    ds_read_b64_tr_b16 a[74:75], v15 offset:20992
    v_mfma_f32_16x16x32_bf16 v[44:47], a[44:47], v[136:139], v[44:47]
    s_add_u32 s3, s79, s61
    buffer_load_dwordx4 v[180:183], v1, s[24:27], s3 offen sc1
    ds_read_b64_tr_b16 a[76:77], v16 offset:20480
    ds_read_b64_tr_b16 a[78:79], v16 offset:20992
    s_waitcnt lgkmcnt(8)
    v_mfma_f32_16x16x32_bf16 v[32:35], a[48:51], v[140:143], v[32:35]
    ds_read_b64_tr_b16 a[80:81], v13 offset:24576
    ds_read_b64_tr_b16 a[82:83], v13 offset:25088
    v_mfma_f32_16x16x32_bf16 v[36:39], a[52:55], v[140:143], v[36:39]
    s_add_u32 s3, s79, s62
    buffer_load_dwordx4 v[184:187], v1, s[24:27], s3 offen sc1
    ds_read_b64_tr_b16 a[84:85], v14 offset:24576
    ds_read_b64_tr_b16 a[86:87], v14 offset:25088
    v_mfma_f32_16x16x32_bf16 v[40:43], a[56:59], v[140:143], v[40:43]
    ds_read_b64_tr_b16 a[88:89], v15 offset:24576
    ds_read_b64_tr_b16 a[90:91], v15 offset:25088
    v_mfma_f32_16x16x32_bf16 v[44:47], a[60:63], v[140:143], v[44:47]
    s_add_u32 s3, s79, s63
    buffer_load_dwordx4 v[188:191], v1, s[24:27], s3 offen sc1
    ds_read_b64_tr_b16 a[92:93], v16 offset:24576
    ds_read_b64_tr_b16 a[94:95], v16 offset:25088
    s_barrier
    s_waitcnt lgkmcnt(8)
    v_mfma_f32_16x16x32_bf16 v[32:35], a[64:67], v[144:147], v[32:35]
    ds_read_b64_tr_b16 a[0:1], v13 offset:28672
    ds_read_b64_tr_b16 a[2:3], v13 offset:29184
    v_mfma_f32_16x16x32_bf16 v[36:39], a[68:71], v[144:147], v[36:39]
    buffer_load_dwordx4 v[48:51], v9, s[8:11], s64 offen offset:0
    ds_read_b64_tr_b16 a[4:5], v14 offset:28672
    ds_read_b64_tr_b16 a[6:7], v14 offset:29184
    v_mfma_f32_16x16x32_bf16 v[40:43], a[72:75], v[144:147], v[40:43]
    ds_read_b64_tr_b16 a[8:9], v15 offset:28672
    ds_read_b64_tr_b16 a[10:11], v15 offset:29184
    v_mfma_f32_16x16x32_bf16 v[44:47], a[76:79], v[144:147], v[44:47]
    buffer_load_dwordx4 v[52:55], v9, s[8:11], s64 offen offset:64
    ds_read_b64_tr_b16 a[12:13], v16 offset:28672
    ds_read_b64_tr_b16 a[14:15], v16 offset:29184
    s_waitcnt lgkmcnt(8)
    v_mfma_f32_16x16x32_bf16 v[32:35], a[80:83], v[148:151], v[32:35]
    ds_read_b64_tr_b16 a[16:17], v13 offset:32768
    ds_read_b64_tr_b16 a[18:19], v13 offset:33280
    v_mfma_f32_16x16x32_bf16 v[36:39], a[84:87], v[148:151], v[36:39]
    ds_read_b64_tr_b16 a[20:21], v14 offset:32768
    ds_read_b64_tr_b16 a[22:23], v14 offset:33280
    v_mfma_f32_16x16x32_bf16 v[40:43], a[88:91], v[148:151], v[40:43]
    ds_read_b64_tr_b16 a[24:25], v15 offset:32768
    ds_read_b64_tr_b16 a[26:27], v15 offset:33280
    v_mfma_f32_16x16x32_bf16 v[44:47], a[92:95], v[148:151], v[44:47]
    ds_read_b64_tr_b16 a[28:29], v16 offset:32768
    ds_read_b64_tr_b16 a[30:31], v16 offset:33280
    s_waitcnt lgkmcnt(8)
    v_mfma_f32_16x16x32_bf16 v[32:35], a[0:3], v[152:155], v[32:35]
    ds_read_b64_tr_b16 a[32:33], v13 offset:36864
    ds_read_b64_tr_b16 a[34:35], v13 offset:37376
    v_mfma_f32_16x16x32_bf16 v[36:39], a[4:7], v[152:155], v[36:39]
    ds_read_b64_tr_b16 a[36:37], v14 offset:36864
    ds_read_b64_tr_b16 a[38:39], v14 offset:37376
    v_mfma_f32_16x16x32_bf16 v[40:43], a[8:11], v[152:155], v[40:43]
    ds_read_b64_tr_b16 a[40:41], v15 offset:36864
    ds_read_b64_tr_b16 a[42:43], v15 offset:37376
    v_mfma_f32_16x16x32_bf16 v[44:47], a[12:15], v[152:155], v[44:47]
    ds_read_b64_tr_b16 a[44:45], v16 offset:36864
    ds_read_b64_tr_b16 a[46:47], v16 offset:37376
    s_waitcnt lgkmcnt(8)
    v_mfma_f32_16x16x32_bf16 v[32:35], a[16:19], v[156:159], v[32:35]
    ds_read_b64_tr_b16 a[48:49], v13 offset:40960
    ds_read_b64_tr_b16 a[50:51], v13 offset:41472
    v_mfma_f32_16x16x32_bf16 v[36:39], a[20:23], v[156:159], v[36:39]
    ds_read_b64_tr_b16 a[52:53], v14 offset:40960
    ds_read_b64_tr_b16 a[54:55], v14 offset:41472
    v_mfma_f32_16x16x32_bf16 v[40:43], a[24:27], v[156:159], v[40:43]
    ds_read_b64_tr_b16 a[56:57], v15 offset:40960
    ds_read_b64_tr_b16 a[58:59], v15 offset:41472
    v_mfma_f32_16x16x32_bf16 v[44:47], a[28:31], v[156:159], v[44:47]
    ds_read_b64_tr_b16 a[60:61], v16 offset:40960
    ds_read_b64_tr_b16 a[62:63], v16 offset:41472
    s_waitcnt vmcnt(2)
L_hA1_chk:
    v_max_u32 v24, v160, v164
    v_max3_u32 v24, v168, v172, v24
    v_max3_u32 v24, v176, v180, v24
    v_max3_u32 v24, v184, v188, v24
    v_cmp_eq_u32 vcc, -1, v24
    s_cbranch_vccnz L_hA1_retry
L_hA1_ok:
    s_waitcnt lgkmcnt(8)
    v_mfma_f32_16x16x32_bf16 v[32:35], a[32:35], v[160:163], v[32:35]
    ds_read_b64_tr_b16 a[64:65], v13 offset:45056
    ds_read_b64_tr_b16 a[66:67], v13 offset:45568
    v_mfma_f32_16x16x32_bf16 v[36:39], a[36:39], v[160:163], v[36:39]
    ds_read_b64_tr_b16 a[68:69], v14 offset:45056
    ds_read_b64_tr_b16 a[70:71], v14 offset:45568
    v_mfma_f32_16x16x32_bf16 v[40:43], a[40:43], v[160:163], v[40:43]
    ds_read_b64_tr_b16 a[72:73], v15 offset:45056
    ds_read_b64_tr_b16 a[74:75], v15 offset:45568
    v_mfma_f32_16x16x32_bf16 v[44:47], a[44:47], v[160:163], v[44:47]
    ds_read_b64_tr_b16 a[76:77], v16 offset:45056
    ds_read_b64_tr_b16 a[78:79], v16 offset:45568
    s_waitcnt lgkmcnt(8)
    v_mfma_f32_16x16x32_bf16 v[32:35], a[48:51], v[164:167], v[32:35]
    v_subrev_u32 v13, 40960, v13
    v_subrev_u32 v14, 40960, v14
    v_subrev_u32 v15, 40960, v15
    v_subrev_u32 v16, 40960, v16
    ds_read_b64_tr_b16 a[80:81], v13 offset:0
    ds_read_b64_tr_b16 a[82:83], v13 offset:512
    v_mfma_f32_16x16x32_bf16 v[36:39], a[52:55], v[164:167], v[36:39]
    ds_read_b64_tr_b16 a[84:85], v14 offset:0
    ds_read_b64_tr_b16 a[86:87], v14 offset:512
    v_mfma_f32_16x16x32_bf16 v[40:43], a[56:59], v[164:167], v[40:43]
    ds_read_b64_tr_b16 a[88:89], v15 offset:0
    ds_read_b64_tr_b16 a[90:91], v15 offset:512
    v_mfma_f32_16x16x32_bf16 v[44:47], a[60:63], v[164:167], v[44:47]
    ds_read_b64_tr_b16 a[92:93], v16 offset:0
    ds_read_b64_tr_b16 a[94:95], v16 offset:512
    s_waitcnt lgkmcnt(8)
    v_mfma_f32_16x16x32_bf16 v[32:35], a[64:67], v[168:171], v[32:35]
    ds_read_b64_tr_b16 a[0:1], v13 offset:4096
    ds_read_b64_tr_b16 a[2:3], v13 offset:4608
    v_mfma_f32_16x16x32_bf16 v[36:39], a[68:71], v[168:171], v[36:39]
    ds_read_b64_tr_b16 a[4:5], v14 offset:4096
    ds_read_b64_tr_b16 a[6:7], v14 offset:4608
    v_mfma_f32_16x16x32_bf16 v[40:43], a[72:75], v[168:171], v[40:43]
    ds_read_b64_tr_b16 a[8:9], v15 offset:4096
    ds_read_b64_tr_b16 a[10:11], v15 offset:4608
    v_mfma_f32_16x16x32_bf16 v[44:47], a[76:79], v[168:171], v[44:47]
    ds_read_b64_tr_b16 a[12:13], v16 offset:4096
    ds_read_b64_tr_b16 a[14:15], v16 offset:4608
    s_waitcnt lgkmcnt(8)
    v_mfma_f32_16x16x32_bf16 v[32:35], a[80:83], v[172:175], v[32:35]
    ds_read_b64_tr_b16 a[16:17], v13 offset:8192
    ds_read_b64_tr_b16 a[18:19], v13 offset:8704
    v_mfma_f32_16x16x32_bf16 v[36:39], a[84:87], v[172:175], v[36:39]
    ds_read_b64_tr_b16 a[20:21], v14 offset:8192
    ds_read_b64_tr_b16 a[22:23], v14 offset:8704
    v_mfma_f32_16x16x32_bf16 v[40:43], a[88:91], v[172:175], v[40:43]
    ds_read_b64_tr_b16 a[24:25], v15 offset:8192
    ds_read_b64_tr_b16 a[26:27], v15 offset:8704
    v_mfma_f32_16x16x32_bf16 v[44:47], a[92:95], v[172:175], v[44:47]
    ds_read_b64_tr_b16 a[28:29], v16 offset:8192
    ds_read_b64_tr_b16 a[30:31], v16 offset:8704
    s_add_u32 s3, s65, s74
    buffer_load_dwordx4 v[192:195], v1, s[24:27], s3 offen sc1
    s_add_u32 s3, s65, s75
    buffer_load_dwordx4 v[196:199], v1, s[24:27], s3 offen sc1
    s_add_u32 s3, s65, s76
    buffer_load_dwordx4 v[200:203], v1, s[24:27], s3 offen sc1
    s_add_u32 s3, s65, s84
    buffer_load_dwordx4 v[204:207], v1, s[24:27], s3 offen sc1
    s_add_u32 s3, s65, s88
    buffer_load_dwordx4 v[208:211], v1, s[24:27], s3 offen sc1
    s_add_u32 s3, s65, s45
    buffer_load_dwordx4 v[212:215], v1, s[24:27], s3 offen sc1
    s_waitcnt lgkmcnt(8)
    v_mfma_f32_16x16x32_bf16 v[32:35], a[0:3], v[176:179], v[32:35]
    ds_read_b64_tr_b16 a[32:33], v13 offset:12288
    ds_read_b64_tr_b16 a[34:35], v13 offset:12800
    v_mfma_f32_16x16x32_bf16 v[36:39], a[4:7], v[176:179], v[36:39]
    ds_read_b64_tr_b16 a[36:37], v14 offset:12288
    ds_read_b64_tr_b16 a[38:39], v14 offset:12800
    v_mfma_f32_16x16x32_bf16 v[40:43], a[8:11], v[176:179], v[40:43]
    ds_read_b64_tr_b16 a[40:41], v15 offset:12288
    ds_read_b64_tr_b16 a[42:43], v15 offset:12800
    v_mfma_f32_16x16x32_bf16 v[44:47], a[12:15], v[176:179], v[44:47]
    ds_read_b64_tr_b16 a[44:45], v16 offset:12288
    ds_read_b64_tr_b16 a[46:47], v16 offset:12800
    s_waitcnt lgkmcnt(8)
    v_mfma_f32_16x16x32_bf16 v[32:35], a[16:19], v[180:183], v[32:35]
    ds_read_b64_tr_b16 a[48:49], v13 offset:16384
    ds_read_b64_tr_b16 a[50:51], v13 offset:16896
    v_mfma_f32_16x16x32_bf16 v[36:39], a[20:23], v[180:183], v[36:39]
    ds_read_b64_tr_b16 a[52:53], v14 offset:16384
    ds_read_b64_tr_b16 a[54:55], v14 offset:16896
    v_mfma_f32_16x16x32_bf16 v[40:43], a[24:27], v[180:183], v[40:43]
    ds_read_b64_tr_b16 a[56:57], v15 offset:16384
    ds_read_b64_tr_b16 a[58:59], v15 offset:16896
    v_mfma_f32_16x16x32_bf16 v[44:47], a[28:31], v[180:183], v[44:47]
    ds_read_b64_tr_b16 a[60:61], v16 offset:16384
    ds_read_b64_tr_b16 a[62:63], v16 offset:16896
    s_mov_b32 s7, s66
    s_add_u32 s6, s7, s68
    buffer_load_dwordx2 v[56:57], v10, s[24:27], s7 offen sc1
    buffer_load_dword v64, v11, s[24:27], s6 offen offset:4 sc1
    s_add_u32 s7, s7, s67
    s_add_u32 s6, s7, s68
    buffer_load_dwordx2 v[58:59], v10, s[24:27], s7 offen sc1
    buffer_load_dword v65, v10, s[24:27], s6 offen offset:4 sc1
    s_add_u32 s7, s7, s67
    s_add_u32 s6, s7, s68
    buffer_load_dwordx2 v[60:61], v10, s[24:27], s7 offen sc1
    buffer_load_dword v66, v10, s[24:27], s6 offen offset:4 sc1
    s_add_u32 s7, s7, s67
    s_add_u32 s6, s7, s68
    buffer_load_dwordx2 v[62:63], v10, s[24:27], s7 offen sc1
    buffer_load_dword v67, v10, s[24:27], s6 offen offset:4 sc1
    s_waitcnt lgkmcnt(8)
    v_mfma_f32_16x16x32_bf16 v[32:35], a[32:35], v[184:187], v[32:35]
    ds_read_b64_tr_b16 a[64:65], v13 offset:40960
    ds_read_b64_tr_b16 a[66:67], v13 offset:41472
    v_mfma_f32_16x16x32_bf16 v[36:39], a[36:39], v[184:187], v[36:39]
    ds_read_b64_tr_b16 a[68:69], v14 offset:40960
    ds_read_b64_tr_b16 a[70:71], v14 offset:41472
    v_mfma_f32_16x16x32_bf16 v[40:43], a[40:43], v[184:187], v[40:43]
    ds_read_b64_tr_b16 a[72:73], v15 offset:40960
    ds_read_b64_tr_b16 a[74:75], v15 offset:41472
    v_mfma_f32_16x16x32_bf16 v[44:47], a[44:47], v[184:187], v[44:47]
    ds_read_b64_tr_b16 a[76:77], v16 offset:40960
    ds_read_b64_tr_b16 a[78:79], v16 offset:41472
    s_waitcnt lgkmcnt(8)
    v_mfma_f32_16x16x32_bf16 v[32:35], a[48:51], v[188:191], v[32:35]
    ds_read_b64_tr_b16 a[80:81], v13 offset:20480
    ds_read_b64_tr_b16 a[82:83], v13 offset:20992
    v_mfma_f32_16x16x32_bf16 v[36:39], a[52:55], v[188:191], v[36:39]
    ds_read_b64_tr_b16 a[84:85], v14 offset:20480
    ds_read_b64_tr_b16 a[86:87], v14 offset:20992
    v_mfma_f32_16x16x32_bf16 v[40:43], a[56:59], v[188:191], v[40:43]
    ds_read_b64_tr_b16 a[88:89], v15 offset:20480
    ds_read_b64_tr_b16 a[90:91], v15 offset:20992
    v_mfma_f32_16x16x32_bf16 v[44:47], a[60:63], v[188:191], v[44:47]
    ds_read_b64_tr_b16 a[92:93], v16 offset:20480
    ds_read_b64_tr_b16 a[94:95], v16 offset:20992
    ds_read_b64_tr_b16 a[0:1], v13 offset:24576
    ds_read_b64_tr_b16 a[2:3], v13 offset:25088
    ds_read_b64_tr_b16 a[4:5], v14 offset:24576
    ds_read_b64_tr_b16 a[6:7], v14 offset:25088
    ds_read_b64_tr_b16 a[8:9], v15 offset:24576
    ds_read_b64_tr_b16 a[10:11], v15 offset:25088
    ds_read_b64_tr_b16 a[12:13], v16 offset:24576
    ds_read_b64_tr_b16 a[14:15], v16 offset:25088
    ds_read_b64_tr_b16 a[16:17], v13 offset:28672
    ds_read_b64_tr_b16 a[18:19], v13 offset:29184
    ds_read_b64_tr_b16 a[20:21], v14 offset:28672
    ds_read_b64_tr_b16 a[22:23], v14 offset:29184
    ds_read_b64_tr_b16 a[24:25], v15 offset:28672
    ds_read_b64_tr_b16 a[26:27], v15 offset:29184
    ds_read_b64_tr_b16 a[28:29], v16 offset:28672
    ds_read_b64_tr_b16 a[30:31], v16 offset:29184
    ds_read_b64_tr_b16 a[32:33], v13 offset:32768
    ds_read_b64_tr_b16 a[34:35], v13 offset:33280
    ds_read_b64_tr_b16 a[36:37], v14 offset:32768
    ds_read_b64_tr_b16 a[38:39], v14 offset:33280
    ds_read_b64_tr_b16 a[40:41], v15 offset:32768
    ds_read_b64_tr_b16 a[42:43], v15 offset:33280
    ds_read_b64_tr_b16 a[44:45], v16 offset:32768
    ds_read_b64_tr_b16 a[46:47], v16 offset:33280
    ds_read_b64_tr_b16 a[48:49], v13 offset:36864
    ds_read_b64_tr_b16 a[50:51], v13 offset:37376
    ds_read_b64_tr_b16 a[52:53], v14 offset:36864
    ds_read_b64_tr_b16 a[54:55], v14 offset:37376
    ds_read_b64_tr_b16 a[56:57], v15 offset:36864
    ds_read_b64_tr_b16 a[58:59], v15 offset:37376
    ds_read_b64_tr_b16 a[60:61], v16 offset:36864
    ds_read_b64_tr_b16 a[62:63], v16 offset:37376
    s_waitcnt vmcnt(14)
    v_permlane16_swap_b32 v48, v50
    v_permlane16_swap_b32 v49, v51
    v_permlane16_swap_b32 v52, v54
    v_permlane16_swap_b32 v53, v55
    v_lshlrev_b32 v80, 16, v48
    v_and_b32 v81, 0xffff0000, v48
    v_lshlrev_b32 v82, 16, v49
    v_and_b32 v83, 0xffff0000, v49
    v_lshlrev_b32 v84, 16, v50
    v_and_b32 v85, 0xffff0000, v50
    v_lshlrev_b32 v86, 16, v51
    v_and_b32 v87, 0xffff0000, v51
    v_lshlrev_b32 v88, 16, v52
    v_and_b32 v89, 0xffff0000, v52
    v_lshlrev_b32 v90, 16, v53
    v_and_b32 v91, 0xffff0000, v53
    v_lshlrev_b32 v92, 16, v54
    v_and_b32 v93, 0xffff0000, v54
    v_lshlrev_b32_e64 v94, 16, v55
    v_and_b32 v95, 0xffff0000, v55
    v_pk_add_f32 v[32:33], v[32:33], v[80:81]
    v_pk_add_f32 v[34:35], v[34:35], v[82:83]
    v_pk_add_f32 v[36:37], v[36:37], v[84:85]
    v_pk_add_f32 v[38:39], v[38:39], v[86:87]
    v_pk_add_f32 v[40:41], v[40:41], v[88:89]
    v_pk_add_f32 v[42:43], v[42:43], v[90:91]
    v_pk_add_f32 v[44:45], v[44:45], v[92:93]
    v_pk_add_f32 v[46:47], v[46:47], v[94:95]
    s_waitcnt lgkmcnt(0)
    s_waitcnt vmcnt(8)
L_hA2_chk:
    v_max_u32 v24, v192, v196
    v_max3_u32 v24, v200, v204, v24
    v_max3_u32 v24, v208, v212, v24
    v_cmp_eq_u32 vcc, -1, v24
    s_cbranch_vccnz L_hA2_retry
L_hA2_ok:
    v_mfma_f32_16x16x32_bf16 v[32:35], a[64:67], v[192:195], v[32:35]
    v_mfma_f32_16x16x32_bf16 v[36:39], a[68:71], v[192:195], v[36:39]
    v_mfma_f32_16x16x32_bf16 v[40:43], a[72:75], v[192:195], v[40:43]
    v_mfma_f32_16x16x32_bf16 v[44:47], a[76:79], v[192:195], v[44:47]
    v_mfma_f32_16x16x32_bf16 v[32:35], a[80:83], v[196:199], v[32:35]
    v_mfma_f32_16x16x32_bf16 v[36:39], a[84:87], v[196:199], v[36:39]
    v_mfma_f32_16x16x32_bf16 v[40:43], a[88:91], v[196:199], v[40:43]
    v_mfma_f32_16x16x32_bf16 v[44:47], a[92:95], v[196:199], v[44:47]
    v_mfma_f32_16x16x32_bf16 v[32:35], a[0:3], v[200:203], v[32:35]
    v_mfma_f32_16x16x32_bf16 v[36:39], a[4:7], v[200:203], v[36:39]
    v_mfma_f32_16x16x32_bf16 v[40:43], a[8:11], v[200:203], v[40:43]
    v_mfma_f32_16x16x32_bf16 v[44:47], a[12:15], v[200:203], v[44:47]
    v_mfma_f32_16x16x32_bf16 v[32:35], a[16:19], v[204:207], v[32:35]
    v_mfma_f32_16x16x32_bf16 v[36:39], a[20:23], v[204:207], v[36:39]
    v_mfma_f32_16x16x32_bf16 v[40:43], a[24:27], v[204:207], v[40:43]
    v_mfma_f32_16x16x32_bf16 v[44:47], a[28:31], v[204:207], v[44:47]
    v_mfma_f32_16x16x32_bf16 v[32:35], a[32:35], v[208:211], v[32:35]
    v_mfma_f32_16x16x32_bf16 v[36:39], a[36:39], v[208:211], v[36:39]
    v_mfma_f32_16x16x32_bf16 v[40:43], a[40:43], v[208:211], v[40:43]
    v_mfma_f32_16x16x32_bf16 v[44:47], a[44:47], v[208:211], v[44:47]
    v_mfma_f32_16x16x32_bf16 v[32:35], a[48:51], v[212:215], v[32:35]
    v_mfma_f32_16x16x32_bf16 v[36:39], a[52:55], v[212:215], v[36:39]
    v_mfma_f32_16x16x32_bf16 v[40:43], a[56:59], v[212:215], v[40:43]
    v_mfma_f32_16x16x32_bf16 v[44:47], a[60:63], v[212:215], v[44:47]
    s_waitcnt vmcnt(0)
L_yA_chk:
    v_max_u32 v24, v56, v58
    v_max3_u32 v24, v60, v62, v24
    v_max3_u32 v24, v64, v65, v24
    v_max3_u32 v24, v66, v67, v24
    v_cmp_eq_u32_e64 vcc, -1, v24
    s_cbranch_vccnz L_yA_retry
L_yA_ok:
    v_and_b32 v80, 0xffff0000, v64
    v_and_b32 v82, 0xffff0000, v56
    v_perm_b32 v81, v57, v56, s70
    v_perm_b32 v83, v57, v56, s71
    v_and_b32 v84, 0xffff0000, v65
    v_and_b32 v86, 0xffff0000, v58
    v_perm_b32 v85, v59, v58, s70
    v_perm_b32 v87, v59, v58, s71
    v_and_b32 v88, 0xffff0000, v66
    v_and_b32 v90, 0xffff0000, v60
    v_perm_b32 v89, v61, v60, s70
    v_perm_b32 v91, v61, v60, s71
    v_and_b32 v92, 0xffff0000, v67
    v_and_b32 v94, 0xffff0000, v62
    v_perm_b32 v93, v63, v62, s70
    v_perm_b32 v95, v63, v62, s71
    v_pk_add_f32 v[32:33], v[32:33], v[80:81]
    v_pk_add_f32 v[34:35], v[34:35], v[82:83]
    v_pk_add_f32 v[36:37], v[36:37], v[84:85]
    v_pk_add_f32 v[38:39], v[38:39], v[86:87]
    v_pk_add_f32 v[40:41], v[40:41], v[88:89]
    v_pk_add_f32 v[42:43], v[42:43], v[90:91]
    v_pk_add_f32 v[44:45], v[44:45], v[92:93]
    v_pk_add_f32 v[46:47], v[46:47], v[94:95]
    v_cvt_pk_bf16_f32 v72, v32, v33
    v_cvt_pk_bf16_f32 v73, v34, v35
    v_cvt_pk_bf16_f32 v74, v36, v37
    v_cvt_pk_bf16_f32 v75, v38, v39
    v_cvt_pk_bf16_f32 v76, v40, v41
    v_cvt_pk_bf16_f32 v77, v42, v43
    v_cvt_pk_bf16_f32 v78, v44, v45
    v_cvt_pk_bf16_f32 v79, v46, v47
    v_permlane16_swap_b32 v72, v74
    v_permlane16_swap_b32 v73, v75
    buffer_store_dwordx4 v[72:75], v9, s[28:31], s64 offen offset:0
    v_permlane16_swap_b32 v76, v78
    v_permlane16_swap_b32 v77, v79
    buffer_store_dwordx4 v[76:79], v9, s[28:31], s64 offen offset:64
    s_endpgm
L_pathB:
    s_waitcnt lgkmcnt(0)
    s_barrier
    s_waitcnt vmcnt(11)
    v_mfma_f32_32x32x16_bf16 v[192:207], v[128:131], a[0:3], 0
    buffer_load_dwordx4 v[164:167], v1, s[24:27], s50 offen offset:1024 sc1
    v_add_u32 v2, 0x20000, v1
    v_add_u32 v3, 0x40000, v1
    s_lshl_b32 s3, s42, 13
    v_mfma_f32_32x32x16_bf16 v[208:223], v[128:131], a[4:7], 0
    s_add_u32 s3, s3, 32768
    v_add_u32 v4, s3, v1
    s_waitcnt vmcnt(11)
    v_max_u32 v26, v128, v132
    v_mfma_f32_32x32x16_bf16 v[192:207], v[132:135], a[8:11], v[192:207]
    buffer_load_dwordx4 v[128:131], v1, s[24:27], s50 offen offset:2048 sc1
    s_lshl_b32 s3, s42, 11
    s_add_u32 s3, s3, 32768
    v_lshrrev_b32 v40, 4, v0
    v_mfma_f32_32x32x16_bf16 v[208:223], v[132:135], a[12:15], v[208:223]
    v_lshl_add_u32 v40, v40, 8, s3
    v_add_u32 v5, v40, v1
    s_waitcnt vmcnt(11)
    v_mfma_f32_32x32x16_bf16 v[192:207], v[136:139], a[16:19], v[192:207]
    buffer_load_dwordx4 v[132:135], v1, s[24:27], s50 offen offset:3072 sc1
    v_and_b32 v32, 31, v0
    v_cvt_f32_u32 v32, v32
    v_lshrrev_b32 v33, 5, v0
    v_mfma_f32_32x32x16_bf16 v[208:223], v[136:139], a[20:23], v[208:223]
    s_lshl_b32 s3, s44, 10
    v_add_u32 v36, s3, v1
    s_waitcnt vmcnt(11)
    v_max3_u32 v26, v136, v140, v26
    v_mfma_f32_32x32x16_bf16 v[192:207], v[140:143], a[24:27], v[192:207]
    buffer_load_dwordx4 v[136:139], v1, s[24:27], s51 offen offset:0 sc1
    s_lshl_b32 s3, s42, 12
    v_add_u32 v37, s3, v1
    s_lshl_b32 s3, s42, 11
    v_mfma_f32_32x32x16_bf16 v[208:223], v[140:143], a[28:31], v[208:223]
    v_add_u32 v38, s3, v1
    v_mul_f32 v34, 0x3d000000, v32
    s_waitcnt vmcnt(11)
    v_mfma_f32_32x32x16_bf16 v[192:207], v[144:147], a[32:35], v[192:207]
    buffer_load_dwordx4 v[140:143], v1, s[24:27], s51 offen offset:1024 sc1
    s_lshl_b32 s3, s44, 4
    v_lshl_add_u32 v35, v33, 3, s3
    v_cvt_f32_u32 v35, v35
    v_mfma_f32_32x32x16_bf16 v[208:223], v[144:147], a[36:39], v[208:223]
    v_mul_f32 v80, v35, v34
    v_add_f32 v39, 0x3f800000, v35
    s_waitcnt vmcnt(11)
    v_max3_u32 v26, v144, v148, v26
    v_mfma_f32_32x32x16_bf16 v[192:207], v[148:151], a[40:43], v[192:207]
    buffer_load_dwordx4 v[144:147], v1, s[24:27], s51 offen offset:2048 sc1
    v_mul_f32 v81, v39, v34
    v_add_f32 v39, 0x40000000, v35
    v_mul_f32 v82, v39, v34
    v_mfma_f32_32x32x16_bf16 v[208:223], v[148:151], a[44:47], v[208:223]
    v_add_f32 v39, 0x40400000, v35
    v_mul_f32 v83, v39, v34
    s_waitcnt vmcnt(11)
    v_mfma_f32_32x32x16_bf16 v[192:207], v[152:155], a[48:51], v[192:207]
    buffer_load_dwordx4 v[148:151], v1, s[24:27], s51 offen offset:3072 sc1
    v_add_f32 v39, 0x40800000, v35
    v_mul_f32 v84, v39, v34
    v_add_f32 v39, 0x40a00000, v35
    v_mfma_f32_32x32x16_bf16 v[208:223], v[152:155], a[52:55], v[208:223]
    v_mul_f32 v85, v39, v34
    v_add_f32 v39, 0x40c00000, v35
    s_waitcnt vmcnt(11)
    v_max3_u32 v26, v152, v156, v26
    v_mfma_f32_32x32x16_bf16 v[192:207], v[156:159], a[56:59], v[192:207]
    buffer_load_dwordx4 v[152:155], v1, s[24:27], s52 offen offset:0 sc1
    v_mul_f32 v86, v39, v34
    v_add_f32 v39, 0x40e00000, v35
    v_mul_f32 v87, v39, v34
    v_mfma_f32_32x32x16_bf16 v[208:223], v[156:159], a[60:63], v[208:223]
    v_cos_f32 v88, v80
    v_cos_f32 v89, v81
    s_waitcnt vmcnt(11)
    v_mfma_f32_32x32x16_bf16 v[192:207], v[160:163], a[64:67], v[192:207]
    buffer_load_dwordx4 v[156:159], v1, s[24:27], s52 offen offset:1024 sc1
    v_cos_f32 v90, v82
    v_cos_f32 v91, v83
    v_cos_f32 v92, v84
    v_mfma_f32_32x32x16_bf16 v[208:223], v[160:163], a[68:71], v[208:223]
    v_cos_f32 v93, v85
    v_cos_f32 v94, v86
    s_waitcnt vmcnt(8)
    v_max3_u32 v26, v160, v164, v26
    v_mfma_f32_32x32x16_bf16 v[192:207], v[164:167], a[72:75], v[192:207]
    buffer_load_dwordx4 v[160:163], v1, s[24:27], s52 offen offset:2048 sc1
    v_cos_f32 v95, v87
    v_sin_f32 v96, v80
    v_sin_f32 v97, v81
    v_mfma_f32_32x32x16_bf16 v[208:223], v[164:167], a[76:79], v[208:223]
    v_sin_f32 v98, v82
    v_sin_f32 v99, v83
    s_waitcnt vmcnt(8)
    v_mfma_f32_32x32x16_bf16 v[192:207], v[128:131], a[80:83], v[192:207]
    buffer_load_dwordx4 v[164:167], v1, s[24:27], s52 offen offset:3072 sc1
    s_barrier
    v_mov_b32 v24, 3
    v_mov_b32 v25, 9240576
    buffer_store_byte v24, v25, s[24:27], s4 offen sc1
    v_sin_f32 v100, v84
    v_sin_f32 v101, v85
    v_sin_f32 v102, v86
    v_mfma_f32_32x32x16_bf16 v[208:223], v[128:131], a[84:87], v[208:223]
    v_sin_f32 v103, v87
    v_cvt_pk_bf16_f32 v104, v88, v89
    s_waitcnt vmcnt(9)
    v_max3_u32 v26, v128, v132, v26
    v_mfma_f32_32x32x16_bf16 v[192:207], v[132:135], a[88:91], v[192:207]
    buffer_load_dwordx4 v[128:131], v1, s[24:27], s53 offen offset:0 sc1
    v_cvt_pk_bf16_f32 v105, v90, v91
    v_cvt_pk_bf16_f32 v106, v92, v93
    v_cvt_pk_bf16_f32 v107, v94, v95
    v_mfma_f32_32x32x16_bf16 v[208:223], v[132:135], a[92:95], v[208:223]
    v_cvt_pk_bf16_f32 v108, v96, v97
    v_cvt_pk_bf16_f32 v109, v98, v99
    s_waitcnt vmcnt(9)
    v_mfma_f32_32x32x16_bf16 v[192:207], v[136:139], a[96:99], v[192:207]
    buffer_load_dwordx4 v[132:135], v1, s[24:27], s53 offen offset:1024 sc1
    v_cvt_pk_bf16_f32 v110, v100, v101
    v_cvt_pk_bf16_f32 v111, v102, v103
    v_xor_b32 v112, 0x80008000, v108
    v_mfma_f32_32x32x16_bf16 v[208:223], v[136:139], a[100:103], v[208:223]
    v_xor_b32 v113, 0x80008000, v109
    v_xor_b32 v114, 0x80008000, v110
    s_waitcnt vmcnt(9)
    v_max3_u32 v26, v136, v140, v26
    v_mfma_f32_32x32x16_bf16 v[192:207], v[140:143], a[104:107], v[192:207]
    buffer_load_dwordx4 v[136:139], v1, s[24:27], s53 offen offset:2048 sc1
    v_xor_b32 v115, 0x80008000, v111
    ds_write_b128 v36, v[104:107] offset:0
    ds_write_b128 v36, v[108:111] offset:2048
    v_mfma_f32_32x32x16_bf16 v[208:223], v[140:143], a[108:111], v[208:223]
    ds_write_b128 v36, v[112:115] offset:4096
    v_mul_f32 v34, 0x3a000000, v32
    s_waitcnt vmcnt(9)
    v_mfma_f32_32x32x16_bf16 v[192:207], v[144:147], a[112:115], v[192:207]
    buffer_load_dwordx4 v[140:143], v1, s[24:27], s53 offen offset:3072 sc1
    s_lshl_b32 s3, s42, 4
    v_lshl_add_u32 v35, v33, 2, s3
    v_cvt_f32_u32 v35, v35
    v_mfma_f32_32x32x16_bf16 v[208:223], v[144:147], a[116:119], v[208:223]
    v_mul_f32 v80, v35, v34
    v_add_f32 v39, 0x3f800000, v35
    s_waitcnt vmcnt(9)
    v_max3_u32 v26, v144, v148, v26
    v_mfma_f32_32x32x16_bf16 v[192:207], v[148:151], a[120:123], v[192:207]
    buffer_load_dwordx4 v[144:147], v1, s[24:27], s54 offen offset:0 sc1
    v_mul_f32 v81, v39, v34
    v_add_f32 v39, 0x40000000, v35
    v_mfma_f32_32x32x16_bf16 v[208:223], v[148:151], a[124:127], v[208:223]
    v_mul_f32 v82, v39, v34
    v_add_f32 v39, 0x40400000, v35
    v_mul_f32 v83, v39, v34
    s_waitcnt vmcnt(9)
    v_mfma_f32_32x32x16_bf16 v[192:207], v[152:155], a[128:131], v[192:207]
    buffer_load_dwordx4 v[148:151], v1, s[24:27], s54 offen offset:1024 sc1
    v_add_f32 v39, 0x41000000, v35
    v_mul_f32 v84, v39, v34
    v_mfma_f32_32x32x16_bf16 v[208:223], v[152:155], a[132:135], v[208:223]
    v_add_f32 v39, 0x41100000, v35
    v_mul_f32 v85, v39, v34
    v_add_f32 v39, 0x41200000, v35
    s_waitcnt vmcnt(9)
    v_max3_u32 v26, v152, v156, v26
    v_mfma_f32_32x32x16_bf16 v[192:207], v[156:159], a[136:139], v[192:207]
    buffer_load_dwordx4 v[152:155], v1, s[24:27], s54 offen offset:2048 sc1
    v_mul_f32 v86, v39, v34
    v_add_f32 v39, 0x41300000, v35
    v_mfma_f32_32x32x16_bf16 v[208:223], v[156:159], a[140:143], v[208:223]
    v_mul_f32 v87, v39, v34
    v_cos_f32 v88, v80
    v_cos_f32 v89, v81
    s_waitcnt vmcnt(9)
    v_mfma_f32_32x32x16_bf16 v[192:207], v[160:163], a[144:147], v[192:207]
    buffer_load_dwordx4 v[156:159], v1, s[24:27], s54 offen offset:3072 sc1
    v_cos_f32 v90, v82
    v_cos_f32 v91, v83
    v_mfma_f32_32x32x16_bf16 v[208:223], v[160:163], a[148:151], v[208:223]
    v_cos_f32 v92, v84
    v_cos_f32 v93, v85
    v_cos_f32 v94, v86
    s_waitcnt vmcnt(9)
    v_max3_u32 v26, v160, v164, v26
    v_mfma_f32_32x32x16_bf16 v[192:207], v[164:167], a[152:155], v[192:207]
    buffer_load_dwordx4 v[160:163], v1, s[24:27], s55 offen offset:0 sc1
    v_cos_f32 v95, v87
    v_sin_f32 v96, v80
    v_mfma_f32_32x32x16_bf16 v[208:223], v[164:167], a[156:159], v[208:223]
    v_sin_f32 v97, v81
    v_sin_f32 v98, v82
    v_sin_f32 v99, v83
    s_waitcnt vmcnt(8)
    v_mfma_f32_32x32x16_bf16 v[192:207], v[128:131], a[160:163], v[192:207]
    buffer_load_dwordx4 v[164:167], v1, s[24:27], s55 offen offset:1024 sc1
    v_sin_f32 v100, v84
    v_sin_f32 v101, v85
    v_mfma_f32_32x32x16_bf16 v[208:223], v[128:131], a[164:167], v[208:223]
    v_sin_f32 v102, v86
    v_sin_f32 v103, v87
    ds_write_b128 v37, v[88:91] offset:6144
    s_waitcnt vmcnt(8)
    v_max3_u32 v26, v128, v132, v26
    v_mfma_f32_32x32x16_bf16 v[192:207], v[132:135], a[168:171], v[192:207]
    buffer_load_dwordx4 v[128:131], v1, s[24:27], s55 offen offset:2048 sc1
    ds_write_b128 v37, v[96:99] offset:7168
    ds_write_b128 v37, v[92:95] offset:8192
    v_mfma_f32_32x32x16_bf16 v[208:223], v[132:135], a[172:175], v[208:223]
    ds_write_b128 v37, v[100:103] offset:9216
    v_mul_f32 v34, 0x3c800000, v32
    s_lshl_b32 s3, s43, 5
    s_waitcnt vmcnt(8)
    v_mfma_f32_32x32x16_bf16 v[192:207], v[136:139], a[176:179], v[192:207]
    buffer_load_dwordx4 v[132:135], v1, s[24:27], s55 offen offset:3072 sc1
    s_add_u32 s3, s3, s44
    v_lshl_add_u32 v35, v33, 2, s3
    v_mfma_f32_32x32x16_bf16 v[208:223], v[136:139], a[180:183], v[208:223]
    v_cvt_f32_u32 v35, v35
    v_mul_f32 v80, v35, v34
    v_add_f32 v39, 0x40000000, v35
    s_waitcnt vmcnt(8)
    v_max3_u32 v26, v136, v140, v26
    v_mfma_f32_32x32x16_bf16 v[192:207], v[140:143], a[184:187], v[192:207]
    buffer_load_dwordx4 v[136:139], v2, s[24:27], s48 offen offset:0 sc1
    v_mul_f32 v81, v39, v34
    v_add_f32 v39, 0x41000000, v35
    v_mfma_f32_32x32x16_bf16 v[208:223], v[140:143], a[188:191], v[208:223]
    v_mul_f32 v82, v39, v34
    v_add_f32 v39, 0x41200000, v35
    v_mul_f32 v83, v39, v34
    s_waitcnt vmcnt(8)
    v_mfma_f32_32x32x16_bf16 v[192:207], v[144:147], a[192:195], v[192:207]
    buffer_load_dwordx4 v[140:143], v2, s[24:27], s48 offen offset:1024 sc1
    v_add_f32 v39, 0x41800000, v35
    v_mul_f32 v84, v39, v34
    v_mfma_f32_32x32x16_bf16 v[208:223], v[144:147], a[196:199], v[208:223]
    v_add_f32 v39, 0x41900000, v35
    v_mul_f32 v85, v39, v34
    v_add_f32 v39, 0x41c00000, v35
    s_waitcnt vmcnt(8)
    v_max3_u32 v26, v144, v148, v26
    v_mfma_f32_32x32x16_bf16 v[192:207], v[148:151], a[200:203], v[192:207]
    buffer_load_dwordx4 v[144:147], v2, s[24:27], s48 offen offset:2048 sc1
    v_mul_f32 v86, v39, v34
    v_add_f32 v39, 0x41d00000, v35
    v_mfma_f32_32x32x16_bf16 v[208:223], v[148:151], a[204:207], v[208:223]
    v_mul_f32 v87, v39, v34
    v_cos_f32 v40, v80
    v_cos_f32 v41, v81
    s_waitcnt vmcnt(8)
    v_mfma_f32_32x32x16_bf16 v[192:207], v[152:155], a[208:211], v[192:207]
    buffer_load_dwordx4 v[148:151], v2, s[24:27], s48 offen offset:3072 sc1
    v_cos_f32 v42, v82
    v_cos_f32 v43, v83
    v_mfma_f32_32x32x16_bf16 v[208:223], v[152:155], a[212:215], v[208:223]
    v_cos_f32 v44, v84
    v_cos_f32 v45, v85
    v_cos_f32 v46, v86
    s_waitcnt vmcnt(8)
    v_max3_u32 v26, v152, v156, v26
    v_mfma_f32_32x32x16_bf16 v[192:207], v[156:159], a[216:219], v[192:207]
    buffer_load_dwordx4 v[152:155], v2, s[24:27], s49 offen offset:0 sc1
    v_cos_f32 v47, v87
    v_sin_f32_e64 v48, -v80
    v_mfma_f32_32x32x16_bf16 v[208:223], v[156:159], a[220:223], v[208:223]
    v_sin_f32_e64 v49, -v81
    v_sin_f32_e64 v50, -v82
    v_sin_f32_e64 v51, -v83
    s_waitcnt vmcnt(8)
    v_mfma_f32_32x32x16_bf16 v[192:207], v[160:163], a[224:227], v[192:207]
    buffer_load_dwordx4 v[156:159], v2, s[24:27], s49 offen offset:1024 sc1
    v_sin_f32_e64 v52, -v84
    v_sin_f32_e64 v53, -v85
    v_mfma_f32_32x32x16_bf16 v[208:223], v[160:163], a[228:231], v[208:223]
    v_sin_f32_e64 v54, -v86
    v_sin_f32_e64 v55, -v87
    v_cvt_pk_bf16_f32 v116, v40, v41
    s_waitcnt vmcnt(8)
    v_max3_u32 v26, v160, v164, v26
    v_mfma_f32_32x32x16_bf16 v[192:207], v[164:167], a[232:235], v[192:207]
    buffer_load_dwordx4 v[160:163], v2, s[24:27], s49 offen offset:2048 sc1
    v_cvt_pk_bf16_f32 v117, v42, v43
    v_cvt_pk_bf16_f32 v118, v44, v45
    v_mfma_f32_32x32x16_bf16 v[208:223], v[164:167], a[236:239], v[208:223]
    v_cvt_pk_bf16_f32 v119, v46, v47
    v_cvt_pk_bf16_f32 v120, v48, v49
    v_cvt_pk_bf16_f32 v121, v50, v51
    s_waitcnt vmcnt(8)
    v_mfma_f32_32x32x16_bf16 v[192:207], v[128:131], a[240:243], v[192:207]
    buffer_load_dwordx4 v[164:167], v2, s[24:27], s49 offen offset:3072 sc1
    v_cvt_pk_bf16_f32 v122, v52, v53
    v_cvt_pk_bf16_f32 v123, v54, v55
    v_mfma_f32_32x32x16_bf16 v[208:223], v[128:131], a[244:247], v[208:223]
    ds_write_b128 v38, v[116:119] offset:22528
    ds_write_b128 v38, v[120:123] offset:23552
    s_waitcnt vmcnt(8)
    v_max3_u32 v26, v128, v132, v26
    v_mfma_f32_32x32x16_bf16 v[192:207], v[132:135], a[248:251], v[192:207]
    buffer_load_dwordx4 v[128:131], v2, s[24:27], s50 offen offset:0 sc1
    v_mfma_f32_32x32x16_bf16 v[208:223], v[132:135], a[252:255], v[208:223]
    v_cmp_eq_u32 vcc, -1, v26
    s_cbranch_vccnz L_slowB0
L_retB0:
    s_waitcnt vmcnt(8)
    v_mfma_f32_32x32x16_bf16 v[224:239], v[136:139], a[0:3], 0
    buffer_load_dwordx4 v[132:135], v2, s[24:27], s50 offen offset:1024 sc1
    v_and_b32 v40, 12, v0
    v_and_b32 v41, 15, v0
    v_add_u32 v40, v40, v41
    v_mfma_f32_32x32x16_bf16 v[240:255], v[136:139], a[4:7], 0
    s_lshl_b32 s3, s43, 5
    s_lshl_b32 s7, s44, 2
    v_mul_u32_u24 v25, 260, v0
    v_and_b32 v25, 0x3e04, v25
    v_or_b32 v25, 9240576, v25
    buffer_load_dword v30, v25, s[24:27], 0 offen sc1
    s_waitcnt vmcnt(9)
    v_max_u32 v27, v136, v140
    v_mfma_f32_32x32x16_bf16 v[224:239], v[140:143], a[8:11], v[224:239]
    buffer_load_dwordx4 v[136:139], v2, s[24:27], s50 offen offset:2048 sc1
    ds_write_b128 v4, v[192:195] offset:0
    s_add_u32 s3, s3, s7
    v_add_u32 v40, s3, v40
    v_mfma_f32_32x32x16_bf16 v[240:255], v[140:143], a[12:15], v[240:255]
    ds_write_b128 v4, v[196:199] offset:1024
    v_lshrrev_b32 v41, 4, v0
    v_lshlrev_b32 v42, 10, v40
    v_and_b32 v43, 1, v41
    s_waitcnt vmcnt(9)
    v_mfma_f32_32x32x16_bf16 v[224:239], v[144:147], a[16:19], v[224:239]
    buffer_load_dwordx4 v[140:143], v2, s[24:27], s50 offen offset:3072 sc1
    ds_write_b128 v4, v[200:203] offset:2048
    v_lshl_add_u32 v42, v43, 5, v42
    v_lshrrev_b32 v44, 1, v41
    v_mfma_f32_32x32x16_bf16 v[240:255], v[144:147], a[20:23], v[240:255]
    ds_write_b128 v4, v[204:207] offset:3072
    v_lshl_add_u32 v9, v44, 4, v42
    s_lshl_b32 s64, s40, 16
    s_waitcnt vmcnt(9)
    v_max3_u32 v27, v144, v148, v27
    v_mfma_f32_32x32x16_bf16 v[224:239], v[148:151], a[24:27], v[224:239]
    buffer_load_dwordx4 v[144:147], v2, s[24:27], s51 offen offset:0 sc1
    ds_write_b128 v4, v[208:211] offset:4096
    s_add_u32 s64, s64, s98
    s_mul_i32 s65, s40, 90112
    v_mfma_f32_32x32x16_bf16 v[240:255], v[148:151], a[28:31], v[240:255]
    ds_write_b128 v4, v[212:215] offset:5120
    s_lshl_b32 s3, s42, 10
    s_add_u32 s65, s65, s3
    s_add_u32 s65, s65, 2883584
    s_waitcnt vmcnt(9)
    v_mfma_f32_32x32x16_bf16 v[224:239], v[152:155], a[32:35], v[224:239]
    buffer_load_dwordx4 v[148:151], v2, s[24:27], s51 offen offset:1024 sc1
    ds_write_b128 v4, v[216:219] offset:6144
    s_add_u32 s79, s65, 4096
    s_lshl_b32 s3, s41, 4
    v_mfma_f32_32x32x16_bf16 v[240:255], v[152:155], a[36:39], v[240:255]
    ds_write_b128 v4, v[220:223] offset:7168
    s_sub_u32 s7, 124, s3
    s_cmp_ge_u32 s41, 4
    s_cselect_b32 s3, s7, s3
    s_cselect_b32 s7, -1, 0
    s_cselect_b32 s68, 0, 0xffffc000
    s_waitcnt vmcnt(9)
    v_max3_u32 v27, v152, v156, v27
    v_mfma_f32_32x32x16_bf16 v[224:239], v[156:159], a[40:43], v[224:239]
    buffer_load_dwordx4 v[152:155], v2, s[24:27], s51 offen offset:2048 sc1
    s_xor_b32 s67, s7, 0x10000
    s_sub_u32 s67, s67, s7
    v_mfma_f32_32x32x16_bf16 v[240:255], v[156:159], a[44:47], v[240:255]
    s_lshl_b32 s3, s3, 14
    s_add_u32 s66, s3, 7864320
    s_lshl_b32 s3, s40, 6
    s_waitcnt vmcnt(9)
    v_mfma_f32_32x32x16_bf16 v[224:239], v[160:163], a[48:51], v[224:239]
    buffer_load_dwordx4 v[156:159], v2, s[24:27], s51 offen offset:3072 sc1
    v_add_u32 v40, s3, v40
    v_xor_b32 v40, s7, v40
    v_mfma_f32_32x32x16_bf16 v[240:255], v[160:163], a[52:55], v[240:255]
    v_subrev_u32 v40, s7, v40
    v_and_b32 v40, 0x7ff, v40
    s_waitcnt vmcnt(9)
    v_max3_u32 v27, v160, v164, v27
    v_mfma_f32_32x32x16_bf16 v[224:239], v[164:167], a[56:59], v[224:239]
    buffer_load_dwordx4 v[160:163], v2, s[24:27], s52 offen offset:0 sc1
    s_waitcnt lgkmcnt(0)
    s_barrier
    ds_read_b128 v[80:83], v5 offset:0
    v_xor_b32 v42, s7, v41
    v_and_b32 v42, 3, v42
    v_lshlrev_b32 v42, 14, v42
    v_mfma_f32_32x32x16_bf16 v[240:255], v[164:167], a[60:63], v[240:255]
    ds_read_b128 v[84:87], v5 offset:256
    v_lshrrev_b32 v44, 6, v40
    v_lshl_add_u32 v42, v44, 9, v42
    s_waitcnt vmcnt(9)
    v_mfma_f32_32x32x16_bf16 v[224:239], v[128:131], a[64:67], v[224:239]
    buffer_load_dwordx4 v[164:167], v2, s[24:27], s52 offen offset:1024 sc1
    ds_read_b128 v[88:91], v5 offset:8192
    v_and_b32 v44, 3, v40
    v_lshl_add_u32 v42, v44, 3, v42
    v_mfma_f32_32x32x16_bf16 v[240:255], v[128:131], a[68:71], v[240:255]
    ds_read_b128 v[92:95], v5 offset:8448
    v_bfe_u32 v44, v40, 2, 1
    v_lshl_add_u32 v42, v44, 7, v42
    s_waitcnt vmcnt(9)
    v_max3_u32 v27, v128, v132, v27
    v_mfma_f32_32x32x16_bf16 v[224:239], v[132:135], a[72:75], v[224:239]
    buffer_load_dwordx4 v[128:131], v2, s[24:27], s52 offen offset:2048 sc1
    ds_read_b128 v[96:99], v5 offset:16384
    v_bfe_u32 v44, v40, 3, 2
    v_lshl_add_u32 v42, v44, 5, v42
    v_bfe_u32 v44, v40, 5, 1
    v_mfma_f32_32x32x16_bf16 v[240:255], v[132:135], a[76:79], v[240:255]
    ds_read_b128 v[100:103], v5 offset:16640
    v_lshl_add_u32 v10, v44, 8, v42
    v_bfe_u32 v40, v0, 2, 2
    s_waitcnt vmcnt(8)
    v_mfma_f32_32x32x16_bf16 v[224:239], v[136:139], a[80:83], v[224:239]
    buffer_load_dwordx4 v[132:135], v2, s[24:27], s52 offen offset:3072 sc1
    ds_read_b128 v[104:107], v5 offset:24576
    v_lshl_add_u32 v42, v41, 3, v40
    v_lshlrev_b32 v42, 7, v42
    v_mfma_f32_32x32x16_bf16 v[240:255], v[136:139], a[84:87], v[240:255]
    ds_read_b128 v[108:111], v5 offset:24832
    v_lshrrev_b32 v44, 1, v40
    v_lshl_add_u32 v44, v43, 1, v44
L_d2B_chk:
    v_and_b32 v30, 0x02020202, v30
    v_cmp_ne_u32 vcc, 0x02020202, v30
    s_cbranch_vccnz L_d2B_retry
L_d2B_ok:
    s_waitcnt vmcnt(8)
    v_max3_u32 v27, v136, v140, v27
    v_mfma_f32_32x32x16_bf16 v[224:239], v[140:143], a[88:91], v[224:239]
    buffer_load_dwordx4 v[136:139], v2, s[24:27], s53 offen offset:0 sc1
    s_waitcnt lgkmcnt(4)
    v_add_f32 v80, v80, v88
    v_lshl_add_u32 v42, v44, 5, v42
    v_and_b32 v44, 3, v0
    v_lshl_add_u32 v42, v44, 3, v42
    v_mfma_f32_32x32x16_bf16 v[240:255], v[140:143], a[92:95], v[240:255]
    v_add_f32 v81, v81, v89
    v_add_f32 v82, v82, v90
    v_add_u32 v13, 114688, v42
    v_xor_b32 v14, 32, v13
    s_waitcnt vmcnt(8)
    v_mfma_f32_32x32x16_bf16 v[224:239], v[144:147], a[96:99], v[224:239]
    buffer_load_dwordx4 v[140:143], v2, s[24:27], s53 offen offset:1024 sc1
    v_add_f32 v83, v83, v91
    v_add_f32 v84, v84, v92
    v_xor_b32 v15, 64, v13
    v_xor_b32 v16, 0x60, v13
    v_mfma_f32_32x32x16_bf16 v[240:255], v[144:147], a[100:103], v[240:255]
    v_add_f32 v85, v85, v93
    v_add_f32 v86, v86, v94
    s_and_b32 s3, s40, 3
    s_lshl_b32 s3, s3, 8
    v_xor_b32 v42, s42, v44
    s_waitcnt vmcnt(8)
    v_max3_u32 v27, v144, v148, v27
    v_mfma_f32_32x32x16_bf16 v[224:239], v[148:151], a[104:107], v[224:239]
    buffer_load_dwordx4 v[144:147], v2, s[24:27], s53 offen offset:2048 sc1
    v_add_f32 v87, v87, v95
    v_add_f32 v80, v80, v28
    v_lshl_add_u32 v42, v42, 4, s3
    v_lshl_add_u32 v42, v40, 6, v42
    v_mfma_f32_32x32x16_bf16 v[240:255], v[148:151], a[108:111], v[240:255]
    v_add_f32 v81, v81, v28
    v_add_f32 v82, v82, v28
    v_lshl_add_u32 v11, v41, 10, v42
    s_sub_u32 s3, s41, 6
    s_waitcnt vmcnt(8)
    v_mfma_f32_32x32x16_bf16 v[224:239], v[152:155], a[112:115], v[224:239]
    buffer_load_dwordx4 v[148:151], v2, s[24:27], s53 offen offset:3072 sc1
    v_add_f32 v83, v83, v28
    v_add_f32 v84, v84, v29
    s_lshl_b32 s3, s3, 3
    s_lshr_b32 s7, s40, 2
    v_mfma_f32_32x32x16_bf16 v[240:255], v[152:155], a[116:119], v[240:255]
    v_add_f32 v85, v85, v29
    v_add_f32 v86, v86, v29
    s_add_u32 s3, s3, s7
    s_lshl_b32 s3, s3, 17
    s_lshl_b32 s7, s42, 12
    s_waitcnt vmcnt(8)
    v_max3_u32 v27, v152, v156, v27
    v_mfma_f32_32x32x16_bf16 v[224:239], v[156:159], a[120:123], v[224:239]
    buffer_load_dwordx4 v[152:155], v2, s[24:27], s54 offen offset:0 sc1
    v_add_f32 v87, v87, v29
    s_waitcnt lgkmcnt(0)
    s_add_u32 s3, s3, s7
    s_add_u32 s69, s3, 5767168
    v_mfma_f32_32x32x16_bf16 v[240:255], v[156:159], a[124:127], v[240:255]
    v_add_f32 v96, v96, v104
    v_add_f32 v97, v97, v105
    s_lshl_b32 s3, s42, 10
    s_add_u32 s3, s3, 32768
    s_waitcnt vmcnt(8)
    v_mfma_f32_32x32x16_bf16 v[224:239], v[160:163], a[128:131], v[224:239]
    buffer_load_dwordx4 v[156:159], v2, s[24:27], s54 offen offset:1024 sc1
    v_add_f32 v98, v98, v106
    v_add_f32 v99, v99, v107
    v_add_u32 v12, s3, v1
    v_lshrrev_b32 v32, 5, v0
    v_mfma_f32_32x32x16_bf16 v[240:255], v[160:163], a[132:135], v[240:255]
    v_add_f32 v100, v100, v108
    v_add_f32 v101, v101, v109
    v_lshl_add_u32 v42, v32, 3, v40
    v_lshlrev_b32 v42, 10, v42
    v_lshrrev_b32 v33, 1, v44
    s_waitcnt vmcnt(8)
    v_max3_u32 v27, v160, v164, v27
    v_mfma_f32_32x32x16_bf16 v[224:239], v[164:167], a[136:139], v[224:239]
    buffer_load_dwordx4 v[160:163], v2, s[24:27], s54 offen offset:2048 sc1
    v_add_f32 v102, v102, v110
    v_add_f32 v103, v103, v111
    v_lshl_add_u32 v33, v43, 1, v33
    v_lshl_add_u32 v42, v33, 6, v42
    v_mfma_f32_32x32x16_bf16 v[240:255], v[164:167], a[140:143], v[240:255]
    v_add_f32 v80, v80, v96
    v_add_f32 v81, v81, v97
    v_xor_b32 v33, s42, v40
    v_lshl_add_u32 v42, v33, 4, v42
    s_waitcnt vmcnt(8)
    v_mfma_f32_32x32x16_bf16 v[224:239], v[128:131], a[144:147], v[224:239]
    buffer_load_dwordx4 v[164:167], v2, s[24:27], s54 offen offset:3072 sc1
    v_add_f32 v82, v82, v98
    v_add_f32 v83, v83, v99
    v_and_b32 v33, 1, v44
    v_lshl_add_u32 v42, v33, 3, v42
    v_add_u32 v21, 32768, v42
    v_mfma_f32_32x32x16_bf16 v[240:255], v[128:131], a[148:151], v[240:255]
    v_add_f32 v84, v84, v100
    v_add_f32 v85, v85, v101
    v_lshlrev_b32 v33, 3, v44
    v_lshl_add_u32 v33, v32, 10, v33
    s_waitcnt vmcnt(8)
    v_max3_u32 v27, v128, v132, v27
    v_mfma_f32_32x32x16_bf16 v[224:239], v[132:135], a[152:155], v[224:239]
    buffer_load_dwordx4 v[128:131], v2, s[24:27], s55 offen offset:0 sc1
    v_add_f32 v86, v86, v102
    v_add_f32 v87, v87, v103
    v_bfe_u32 v42, v0, 2, 1
    v_lshl_add_u32 v33, v42, 7, v33
    v_mfma_f32_32x32x16_bf16 v[240:255], v[132:135], a[156:159], v[240:255]
    v_mul_f32 v80, v80, v56
    v_mul_f32 v81, v81, v57
    v_bfe_u32 v42, v0, 3, 2
    v_lshl_add_u32 v23, v42, 5, v33
    s_waitcnt vmcnt(8)
    v_mfma_f32_32x32x16_bf16 v[224:239], v[136:139], a[160:163], v[224:239]
    buffer_load_dwordx4 v[132:135], v2, s[24:27], s55 offen offset:1024 sc1
    v_mul_f32 v82, v82, v58
    v_mul_f32 v83, v83, v59
    s_mov_b32 s70, 0x05040100
    s_mov_b32 s71, 0x07060302
    s_sub_u32 s3, s41, 6
    v_mfma_f32_32x32x16_bf16 v[240:255], v[136:139], a[164:167], v[240:255]
    v_mul_f32 v84, v84, v60
    v_mul_f32 v85, v85, v61
    s_lshl_b32 s3, s3, 5
    s_add_u32 s3, s3, s40
    s_waitcnt vmcnt(8)
    v_max3_u32 v27, v136, v140, v27
    v_mfma_f32_32x32x16_bf16 v[224:239], v[140:143], a[168:171], v[224:239]
    buffer_load_dwordx4 v[136:139], v2, s[24:27], s55 offen offset:2048 sc1
    v_mul_f32 v86, v86, v62
    v_mul_f32_e64 v87, v87, v63
    s_lshl_b32 s3, s3, 2
    s_add_u32 s3, s3, s42
    v_mfma_f32_32x32x16_bf16 v[240:255], v[140:143], a[172:175], v[240:255]
    v_cvt_pk_bf16_f32 v112, v80, v81
    v_cvt_pk_bf16_f32 v113, v82, v83
    s_lshl_b32 s3, s3, 12
    s_add_u32 s99, s3, 7864320
    s_waitcnt vmcnt(8)
    v_mfma_f32_32x32x16_bf16 v[224:239], v[144:147], a[176:179], v[224:239]
    buffer_load_dwordx4 v[140:143], v2, s[24:27], s55 offen offset:3072 sc1
    v_cvt_pk_bf16_f32 v114, v84, v85
    v_cvt_pk_bf16_f32 v115, v86, v87
    v_mfma_f32_32x32x16_bf16 v[240:255], v[144:147], a[180:183], v[240:255]
    v_permlane16_swap_b32 v112, v114
    v_permlane16_swap_b32 v113, v115
    s_waitcnt vmcnt(8)
    v_max3_u32 v27, v144, v148, v27
    v_mfma_f32_32x32x16_bf16 v[224:239], v[148:151], a[184:187], v[224:239]
    s_add_u32 s5, s69, 0
    buffer_load_dwordx4 v[32:35], v11, s[24:27], s5 offen sc1
    buffer_store_dwordx4 v[112:115], v22, s[24:27], s80 offen sc1
    v_mfma_f32_32x32x16_bf16 v[240:255], v[148:151], a[188:191], v[240:255]
    s_waitcnt vmcnt(9)
    v_mfma_f32_32x32x16_bf16 v[224:239], v[152:155], a[192:195], v[224:239]
    s_add_u32 s5, s69, 16384
    buffer_load_dwordx4 v[36:39], v11, s[24:27], s5 offen sc1
    v_mfma_f32_32x32x16_bf16 v[240:255], v[152:155], a[196:199], v[240:255]
    s_waitcnt vmcnt(9)
    v_max3_u32 v27, v152, v156, v27
    v_mfma_f32_32x32x16_bf16 v[224:239], v[156:159], a[200:203], v[224:239]
    s_add_u32 s5, s69, 32768
    buffer_load_dwordx4 v[40:43], v11, s[24:27], s5 offen sc1
    v_mfma_f32_32x32x16_bf16 v[240:255], v[156:159], a[204:207], v[240:255]
    s_waitcnt vmcnt(9)
    v_mfma_f32_32x32x16_bf16 v[224:239], v[160:163], a[208:211], v[224:239]
    s_add_u32 s5, s69, 49152
    buffer_load_dwordx4 v[44:47], v11, s[24:27], s5 offen sc1
    v_mfma_f32_32x32x16_bf16 v[240:255], v[160:163], a[212:215], v[240:255]
    s_waitcnt vmcnt(9)
    v_max3_u32 v27, v160, v164, v27
    v_mfma_f32_32x32x16_bf16 v[224:239], v[164:167], a[216:219], v[224:239]
    s_add_u32 s5, s69, 65536
    buffer_load_dwordx4 v[48:51], v11, s[24:27], s5 offen sc1
    v_mfma_f32_32x32x16_bf16 v[240:255], v[164:167], a[220:223], v[240:255]
    s_waitcnt vmcnt(9)
    v_mfma_f32_32x32x16_bf16 v[224:239], v[128:131], a[224:227], v[224:239]
    s_add_u32 s5, s69, 81920
    buffer_load_dwordx4 v[52:55], v11, s[24:27], s5 offen sc1
    v_mfma_f32_32x32x16_bf16 v[240:255], v[128:131], a[228:231], v[240:255]
    s_waitcnt vmcnt(9)
    v_max3_u32 v27, v128, v132, v27
    v_mfma_f32_32x32x16_bf16 v[224:239], v[132:135], a[232:235], v[224:239]
    s_add_u32 s5, s69, 98304
    buffer_load_dwordx4 v[116:119], v11, s[24:27], s5 offen sc1
    v_mfma_f32_32x32x16_bf16 v[240:255], v[132:135], a[236:239], v[240:255]
    s_waitcnt vmcnt(9)
    v_mfma_f32_32x32x16_bf16 v[224:239], v[136:139], a[240:243], v[224:239]
    s_add_u32 s5, s69, 114688
    buffer_load_dwordx4 v[120:123], v11, s[24:27], s5 offen sc1
    v_mfma_f32_32x32x16_bf16 v[240:255], v[136:139], a[244:247], v[240:255]
    s_barrier
    s_waitcnt vmcnt(9)
    v_max3_u32 v27, v136, v140, v27
    v_mfma_f32_32x32x16_bf16 v[224:239], v[140:143], a[248:251], v[224:239]
    v_mfma_f32_32x32x16_bf16 v[240:255], v[140:143], a[252:255], v[240:255]
    v_cmp_eq_u32_e64 vcc, -1, v27
    s_cbranch_vccnz L_slowB1
L_retB1:
    s_nop 7
    s_nop 0
    ds_write_b128 v4, v[224:227] offset:0
    ds_write_b128 v4, v[228:231] offset:1024
    ds_write_b128 v4, v[232:235] offset:2048
    ds_write_b128 v4, v[236:239] offset:3072
    ds_write_b128 v4, v[240:243] offset:4096
    s_add_u32 m0, s90, 69632
    s_lshl3_add_u32 s5, s62, s98
    buffer_load_dwordx4 v6, s[20:23], s5 offen lds
    ds_write_b128 v4, v[244:247] offset:5120
    s_add_u32 m0, s90, 73728
    s_lshl3_add_u32 s5, s63, s98
    buffer_load_dwordx4 v6, s[20:23], s5 offen lds
    ds_write_b128 v4, v[248:251] offset:6144
    s_add_u32 m0, s90, 81920
    s_lshl3_add_u32 s5, s57, s98
    s_add_u32 s5, s5, 32768
    buffer_load_dwordx4 v6, s[20:23], s5 offen lds
    ds_write_b128 v4, v[252:255] offset:7168
    s_add_u32 m0, s90, 86016
    s_lshl3_add_u32 s5, s58, s98
    s_add_u32 s5, s5, 32768
    buffer_load_dwordx4 v6, s[20:23], s5 offen lds
    s_waitcnt lgkmcnt(0)
    s_barrier
    ds_read_b128 v[80:83], v5 offset:0
    ds_read_b128 v[84:87], v5 offset:256
    ds_read_b128 v[88:91], v5 offset:8192
    ds_read_b128 v[92:95], v5 offset:8448
    ds_read_b128 v[96:99], v5 offset:16384
    ds_read_b128 v[100:103], v5 offset:16640
    ds_read_b128 v[104:107], v5 offset:24576
    ds_read_b128 v[108:111], v5 offset:24832
    s_mov_b32 m0, s90
    s_lshl3_add_u32 s5, s59, s98
    s_add_u32 s5, s5, 32768
    buffer_load_dwordx4 v6, s[20:23], s5 offen lds
    s_add_u32 m0, s90, 4096
    s_lshl3_add_u32 s5, s60, s98
    s_add_u32 s5, s5, 32768
    buffer_load_dwordx4 v6, s[20:23], s5 offen lds
    s_waitcnt lgkmcnt(4)
    v_pk_add_f32 v[80:81], v[80:81], v[88:89]
    v_pk_add_f32 v[82:83], v[82:83], v[90:91]
    v_pk_add_f32 v[84:85], v[84:85], v[92:93]
    v_pk_add_f32 v[86:87], v[86:87], v[94:95]
    s_add_u32 m0, s90, 8192
    s_lshl3_add_u32 s5, s61, s98
    s_add_u32 s5, s5, 32768
    buffer_load_dwordx4 v6, s[20:23], s5 offen lds
    v_pk_add_f32 v[80:81], v[80:81], v[28:29] op_sel:[0,0] op_sel_hi:[1,0]
    v_pk_add_f32 v[82:83], v[82:83], v[28:29] op_sel:[0,0] op_sel_hi:[1,0]
    v_pk_add_f32 v[84:85], v[84:85], v[28:29] op_sel:[0,1] op_sel_hi:[1,1]
    v_pk_add_f32 v[86:87], v[86:87], v[28:29] op_sel:[0,1] op_sel_hi:[1,1]
    s_waitcnt lgkmcnt(0)
    v_pk_add_f32 v[96:97], v[96:97], v[104:105]
    v_pk_add_f32 v[98:99], v[98:99], v[106:107]
    v_pk_add_f32 v[100:101], v[100:101], v[108:109]
    v_pk_add_f32 v[102:103], v[102:103], v[110:111]
    v_pk_add_f32 v[80:81], v[80:81], v[96:97]
    v_pk_add_f32 v[82:83], v[82:83], v[98:99]
    v_pk_add_f32 v[84:85], v[84:85], v[100:101]
    v_pk_add_f32 v[86:87], v[86:87], v[102:103]
    v_pk_mul_f32 v[80:81], v[80:81], v[64:65]
    v_pk_mul_f32 v[82:83], v[82:83], v[66:67]
    v_pk_mul_f32 v[84:85], v[84:85], v[68:69]
    s_add_u32 m0, s90, 12288
    s_lshl3_add_u32 s5, s62, s98
    s_add_u32 s5, s5, 32768
    buffer_load_dwordx4 v6, s[20:23], s5 offen lds
    v_pk_mul_f32 v[86:87], v[86:87], v[70:71]
    v_cvt_pk_bf16_f32 v112, v80, v81
    v_cvt_pk_bf16_f32 v113, v82, v83
    v_cvt_pk_bf16_f32 v114, v84, v85
    v_cvt_pk_bf16_f32 v115, v86, v87
    s_nop 0
    v_permlane16_swap_b32 v112, v114
    v_permlane16_swap_b32 v113, v115
    buffer_store_dwordx4 v[112:115], v22, s[24:27], s81 offen sc1
    ds_read_b128 a[0:3], v1 offset:0
    ds_read_b128 a[4:7], v1 offset:1024
    ds_read_b128 a[8:11], v1 offset:2048
    ds_read_b128 a[12:15], v1 offset:3072
    ds_read_b128 a[16:19], v1 offset:4096
    s_add_u32 m0, s90, 16384
    s_lshl3_add_u32 s5, s63, s98
    s_add_u32 s5, s5, 32768
    buffer_load_dwordx4 v6, s[20:23], s5 offen lds
    ds_read_b128 a[20:23], v1 offset:5120
    ds_read_b128 a[24:27], v1 offset:22528
    ds_read_b128 a[28:31], v1 offset:23552
    ds_read_b128 a[32:35], v1 offset:24576
    ds_read_b128 a[36:39], v1 offset:25600
    ds_read_b128 a[40:43], v1 offset:26624
    ds_read_b128 a[44:47], v1 offset:27648
    ds_read_b128 a[48:51], v1 offset:28672
    ds_read_b128 a[52:55], v1 offset:29696
    s_waitcnt vmcnt(10)
    s_barrier
    ds_write_b128 v12, v[32:35] offset:0
    ds_write_b128 v12, v[36:39] offset:4096
    ds_write_b128 v12, v[40:43] offset:8192
    ds_write_b128 v12, v[44:47] offset:12288
    ds_write_b128 v12, v[48:51] offset:16384
    s_add_u32 m0, s90, 20480
    s_lshl3_add_u32 s5, s75, s98
    buffer_load_dwordx4 v6, s[20:23], s5 offen lds
    ds_write_b128 v12, v[52:55] offset:20480
    ds_write_b128 v12, v[116:119] offset:24576
    ds_write_b128 v12, v[120:123] offset:28672
    s_mul_i32 s7, s43, 43008
    s_lshl_b32 s6, s44, 12
    s_add_u32 s7, s7, s6
    s_add_u32 s7, s7, 22528
    v_add_u32_e64 v11, s7, v1
    v_subrev_u32 v12, 10240, v12
    s_waitcnt lgkmcnt(0)
    s_barrier
    ds_read_b64_tr_b16 a[56:57], v21 offset:0
    ds_read_b64_tr_b16 a[58:59], v21 offset:4096
    ds_read_b64_tr_b16 a[60:61], v21 offset:256
    ds_read_b64_tr_b16 a[62:63], v21 offset:4352
    ds_read_b64_tr_b16 a[64:65], v21 offset:16384
    s_add_u32 m0, s90, 24576
    s_lshl3_add_u32 s5, s76, s98
    buffer_load_dwordx4 v6, s[20:23], s5 offen lds
    ds_read_b64_tr_b16 a[66:67], v21 offset:20480
    ds_read_b64_tr_b16 a[68:69], v21 offset:16640
    ds_read_b64_tr_b16 a[70:71], v21 offset:20736
    ds_read_b64_tr_b16 a[72:73], v21 offset:512
    ds_read_b64_tr_b16 a[74:75], v21 offset:4608
    ds_read_b64_tr_b16 a[76:77], v21 offset:768
    ds_read_b64_tr_b16 a[78:79], v21 offset:4864
    ds_read_b64_tr_b16 a[80:81], v21 offset:16896
    ds_read_b64_tr_b16 a[82:83], v21 offset:20992
    ds_read_b64_tr_b16 a[84:85], v21 offset:17152
    ds_read_b64_tr_b16 a[86:87], v21 offset:21248
    s_waitcnt lgkmcnt(12)
    v_mfma_f32_32x32x16_bf16 v[128:143], a[56:59], a[0:3], 0
    ds_read_b128 v[192:195], v1 offset:6144
    v_mfma_f32_32x32x16_bf16 v[144:159], a[56:59], a[8:11], 0
    s_add_u32 m0, s90, 28672
    s_lshl3_add_u32 s5, s84, s98
    buffer_load_dwordx4 v6, s[20:23], s5 offen lds
    ds_read_b128 v[196:199], v1 offset:7168
    v_mfma_f32_32x32x16_bf16 v[128:143], a[60:63], a[16:19], v[128:143]
    ds_read_b128 v[200:203], v1 offset:8192
    v_mfma_f32_32x32x16_bf16 v[144:159], a[60:63], a[0:3], v[144:159]
    ds_read_b128 v[204:207], v1 offset:9216
    s_waitcnt lgkmcnt(12)
    v_mfma_f32_32x32x16_bf16 v[128:143], a[64:67], a[4:7], v[128:143]
    s_add_u32 m0, s90, 32768
    s_lshl3_add_u32 s5, s88, s98
    buffer_load_dwordx4 v6, s[20:23], s5 offen lds
    ds_read_b128 v[208:211], v1 offset:10240
    v_mfma_f32_32x32x16_bf16 v[144:159], a[64:67], a[12:15], v[144:159]
    ds_read_b128 v[212:215], v1 offset:11264
    v_mfma_f32_32x32x16_bf16 v[128:143], a[68:71], a[20:23], v[128:143]
    ds_read_b128 v[216:219], v1 offset:12288
    v_mfma_f32_32x32x16_bf16 v[144:159], a[68:71], a[4:7], v[144:159]
    s_add_u32 m0, s90, 36864
    s_lshl3_add_u32 s5, s45, s98
    buffer_load_dwordx4 v6, s[20:23], s5 offen lds
    ds_read_b128 v[220:223], v1 offset:13312
    s_waitcnt lgkmcnt(12)
    v_mfma_f32_32x32x16_bf16 v[160:175], a[72:75], a[0:3], 0
    ds_read_b128 v[224:227], v1 offset:14336
    v_mfma_f32_32x32x16_bf16 v[176:191], a[72:75], a[8:11], 0
    ds_read_b128 v[228:231], v1 offset:15360
    v_mfma_f32_32x32x16_bf16 v[160:175], a[76:79], a[16:19], v[160:175]
    s_add_u32 s3, s65, s56
    buffer_load_dwordx4 a[192:195], v1, s[24:27], s3 offen sc1
    ds_read_b128 v[232:235], v1 offset:16384
    v_mfma_f32_32x32x16_bf16 v[176:191], a[76:79], a[0:3], v[176:191]
    ds_read_b128 v[236:239], v1 offset:17408
    s_waitcnt lgkmcnt(12)
    v_mfma_f32_32x32x16_bf16 v[160:175], a[80:83], a[4:7], v[160:175]
    ds_read_b128 v[240:243], v1 offset:18432
    v_mfma_f32_32x32x16_bf16 v[176:191], a[80:83], a[12:15], v[176:191]
    s_add_u32 s3, s65, s57
    buffer_load_dwordx4 a[196:199], v1, s[24:27], s3 offen sc1
    ds_read_b128 v[244:247], v1 offset:19456
    v_mfma_f32_32x32x16_bf16 v[160:175], a[84:87], a[20:23], v[160:175]
    ds_read_b128 v[248:251], v1 offset:20480
    v_mfma_f32_32x32x16_bf16 v[176:191], a[84:87], a[4:7], v[176:191]
    ds_read_b128 v[252:255], v1 offset:21504
    s_waitcnt lgkmcnt(8)
    v_pk_mul_f32 v[112:113], v[144:145], v[196:197]
    s_add_u32 s3, s65, s58
    buffer_load_dwordx4 a[200:203], v1, s[24:27], s3 offen sc1
    v_pk_mul_f32 v[114:115], v[144:145], v[192:193]
    v_pk_mul_f32 v[116:117], v[146:147], v[198:199]
    v_pk_mul_f32 v[118:119], v[146:147], v[194:195]
    v_pk_fma_f32 v[144:145], v[128:129], v[196:197], v[114:115]
    v_pk_fma_f32 v[128:129], v[128:129], v[192:193], v[112:113] neg_lo:[0,0,1] neg_hi:[0,0,1]
    v_pk_fma_f32 v[146:147], v[130:131], v[198:199], v[118:119]
    v_pk_fma_f32 v[130:131], v[130:131], v[194:195], v[116:117] neg_lo:[0,0,1] neg_hi:[0,0,1]
    v_cvt_pk_bf16_f32 v80, v128, v130
    v_cvt_pk_bf16_f32 v84, v144, v146
    v_cvt_pk_bf16_f32 v88, v129, v131
    v_cvt_pk_bf16_f32 v92, v145, v147
    v_pk_mul_f32 v[112:113], v[148:149], v[204:205]
    v_pk_mul_f32 v[114:115], v[148:149], v[200:201]
    v_pk_mul_f32 v[116:117], v[150:151], v[206:207]
    v_pk_mul_f32 v[118:119], v[150:151], v[202:203]
    v_pk_fma_f32 v[148:149], v[132:133], v[204:205], v[114:115]
    s_add_u32 s3, s65, s59
    buffer_load_dwordx4 a[204:207], v1, s[24:27], s3 offen sc1
    v_pk_fma_f32 v[132:133], v[132:133], v[200:201], v[112:113] neg_lo:[0,0,1] neg_hi:[0,0,1]
    v_pk_fma_f32 v[150:151], v[134:135], v[206:207], v[118:119]
    v_pk_fma_f32 v[134:135], v[134:135], v[202:203], v[116:117] neg_lo:[0,0,1] neg_hi:[0,0,1]
    v_cvt_pk_bf16_f32 v81, v132, v134
    v_cvt_pk_bf16_f32 v85, v148, v150
    v_cvt_pk_bf16_f32 v89, v133, v135
    v_cvt_pk_bf16_f32 v93, v149, v151
    v_pk_mul_f32 v[112:113], v[152:153], v[212:213]
    v_pk_mul_f32 v[114:115], v[152:153], v[208:209]
    v_pk_mul_f32 v[116:117], v[154:155], v[214:215]
    v_pk_mul_f32 v[118:119], v[154:155], v[210:211]
    v_pk_fma_f32 v[152:153], v[136:137], v[212:213], v[114:115]
    v_pk_fma_f32 v[136:137], v[136:137], v[208:209], v[112:113] neg_lo:[0,0,1] neg_hi:[0,0,1]
    v_pk_fma_f32 v[154:155], v[138:139], v[214:215], v[118:119]
    v_pk_fma_f32 v[138:139], v[138:139], v[210:211], v[116:117] neg_lo:[0,0,1] neg_hi:[0,0,1]
    v_cvt_pk_bf16_f32 v82, v136, v138
    s_add_u32 s3, s65, s60
    buffer_load_dwordx4 a[208:211], v1, s[24:27], s3 offen sc1
    v_cvt_pk_bf16_f32 v86, v152, v154
    v_cvt_pk_bf16_f32 v90, v137, v139
    v_cvt_pk_bf16_f32 v94, v153, v155
    v_pk_mul_f32 v[112:113], v[156:157], v[220:221]
    v_pk_mul_f32 v[114:115], v[156:157], v[216:217]
    v_pk_mul_f32 v[116:117], v[158:159], v[222:223]
    v_pk_mul_f32 v[118:119], v[158:159], v[218:219]
    v_pk_fma_f32 v[156:157], v[140:141], v[220:221], v[114:115]
    v_pk_fma_f32 v[140:141], v[140:141], v[216:217], v[112:113] neg_lo:[0,0,1] neg_hi:[0,0,1]
    v_pk_fma_f32 v[158:159], v[142:143], v[222:223], v[118:119]
    v_pk_fma_f32 v[142:143], v[142:143], v[218:219], v[116:117] neg_lo:[0,0,1] neg_hi:[0,0,1]
    v_cvt_pk_bf16_f32 v83, v140, v142
    v_cvt_pk_bf16_f32 v87, v156, v158
    v_cvt_pk_bf16_f32 v91, v141, v143
    v_cvt_pk_bf16_f32 v95, v157, v159
    v_mfma_f32_32x32x16_bf16 v[32:47], a[24:27], v[80:83], 0
    s_add_u32 s3, s65, s61
    buffer_load_dwordx4 a[212:215], v1, s[24:27], s3 offen sc1
    v_mfma_f32_32x32x16_bf16 v[48:63], a[32:35], v[88:91], 0
    v_mfma_f32_32x32x16_bf16 v[32:47], a[28:31], v[84:87], v[32:47]
    v_mfma_f32_32x32x16_bf16 v[48:63], a[36:39], v[92:95], v[48:63]
    s_add_u32 s3, s65, s62
    buffer_load_dwordx4 a[216:219], v1, s[24:27], s3 offen sc1
    s_waitcnt lgkmcnt(0)
    v_pk_mul_f32 v[112:113], v[176:177], v[228:229]
    s_add_u32 s3, s65, s63
    buffer_load_dwordx4 a[220:223], v1, s[24:27], s3 offen sc1
    v_pk_mul_f32 v[114:115], v[176:177], v[224:225]
    v_pk_mul_f32 v[116:117], v[178:179], v[230:231]
    v_pk_mul_f32 v[118:119], v[178:179], v[226:227]
    v_pk_fma_f32 v[176:177], v[160:161], v[228:229], v[114:115]
    v_pk_fma_f32 v[160:161], v[160:161], v[224:225], v[112:113] neg_lo:[0,0,1] neg_hi:[0,0,1]
    v_pk_fma_f32 v[178:179], v[162:163], v[230:231], v[118:119]
    v_pk_fma_f32 v[162:163], v[162:163], v[226:227], v[116:117] neg_lo:[0,0,1] neg_hi:[0,0,1]
    v_cvt_pk_bf16_f32 v96, v160, v162
    v_cvt_pk_bf16_f32 v100, v176, v178
    v_cvt_pk_bf16_f32 v104, v161, v163
    v_cvt_pk_bf16_f32 v108, v177, v179
    v_pk_mul_f32 v[112:113], v[180:181], v[236:237]
    v_pk_mul_f32 v[114:115], v[180:181], v[232:233]
    v_pk_mul_f32 v[116:117], v[182:183], v[238:239]
    v_pk_mul_f32 v[118:119], v[182:183], v[234:235]
    v_pk_fma_f32 v[180:181], v[164:165], v[236:237], v[114:115]
    buffer_load_dwordx4 a[184:187], v9, s[8:11], s64 offen offset:0
    v_pk_fma_f32 v[164:165], v[164:165], v[232:233], v[112:113] neg_lo:[0,0,1] neg_hi:[0,0,1]
    v_pk_fma_f32 v[182:183], v[166:167], v[238:239], v[118:119]
    v_pk_fma_f32 v[166:167], v[166:167], v[234:235], v[116:117] neg_lo:[0,0,1] neg_hi:[0,0,1]
    v_cvt_pk_bf16_f32 v97, v164, v166
    v_cvt_pk_bf16_f32 v101, v180, v182
    v_cvt_pk_bf16_f32 v105, v165, v167
    v_cvt_pk_bf16_f32 v109, v181, v183
    v_pk_mul_f32 v[112:113], v[184:185], v[244:245]
    v_pk_mul_f32 v[114:115], v[184:185], v[240:241]
    v_pk_mul_f32 v[116:117], v[186:187], v[246:247]
    v_pk_mul_f32 v[118:119], v[186:187], v[242:243]
    v_pk_fma_f32 v[184:185], v[168:169], v[244:245], v[114:115]
    v_pk_fma_f32 v[168:169], v[168:169], v[240:241], v[112:113] neg_lo:[0,0,1] neg_hi:[0,0,1]
    v_pk_fma_f32 v[186:187], v[170:171], v[246:247], v[118:119]
    v_pk_fma_f32 v[170:171], v[170:171], v[242:243], v[116:117] neg_lo:[0,0,1] neg_hi:[0,0,1]
    v_cvt_pk_bf16_f32 v98, v168, v170
    buffer_load_dwordx4 a[188:191], v9, s[8:11], s64 offen offset:64
    v_cvt_pk_bf16_f32 v102, v184, v186
    v_cvt_pk_bf16_f32 v106, v169, v171
    v_cvt_pk_bf16_f32 v110, v185, v187
    v_pk_mul_f32 v[112:113], v[188:189], v[252:253]
    v_pk_mul_f32 v[114:115], v[188:189], v[248:249]
    v_pk_mul_f32 v[116:117], v[190:191], v[254:255]
    v_pk_mul_f32 v[118:119], v[190:191], v[250:251]
    v_pk_fma_f32 v[188:189], v[172:173], v[252:253], v[114:115]
    v_pk_fma_f32 v[172:173], v[172:173], v[248:249], v[112:113] neg_lo:[0,0,1] neg_hi:[0,0,1]
    v_pk_fma_f32 v[190:191], v[174:175], v[254:255], v[118:119]
    v_pk_fma_f32 v[174:175], v[174:175], v[250:251], v[116:117] neg_lo:[0,0,1] neg_hi:[0,0,1]
    v_cvt_pk_bf16_f32 v99, v172, v174
    v_cvt_pk_bf16_f32 v103, v188, v190
    v_cvt_pk_bf16_f32 v107, v173, v175
    v_cvt_pk_bf16_f32 v111, v189, v191
    v_mfma_f32_32x32x16_bf16 v[32:47], a[40:43], v[96:99], v[32:47]
    s_add_u32 s3, s79, s56
    buffer_load_dwordx4 a[224:227], v1, s[24:27], s3 offen sc1
    v_mfma_f32_32x32x16_bf16 v[48:63], a[48:51], v[104:107], v[48:63]
    v_mfma_f32_32x32x16_bf16 v[32:47], a[44:47], v[100:103], v[32:47]
    s_add_u32 s3, s79, s57
    buffer_load_dwordx4 a[228:231], v1, s[24:27], s3 offen sc1
    v_mfma_f32_32x32x16_bf16 v[48:63], a[52:55], v[108:111], v[48:63]
    s_nop 7
    s_nop 3
    v_pk_add_f32 v[128:129], v[32:33], v[48:49]
    s_add_u32 s3, s79, s58
    buffer_load_dwordx4 a[232:235], v1, s[24:27], s3 offen sc1
    v_pk_add_f32 v[130:131], v[34:35], v[50:51]
    v_pk_add_f32 v[132:133], v[36:37], v[52:53]
    v_pk_add_f32 v[134:135], v[38:39], v[54:55]
    v_pk_add_f32 v[136:137], v[40:41], v[56:57]
    v_pk_add_f32 v[138:139], v[42:43], v[58:59]
    v_pk_add_f32 v[140:141], v[44:45], v[60:61]
    v_pk_add_f32 v[142:143], v[46:47], v[62:63]
    v_cvt_pk_bf16_f32 v64, v128, v129
    v_cvt_pk_bf16_f32 v65, v130, v131
    v_cvt_pk_bf16_f32 v66, v132, v133
    s_add_u32 s3, s79, s59
    buffer_load_dwordx4 a[236:239], v1, s[24:27], s3 offen sc1
    v_cvt_pk_bf16_f32 v67, v134, v135
    v_cvt_pk_bf16_f32 v68, v136, v137
    v_cvt_pk_bf16_f32 v69, v138, v139
    v_cvt_pk_bf16_f32 v70, v140, v141
    v_cvt_pk_bf16_f32 v71, v142, v143
    ds_write_b128 v11, v[64:67] offset:0
    ds_write_b128 v11, v[68:71] offset:1024
    v_pk_add_f32 v[144:145], v[32:33], v[48:49] neg_lo:[0,1] neg_hi:[0,1]
    v_pk_add_f32 v[146:147], v[34:35], v[50:51] neg_lo:[0,1] neg_hi:[0,1]
    v_pk_add_f32 v[148:149], v[36:37], v[52:53] neg_lo:[0,1] neg_hi:[0,1]
    s_add_u32 s3, s79, s60
    buffer_load_dwordx4 a[240:243], v1, s[24:27], s3 offen sc1
    v_pk_add_f32 v[150:151], v[38:39], v[54:55] neg_lo:[0,1] neg_hi:[0,1]
    v_pk_add_f32 v[152:153], v[40:41], v[56:57] neg_lo:[0,1] neg_hi:[0,1]
    v_pk_add_f32 v[154:155], v[42:43], v[58:59] neg_lo:[0,1] neg_hi:[0,1]
    v_pk_add_f32 v[156:157], v[44:45], v[60:61] neg_lo:[0,1] neg_hi:[0,1]
    v_pk_add_f32 v[158:159], v[46:47], v[62:63] neg_lo:[0,1] neg_hi:[0,1]
    v_cvt_pk_bf16_f32 v72, v144, v145
    v_cvt_pk_bf16_f32 v73, v146, v147
    v_cvt_pk_bf16_f32 v74, v148, v149
    v_cvt_pk_bf16_f32 v75, v150, v151
    v_cvt_pk_bf16_f32 v76, v152, v153
    s_add_u32 s3, s79, s61
    buffer_load_dwordx4 a[244:247], v1, s[24:27], s3 offen sc1
    v_cvt_pk_bf16_f32 v77, v154, v155
    v_cvt_pk_bf16_f32 v78, v156, v157
    v_cvt_pk_bf16_f32 v79, v158, v159
    ds_write_b128 v11, v[72:75] offset:2048
    ds_write_b128 v11, v[76:79] offset:3072
    s_add_u32 s3, s79, s62
    buffer_load_dwordx4 a[248:251], v1, s[24:27], s3 offen sc1
    s_add_u32 s3, s79, s63
    buffer_load_dwordx4 a[252:255], v1, s[24:27], s3 offen sc1
    s_waitcnt lgkmcnt(0)
    s_waitcnt vmcnt(18)
    s_barrier
    ds_read_b128 v[80:83], v12 offset:0
    ds_read_b128 v[84:87], v12 offset:4096
    ds_read_b128 v[88:91], v12 offset:43008
    ds_read_b128 v[92:95], v12 offset:47104
    ds_read_b64_tr_b16 a[88:89], v13 offset:4096
    ds_read_b64_tr_b16 a[90:91], v13 offset:4608
    ds_read_b64_tr_b16 a[92:93], v14 offset:4096
    ds_read_b64_tr_b16 a[94:95], v14 offset:4608
    ds_read_b64_tr_b16 a[96:97], v15 offset:4096
    ds_read_b64_tr_b16 a[98:99], v15 offset:4608
    ds_read_b64_tr_b16 a[100:101], v16 offset:4096
    ds_read_b64_tr_b16 a[102:103], v16 offset:4608
    ds_read_b64_tr_b16 a[104:105], v13 offset:8192
    ds_read_b64_tr_b16 a[106:107], v13 offset:8704
    ds_read_b64_tr_b16 a[108:109], v14 offset:8192
    ds_read_b64_tr_b16 a[110:111], v14 offset:8704
    ds_read_b64_tr_b16 a[112:113], v15 offset:8192
    ds_read_b64_tr_b16 a[114:115], v15 offset:8704
    ds_read_b64_tr_b16 a[116:117], v16 offset:8192
    ds_read_b64_tr_b16 a[118:119], v16 offset:8704
    s_waitcnt lgkmcnt(15)
    v_perm_b32 v96, v84, v80, s70
    v_perm_b32 v97, v92, v88, s70
    buffer_store_dwordx2 v[96:97], v23, s[24:27], s99 offen offset:0 sc1
    v_perm_b32 v98, v84, v80, s71
    v_perm_b32 v99, v92, v88, s71
    buffer_store_dwordx2 v[98:99], v23, s[24:27], s99 offen offset:256 sc1
    v_perm_b32 v100, v85, v81, s70
    v_perm_b32 v101, v93, v89, s70
    buffer_store_dwordx2 v[100:101], v23, s[24:27], s99 offen offset:512 sc1
    v_perm_b32 v102, v85, v81, s71
    v_perm_b32 v103, v93, v89, s71
    buffer_store_dwordx2 v[102:103], v23, s[24:27], s99 offen offset:768 sc1
    v_perm_b32 v104, v86, v82, s70
    v_perm_b32 v105, v94, v90, s70
    buffer_store_dwordx2 v[104:105], v23, s[24:27], s99 offen offset:2048 sc1
    v_perm_b32 v106, v86, v82, s71
    v_perm_b32 v107, v94, v90, s71
    buffer_store_dwordx2 v[106:107], v23, s[24:27], s99 offen offset:2304 sc1
    v_perm_b32 v108, v87, v83, s70
    v_perm_b32 v109, v95, v91, s70
    buffer_store_dwordx2 v[108:109], v23, s[24:27], s99 offen offset:2560 sc1
    v_perm_b32 v110, v87, v83, s71
    v_perm_b32 v111, v95, v91, s71
    buffer_store_dwordx2 v[110:111], v23, s[24:27], s99 offen offset:2816 sc1
    s_waitcnt vmcnt(18)
L_hB0_chk:
    v_accvgpr_read_b32 v128, a192
    v_accvgpr_read_b32 v132, a196
    v_accvgpr_read_b32 v136, a200
    v_accvgpr_read_b32 v140, a204
    v_accvgpr_read_b32 v144, a208
    v_accvgpr_read_b32 v148, a212
    v_accvgpr_read_b32 v152, a216
    v_accvgpr_read_b32 v156, a220
    v_max_u32 v24, v128, v132
    v_max3_u32 v24, v136, v140, v24
    v_max3_u32 v24, v144, v148, v24
    v_max3_u32 v24, v152, v156, v24
    v_cmp_eq_u32_e64 vcc, -1, v24
    s_cbranch_vccnz L_hB0_retry
L_hB0_ok:
    s_waitcnt lgkmcnt(8)
    v_mfma_f32_16x16x32_bf16 v[32:35], a[88:91], a[192:195], 0
    ds_read_b64_tr_b16 a[120:121], v13 offset:12288
    ds_read_b64_tr_b16 a[122:123], v13 offset:12800
    v_mfma_f32_16x16x32_bf16 v[36:39], a[92:95], a[192:195], 0
    ds_read_b64_tr_b16 a[124:125], v14 offset:12288
    ds_read_b64_tr_b16 a[126:127], v14 offset:12800
    v_mfma_f32_16x16x32_bf16 v[40:43], a[96:99], a[192:195], 0
    ds_read_b64_tr_b16 a[128:129], v15 offset:12288
    ds_read_b64_tr_b16 a[130:131], v15 offset:12800
    v_mfma_f32_16x16x32_bf16 v[44:47], a[100:103], a[192:195], 0
    ds_read_b64_tr_b16 a[132:133], v16 offset:12288
    ds_read_b64_tr_b16 a[134:135], v16 offset:12800
    s_waitcnt lgkmcnt(8)
    v_mfma_f32_16x16x32_bf16 v[32:35], a[104:107], a[196:199], v[32:35]
    ds_read_b64_tr_b16 a[136:137], v13 offset:16384
    ds_read_b64_tr_b16 a[138:139], v13 offset:16896
    v_mfma_f32_16x16x32_bf16 v[36:39], a[108:111], a[196:199], v[36:39]
    ds_read_b64_tr_b16 a[140:141], v14 offset:16384
    ds_read_b64_tr_b16 a[142:143], v14 offset:16896
    v_mfma_f32_16x16x32_bf16 v[40:43], a[112:115], a[196:199], v[40:43]
    ds_read_b64_tr_b16 a[144:145], v15 offset:16384
    ds_read_b64_tr_b16 a[146:147], v15 offset:16896
    v_mfma_f32_16x16x32_bf16 v[44:47], a[116:119], a[196:199], v[44:47]
    ds_read_b64_tr_b16 a[148:149], v16 offset:16384
    ds_read_b64_tr_b16 a[150:151], v16 offset:16896
    s_waitcnt lgkmcnt(8)
    v_mfma_f32_16x16x32_bf16 v[32:35], a[120:123], a[200:203], v[32:35]
    ds_read_b64_tr_b16 a[152:153], v13 offset:20480
    ds_read_b64_tr_b16 a[154:155], v13 offset:20992
    v_mfma_f32_16x16x32_bf16 v[36:39], a[124:127], a[200:203], v[36:39]
    ds_read_b64_tr_b16 a[156:157], v14 offset:20480
    ds_read_b64_tr_b16 a[158:159], v14 offset:20992
    v_mfma_f32_16x16x32_bf16 v[40:43], a[128:131], a[200:203], v[40:43]
    ds_read_b64_tr_b16 a[160:161], v15 offset:20480
    ds_read_b64_tr_b16 a[162:163], v15 offset:20992
    v_mfma_f32_16x16x32_bf16 v[44:47], a[132:135], a[200:203], v[44:47]
    ds_read_b64_tr_b16 a[164:165], v16 offset:20480
    ds_read_b64_tr_b16 a[166:167], v16 offset:20992
    s_waitcnt lgkmcnt(8)
    v_mfma_f32_16x16x32_bf16 v[32:35], a[136:139], a[204:207], v[32:35]
    ds_read_b64_tr_b16 a[168:169], v13 offset:24576
    ds_read_b64_tr_b16 a[170:171], v13 offset:25088
    v_mfma_f32_16x16x32_bf16 v[36:39], a[140:143], a[204:207], v[36:39]
    ds_read_b64_tr_b16 a[172:173], v14 offset:24576
    ds_read_b64_tr_b16 a[174:175], v14 offset:25088
    v_mfma_f32_16x16x32_bf16 v[40:43], a[144:147], a[204:207], v[40:43]
    ds_read_b64_tr_b16 a[176:177], v15 offset:24576
    ds_read_b64_tr_b16 a[178:179], v15 offset:25088
    v_mfma_f32_16x16x32_bf16 v[44:47], a[148:151], a[204:207], v[44:47]
    ds_read_b64_tr_b16 a[180:181], v16 offset:24576
    ds_read_b64_tr_b16 a[182:183], v16 offset:25088
    s_waitcnt lgkmcnt(8)
    v_mfma_f32_16x16x32_bf16 v[32:35], a[152:155], a[208:211], v[32:35]
    ds_read_b64_tr_b16 a[88:89], v13 offset:28672
    ds_read_b64_tr_b16 a[90:91], v13 offset:29184
    v_mfma_f32_16x16x32_bf16 v[36:39], a[156:159], a[208:211], v[36:39]
    ds_read_b64_tr_b16 a[92:93], v14 offset:28672
    ds_read_b64_tr_b16 a[94:95], v14 offset:29184
    v_mfma_f32_16x16x32_bf16 v[40:43], a[160:163], a[208:211], v[40:43]
    ds_read_b64_tr_b16 a[96:97], v15 offset:28672
    ds_read_b64_tr_b16 a[98:99], v15 offset:29184
    v_mfma_f32_16x16x32_bf16 v[44:47], a[164:167], a[208:211], v[44:47]
    ds_read_b64_tr_b16 a[100:101], v16 offset:28672
    ds_read_b64_tr_b16 a[102:103], v16 offset:29184
    s_waitcnt lgkmcnt(8)
    v_mfma_f32_16x16x32_bf16 v[32:35], a[168:171], a[212:215], v[32:35]
    ds_read_b64_tr_b16 a[104:105], v13 offset:32768
    ds_read_b64_tr_b16 a[106:107], v13 offset:33280
    v_mfma_f32_16x16x32_bf16 v[36:39], a[172:175], a[212:215], v[36:39]
    ds_read_b64_tr_b16 a[108:109], v14 offset:32768
    ds_read_b64_tr_b16 a[110:111], v14 offset:33280
    v_mfma_f32_16x16x32_bf16 v[40:43], a[176:179], a[212:215], v[40:43]
    ds_read_b64_tr_b16 a[112:113], v15 offset:32768
    ds_read_b64_tr_b16 a[114:115], v15 offset:33280
    v_mfma_f32_16x16x32_bf16 v[44:47], a[180:183], a[212:215], v[44:47]
    ds_read_b64_tr_b16 a[116:117], v16 offset:32768
    ds_read_b64_tr_b16 a[118:119], v16 offset:33280
    s_waitcnt lgkmcnt(8)
    v_mfma_f32_16x16x32_bf16 v[32:35], a[88:91], a[216:219], v[32:35]
    ds_read_b64_tr_b16 a[120:121], v13 offset:36864
    ds_read_b64_tr_b16 a[122:123], v13 offset:37376
    v_mfma_f32_16x16x32_bf16 v[36:39], a[92:95], a[216:219], v[36:39]
    ds_read_b64_tr_b16 a[124:125], v14 offset:36864
    ds_read_b64_tr_b16 a[126:127], v14 offset:37376
    v_mfma_f32_16x16x32_bf16 v[40:43], a[96:99], a[216:219], v[40:43]
    ds_read_b64_tr_b16 a[128:129], v15 offset:36864
    ds_read_b64_tr_b16 a[130:131], v15 offset:37376
    v_mfma_f32_16x16x32_bf16 v[44:47], a[100:103], a[216:219], v[44:47]
    ds_read_b64_tr_b16 a[132:133], v16 offset:36864
    ds_read_b64_tr_b16 a[134:135], v16 offset:37376
    s_waitcnt lgkmcnt(8)
    v_mfma_f32_16x16x32_bf16 v[32:35], a[104:107], a[220:223], v[32:35]
    ds_read_b64_tr_b16 a[136:137], v13 offset:40960
    ds_read_b64_tr_b16 a[138:139], v13 offset:41472
    v_mfma_f32_16x16x32_bf16 v[36:39], a[108:111], a[220:223], v[36:39]
    ds_read_b64_tr_b16 a[140:141], v14 offset:40960
    ds_read_b64_tr_b16 a[142:143], v14 offset:41472
    v_mfma_f32_16x16x32_bf16 v[40:43], a[112:115], a[220:223], v[40:43]
    ds_read_b64_tr_b16 a[144:145], v15 offset:40960
    ds_read_b64_tr_b16 a[146:147], v15 offset:41472
    v_mfma_f32_16x16x32_bf16 v[44:47], a[116:119], a[220:223], v[44:47]
    ds_read_b64_tr_b16 a[148:149], v16 offset:40960
    ds_read_b64_tr_b16 a[150:151], v16 offset:41472
    s_waitcnt vmcnt(8)
L_hB1_chk:
    v_accvgpr_read_b32 v160, a224
    v_accvgpr_read_b32 v164, a228
    v_accvgpr_read_b32 v168, a232
    v_accvgpr_read_b32 v172, a236
    v_accvgpr_read_b32 v176, a240
    v_accvgpr_read_b32 v180, a244
    v_accvgpr_read_b32 v184, a248
    v_accvgpr_read_b32 v188, a252
    v_max_u32 v24, v160, v164
    v_max3_u32 v24, v168, v172, v24
    v_max3_u32 v24, v176, v180, v24
    v_max3_u32 v24, v184, v188, v24
    v_cmp_eq_u32_e64 vcc, -1, v24
    s_cbranch_vccnz L_hB1_retry
L_hB1_ok:
    s_waitcnt lgkmcnt(8)
    v_mfma_f32_16x16x32_bf16 v[32:35], a[120:123], a[224:227], v[32:35]
    ds_read_b64_tr_b16 a[152:153], v13 offset:45056
    ds_read_b64_tr_b16 a[154:155], v13 offset:45568
    v_mfma_f32_16x16x32_bf16 v[36:39], a[124:127], a[224:227], v[36:39]
    ds_read_b64_tr_b16 a[156:157], v14 offset:45056
    ds_read_b64_tr_b16 a[158:159], v14 offset:45568
    v_mfma_f32_16x16x32_bf16 v[40:43], a[128:131], a[224:227], v[40:43]
    ds_read_b64_tr_b16 a[160:161], v15 offset:45056
    ds_read_b64_tr_b16 a[162:163], v15 offset:45568
    v_mfma_f32_16x16x32_bf16 v[44:47], a[132:135], a[224:227], v[44:47]
    ds_read_b64_tr_b16 a[164:165], v16 offset:45056
    ds_read_b64_tr_b16 a[166:167], v16 offset:45568
    s_waitcnt lgkmcnt(8)
    v_mfma_f32_16x16x32_bf16 v[32:35], a[136:139], a[228:231], v[32:35]
    v_subrev_u32 v13, 40960, v13
    v_subrev_u32 v14, 40960, v14
    v_subrev_u32 v15, 40960, v15
    v_subrev_u32 v16, 40960, v16
    ds_read_b64_tr_b16 a[168:169], v13 offset:0
    ds_read_b64_tr_b16 a[170:171], v13 offset:512
    v_mfma_f32_16x16x32_bf16 v[36:39], a[140:143], a[228:231], v[36:39]
    ds_read_b64_tr_b16 a[172:173], v14 offset:0
    ds_read_b64_tr_b16 a[174:175], v14 offset:512
    v_mfma_f32_16x16x32_bf16 v[40:43], a[144:147], a[228:231], v[40:43]
    ds_read_b64_tr_b16 a[176:177], v15 offset:0
    ds_read_b64_tr_b16 a[178:179], v15 offset:512
    v_mfma_f32_16x16x32_bf16 v[44:47], a[148:151], a[228:231], v[44:47]
    ds_read_b64_tr_b16 a[180:181], v16 offset:0
    ds_read_b64_tr_b16 a[182:183], v16 offset:512
    s_waitcnt lgkmcnt(8)
    v_mfma_f32_16x16x32_bf16 v[32:35], a[152:155], a[232:235], v[32:35]
    ds_read_b64_tr_b16 a[88:89], v13 offset:4096
    ds_read_b64_tr_b16 a[90:91], v13 offset:4608
    v_mfma_f32_16x16x32_bf16 v[36:39], a[156:159], a[232:235], v[36:39]
    ds_read_b64_tr_b16 a[92:93], v14 offset:4096
    ds_read_b64_tr_b16 a[94:95], v14 offset:4608
    v_mfma_f32_16x16x32_bf16 v[40:43], a[160:163], a[232:235], v[40:43]
    ds_read_b64_tr_b16 a[96:97], v15 offset:4096
    ds_read_b64_tr_b16 a[98:99], v15 offset:4608
    v_mfma_f32_16x16x32_bf16 v[44:47], a[164:167], a[232:235], v[44:47]
    ds_read_b64_tr_b16 a[100:101], v16 offset:4096
    ds_read_b64_tr_b16 a[102:103], v16 offset:4608
    s_waitcnt lgkmcnt(8)
    v_mfma_f32_16x16x32_bf16 v[32:35], a[168:171], a[236:239], v[32:35]
    ds_read_b64_tr_b16 a[104:105], v13 offset:8192
    ds_read_b64_tr_b16 a[106:107], v13 offset:8704
    v_mfma_f32_16x16x32_bf16 v[36:39], a[172:175], a[236:239], v[36:39]
    ds_read_b64_tr_b16 a[108:109], v14 offset:8192
    ds_read_b64_tr_b16 a[110:111], v14 offset:8704
    v_mfma_f32_16x16x32_bf16 v[40:43], a[176:179], a[236:239], v[40:43]
    ds_read_b64_tr_b16 a[112:113], v15 offset:8192
    ds_read_b64_tr_b16 a[114:115], v15 offset:8704
    v_mfma_f32_16x16x32_bf16 v[44:47], a[180:183], a[236:239], v[44:47]
    ds_read_b64_tr_b16 a[116:117], v16 offset:8192
    ds_read_b64_tr_b16 a[118:119], v16 offset:8704
    s_add_u32 s3, s65, s74
    buffer_load_dwordx4 v[192:195], v1, s[24:27], s3 offen sc1
    s_add_u32 s3, s65, s75
    buffer_load_dwordx4 v[196:199], v1, s[24:27], s3 offen sc1
    s_add_u32 s3, s65, s76
    buffer_load_dwordx4 v[200:203], v1, s[24:27], s3 offen sc1
    s_add_u32 s3, s65, s84
    buffer_load_dwordx4 v[204:207], v1, s[24:27], s3 offen sc1
    s_add_u32 s3, s65, s88
    buffer_load_dwordx4 v[208:211], v1, s[24:27], s3 offen sc1
    s_add_u32 s3, s65, s45
    buffer_load_dwordx4 v[212:215], v1, s[24:27], s3 offen sc1
    s_waitcnt lgkmcnt(8)
    v_mfma_f32_16x16x32_bf16 v[32:35], a[88:91], a[240:243], v[32:35]
    ds_read_b64_tr_b16 a[120:121], v13 offset:12288
    ds_read_b64_tr_b16 a[122:123], v13 offset:12800
    v_mfma_f32_16x16x32_bf16 v[36:39], a[92:95], a[240:243], v[36:39]
    ds_read_b64_tr_b16 a[124:125], v14 offset:12288
    ds_read_b64_tr_b16 a[126:127], v14 offset:12800
    v_mfma_f32_16x16x32_bf16 v[40:43], a[96:99], a[240:243], v[40:43]
    ds_read_b64_tr_b16 a[128:129], v15 offset:12288
    ds_read_b64_tr_b16 a[130:131], v15 offset:12800
    v_mfma_f32_16x16x32_bf16 v[44:47], a[100:103], a[240:243], v[44:47]
    ds_read_b64_tr_b16 a[132:133], v16 offset:12288
    ds_read_b64_tr_b16 a[134:135], v16 offset:12800
    s_waitcnt lgkmcnt(8)
    v_mfma_f32_16x16x32_bf16 v[32:35], a[104:107], a[244:247], v[32:35]
    ds_read_b64_tr_b16 a[136:137], v13 offset:16384
    ds_read_b64_tr_b16 a[138:139], v13 offset:16896
    v_mfma_f32_16x16x32_bf16 v[36:39], a[108:111], a[244:247], v[36:39]
    ds_read_b64_tr_b16 a[140:141], v14 offset:16384
    ds_read_b64_tr_b16 a[142:143], v14 offset:16896
    v_mfma_f32_16x16x32_bf16 v[40:43], a[112:115], a[244:247], v[40:43]
    ds_read_b64_tr_b16 a[144:145], v15 offset:16384
    ds_read_b64_tr_b16 a[146:147], v15 offset:16896
    v_mfma_f32_16x16x32_bf16 v[44:47], a[116:119], a[244:247], v[44:47]
    ds_read_b64_tr_b16 a[148:149], v16 offset:16384
    ds_read_b64_tr_b16 a[150:151], v16 offset:16896
    s_mov_b32 s7, s66
    buffer_load_dwordx2 v[56:57], v10, s[24:27], s7 offen sc1
    s_add_u32 s7, s7, s67
    buffer_load_dwordx2 v[58:59], v10, s[24:27], s7 offen sc1
    s_add_u32 s7, s7, s67
    buffer_load_dwordx2 v[60:61], v10, s[24:27], s7 offen sc1
    s_add_u32 s7, s7, s67
    buffer_load_dwordx2 v[62:63], v10, s[24:27], s7 offen sc1
    s_waitcnt lgkmcnt(8)
    v_mfma_f32_16x16x32_bf16 v[32:35], a[120:123], a[248:251], v[32:35]
    ds_read_b64_tr_b16 a[152:153], v13 offset:40960
    ds_read_b64_tr_b16 a[154:155], v13 offset:41472
    v_mfma_f32_16x16x32_bf16 v[36:39], a[124:127], a[248:251], v[36:39]
    ds_read_b64_tr_b16 a[156:157], v14 offset:40960
    ds_read_b64_tr_b16 a[158:159], v14 offset:41472
    v_mfma_f32_16x16x32_bf16 v[40:43], a[128:131], a[248:251], v[40:43]
    ds_read_b64_tr_b16 a[160:161], v15 offset:40960
    ds_read_b64_tr_b16 a[162:163], v15 offset:41472
    v_mfma_f32_16x16x32_bf16 v[44:47], a[132:135], a[248:251], v[44:47]
    ds_read_b64_tr_b16 a[164:165], v16 offset:40960
    ds_read_b64_tr_b16 a[166:167], v16 offset:41472
    s_waitcnt lgkmcnt(8)
    v_mfma_f32_16x16x32_bf16 v[32:35], a[136:139], a[252:255], v[32:35]
    ds_read_b64_tr_b16 a[168:169], v13 offset:20480
    ds_read_b64_tr_b16 a[170:171], v13 offset:20992
    v_mfma_f32_16x16x32_bf16 v[36:39], a[140:143], a[252:255], v[36:39]
    ds_read_b64_tr_b16 a[172:173], v14 offset:20480
    ds_read_b64_tr_b16 a[174:175], v14 offset:20992
    v_mfma_f32_16x16x32_bf16 v[40:43], a[144:147], a[252:255], v[40:43]
    ds_read_b64_tr_b16 a[176:177], v15 offset:20480
    ds_read_b64_tr_b16 a[178:179], v15 offset:20992
    v_mfma_f32_16x16x32_bf16 v[44:47], a[148:151], a[252:255], v[44:47]
    ds_read_b64_tr_b16 a[180:181], v16 offset:20480
    ds_read_b64_tr_b16 a[182:183], v16 offset:20992
    ds_read_b64_tr_b16 a[88:89], v13 offset:24576
    ds_read_b64_tr_b16 a[90:91], v13 offset:25088
    ds_read_b64_tr_b16 a[92:93], v14 offset:24576
    ds_read_b64_tr_b16 a[94:95], v14 offset:25088
    ds_read_b64_tr_b16 a[96:97], v15 offset:24576
    ds_read_b64_tr_b16 a[98:99], v15 offset:25088
    ds_read_b64_tr_b16 a[100:101], v16 offset:24576
    ds_read_b64_tr_b16 a[102:103], v16 offset:25088
    ds_read_b64_tr_b16 a[104:105], v13 offset:28672
    ds_read_b64_tr_b16 a[106:107], v13 offset:29184
    ds_read_b64_tr_b16 a[108:109], v14 offset:28672
    ds_read_b64_tr_b16 a[110:111], v14 offset:29184
    ds_read_b64_tr_b16 a[112:113], v15 offset:28672
    ds_read_b64_tr_b16 a[114:115], v15 offset:29184
    ds_read_b64_tr_b16 a[116:117], v16 offset:28672
    ds_read_b64_tr_b16 a[118:119], v16 offset:29184
    ds_read_b64_tr_b16 a[120:121], v13 offset:32768
    ds_read_b64_tr_b16 a[122:123], v13 offset:33280
    ds_read_b64_tr_b16 a[124:125], v14 offset:32768
    ds_read_b64_tr_b16 a[126:127], v14 offset:33280
    ds_read_b64_tr_b16 a[128:129], v15 offset:32768
    ds_read_b64_tr_b16 a[130:131], v15 offset:33280
    ds_read_b64_tr_b16 a[132:133], v16 offset:32768
    ds_read_b64_tr_b16 a[134:135], v16 offset:33280
    ds_read_b64_tr_b16 a[136:137], v13 offset:36864
    ds_read_b64_tr_b16 a[138:139], v13 offset:37376
    ds_read_b64_tr_b16 a[140:141], v14 offset:36864
    ds_read_b64_tr_b16 a[142:143], v14 offset:37376
    ds_read_b64_tr_b16 a[144:145], v15 offset:36864
    ds_read_b64_tr_b16 a[146:147], v15 offset:37376
    ds_read_b64_tr_b16 a[148:149], v16 offset:36864
    ds_read_b64_tr_b16 a[150:151], v16 offset:37376
    v_accvgpr_read_b32 v48, a184
    v_accvgpr_read_b32 v49, a185
    v_accvgpr_read_b32 v50, a186
    v_accvgpr_read_b32 v51, a187
    v_accvgpr_read_b32 v52, a188
    v_accvgpr_read_b32 v53, a189
    v_accvgpr_read_b32 v54, a190
    v_accvgpr_read_b32 v55, a191
    v_permlane16_swap_b32 v48, v50
    v_permlane16_swap_b32 v49, v51
    v_permlane16_swap_b32 v52, v54
    v_permlane16_swap_b32 v53, v55
    v_lshlrev_b32 v80, 16, v48
    v_and_b32 v81, 0xffff0000, v48
    v_lshlrev_b32 v82, 16, v49
    v_and_b32 v83, 0xffff0000, v49
    v_lshlrev_b32 v84, 16, v50
    v_and_b32 v85, 0xffff0000, v50
    v_lshlrev_b32 v86, 16, v51
    v_and_b32 v87, 0xffff0000, v51
    v_lshlrev_b32 v88, 16, v52
    v_and_b32 v89, 0xffff0000, v52
    v_lshlrev_b32 v90, 16, v53
    v_and_b32 v91, 0xffff0000, v53
    v_lshlrev_b32 v92, 16, v54
    v_and_b32 v93, 0xffff0000, v54
    v_lshlrev_b32 v94, 16, v55
    v_and_b32 v95, 0xffff0000, v55
    v_pk_add_f32 v[32:33], v[32:33], v[80:81]
    v_pk_add_f32 v[34:35], v[34:35], v[82:83]
    v_pk_add_f32 v[36:37], v[36:37], v[84:85]
    v_pk_add_f32 v[38:39], v[38:39], v[86:87]
    v_pk_add_f32 v[40:41], v[40:41], v[88:89]
    v_pk_add_f32 v[42:43], v[42:43], v[90:91]
    v_pk_add_f32 v[44:45], v[44:45], v[92:93]
    v_pk_add_f32 v[46:47], v[46:47], v[94:95]
    s_waitcnt lgkmcnt(0)
    s_waitcnt vmcnt(4)
L_hB2_chk:
    v_max_u32 v24, v192, v196
    v_max3_u32 v24, v200, v204, v24
    v_max3_u32 v24, v208, v212, v24
    v_cmp_eq_u32 vcc, -1, v24
    s_cbranch_vccnz L_hB2_retry
L_hB2_ok:
    v_mfma_f32_16x16x32_bf16 v[32:35], a[152:155], v[192:195], v[32:35]
    v_mfma_f32_16x16x32_bf16 v[36:39], a[156:159], v[192:195], v[36:39]
    v_mfma_f32_16x16x32_bf16 v[40:43], a[160:163], v[192:195], v[40:43]
    v_mfma_f32_16x16x32_bf16 v[44:47], a[164:167], v[192:195], v[44:47]
    v_mfma_f32_16x16x32_bf16 v[32:35], a[168:171], v[196:199], v[32:35]
    v_mfma_f32_16x16x32_bf16 v[36:39], a[172:175], v[196:199], v[36:39]
    v_mfma_f32_16x16x32_bf16 v[40:43], a[176:179], v[196:199], v[40:43]
    v_mfma_f32_16x16x32_bf16 v[44:47], a[180:183], v[196:199], v[44:47]
    v_mfma_f32_16x16x32_bf16 v[32:35], a[88:91], v[200:203], v[32:35]
    v_mfma_f32_16x16x32_bf16 v[36:39], a[92:95], v[200:203], v[36:39]
    v_mfma_f32_16x16x32_bf16 v[40:43], a[96:99], v[200:203], v[40:43]
    v_mfma_f32_16x16x32_bf16 v[44:47], a[100:103], v[200:203], v[44:47]
    v_mfma_f32_16x16x32_bf16 v[32:35], a[104:107], v[204:207], v[32:35]
    v_mfma_f32_16x16x32_bf16 v[36:39], a[108:111], v[204:207], v[36:39]
    v_mfma_f32_16x16x32_bf16 v[40:43], a[112:115], v[204:207], v[40:43]
    v_mfma_f32_16x16x32_bf16 v[44:47], a[116:119], v[204:207], v[44:47]
    v_mfma_f32_16x16x32_bf16 v[32:35], a[120:123], v[208:211], v[32:35]
    v_mfma_f32_16x16x32_bf16 v[36:39], a[124:127], v[208:211], v[36:39]
    v_mfma_f32_16x16x32_bf16 v[40:43], a[128:131], v[208:211], v[40:43]
    v_mfma_f32_16x16x32_bf16 v[44:47], a[132:135], v[208:211], v[44:47]
    v_mfma_f32_16x16x32_bf16 v[32:35], a[136:139], v[212:215], v[32:35]
    v_mfma_f32_16x16x32_bf16 v[36:39], a[140:143], v[212:215], v[36:39]
    v_mfma_f32_16x16x32_bf16 v[40:43], a[144:147], v[212:215], v[40:43]
    v_mfma_f32_16x16x32_bf16 v[44:47], a[148:151], v[212:215], v[44:47]
    s_waitcnt vmcnt(0)
L_yB_chk:
    v_max_u32 v24, v56, v58
    v_max3_u32 v24, v60, v62, v24
    v_cmp_eq_u32 vcc, -1, v24
    s_cbranch_vccnz L_yB_retry
L_yB_ok:
    v_and_b32 v80, 0xffff0000, v57
    v_and_b32 v82, 0xffff0000, v56
    v_lshlrev_b32 v81, 16, v57
    v_lshlrev_b32 v83, 16, v56
    v_and_b32 v84, 0xffff0000, v59
    v_and_b32 v86, 0xffff0000, v58
    v_lshlrev_b32 v85, 16, v59
    v_lshlrev_b32_e64 v87, 16, v58
    v_and_b32 v88, 0xffff0000, v61
    v_and_b32 v90, 0xffff0000, v60
    v_lshlrev_b32_e64 v89, 16, v61
    v_lshlrev_b32_e64 v91, 16, v60
    v_and_b32 v92, 0xffff0000, v63
    v_and_b32 v94, 0xffff0000, v62
    v_lshlrev_b32_e64 v93, 16, v63
    v_lshlrev_b32_e64 v95, 16, v62
    v_pk_add_f32 v[32:33], v[32:33], v[80:81]
    v_pk_add_f32 v[34:35], v[34:35], v[82:83]
    v_pk_add_f32 v[36:37], v[36:37], v[84:85]
    v_pk_add_f32 v[38:39], v[38:39], v[86:87]
    v_pk_add_f32 v[40:41], v[40:41], v[88:89]
    v_pk_add_f32 v[42:43], v[42:43], v[90:91]
    v_pk_add_f32 v[44:45], v[44:45], v[92:93]
    v_pk_add_f32 v[46:47], v[46:47], v[94:95]
    v_cvt_pk_bf16_f32 v72, v32, v33
    v_cvt_pk_bf16_f32 v73, v34, v35
    v_cvt_pk_bf16_f32 v74, v36, v37
    v_cvt_pk_bf16_f32 v75, v38, v39
    v_cvt_pk_bf16_f32 v76, v40, v41
    v_cvt_pk_bf16_f32 v77, v42, v43
    v_cvt_pk_bf16_f32 v78, v44, v45
    v_cvt_pk_bf16_f32 v79, v46, v47
    v_permlane16_swap_b32 v72, v74
    v_permlane16_swap_b32 v73, v75
    buffer_store_dwordx4 v[72:75], v9, s[28:31], s64 offen offset:0
    v_permlane16_swap_b32 v76, v78
    v_permlane16_swap_b32 v77, v79
    buffer_store_dwordx4 v[76:79], v9, s[28:31], s64 offen offset:64
    s_endpgm
L_dbg_retry:
    v_mul_u32_u24 v2, 260, v0
    v_and_b32 v2, 0x3e04, v2
    v_or_b32 v2, 9240576, v2
    buffer_load_dword v3, v2, s[24:27], 0 offen sc1
    s_waitcnt vmcnt(0)
    s_add_u32 s91, s91, 1
    s_cmp_gt_u32 s91, 40000
    s_cbranch_scc1 L_dbg_ok
    s_branch L_dbg_chk
L_rdy_retry:
    buffer_load_dword v27, off, s[32:35], 0 sc1
    s_waitcnt vmcnt(0)
    s_add_u32 s91, s91, 1
    s_cmp_gt_u32 s91, 40000
    s_cbranch_scc1 L_rdy_ok
    s_branch L_rdy_chk
L_st_retry:
    s_cmp_gt_u32 s91, 40000
    s_cbranch_scc1 L_st_ok
    s_add_u32 s91, s91, 1
    buffer_load_dwordx4 v[80:83], v1, s[24:27], s85 offen offset:0 sc1
    buffer_load_dwordx4 v[84:87], v1, s[24:27], s85 offen offset:1024 sc1
    buffer_load_dwordx4 v[88:91], v1, s[24:27], s85 offen offset:2048 sc1
    buffer_load_dwordx4 v[92:95], v1, s[24:27], s85 offen offset:3072 sc1
    s_waitcnt vmcnt(0)
    s_branch L_st_chk
L_pr_retry:
    s_cmp_gt_u32 s91, 40000
    s_cbranch_scc1 L_pr_ok
    s_add_u32 s91, s91, 1
    buffer_load_dword v30, v7, s[24:27], s97 offen sc1
    s_waitcnt vmcnt(0)
    v_cmp_eq_u32 vcc, -1, v30
    s_cbranch_vccnz L_pr_retry
    buffer_load_dwordx4 v[128:131], v1, s[24:27], s48 offen offset:0 sc1
    buffer_load_dwordx4 v[132:135], v1, s[24:27], s48 offen offset:1024 sc1
    buffer_load_dwordx4 v[136:139], v1, s[24:27], s48 offen offset:2048 sc1
    buffer_load_dwordx4 v[140:143], v1, s[24:27], s48 offen offset:3072 sc1
    buffer_load_dwordx4 v[144:147], v1, s[24:27], s49 offen offset:0 sc1
    buffer_load_dwordx4 v[148:151], v1, s[24:27], s49 offen offset:1024 sc1
    buffer_load_dwordx4 v[152:155], v1, s[24:27], s49 offen offset:2048 sc1
    buffer_load_dwordx4 v[156:159], v1, s[24:27], s49 offen offset:3072 sc1
    buffer_load_dwordx4 v[160:163], v1, s[24:27], s50 offen offset:0 sc1
    s_waitcnt vmcnt(0)
    s_branch L_pr_ok
L_slowA0:
    s_cmp_gt_u32 s91, 40000
    s_cbranch_scc1 L_retA0
    s_add_u32 s91, s91, 1
    v_mov_b32_e64 v26, 0
    buffer_load_dwordx4 v[80:83], v1, s[24:27], s48 offen offset:0 sc1
    buffer_load_dwordx4 v[84:87], v1, s[24:27], s48 offen offset:1024 sc1
    buffer_load_dwordx4 v[88:91], v1, s[24:27], s48 offen offset:2048 sc1
    buffer_load_dwordx4 v[92:95], v1, s[24:27], s48 offen offset:3072 sc1
    buffer_load_dwordx4 v[96:99], v1, s[24:27], s49 offen offset:0 sc1
    buffer_load_dwordx4 v[100:103], v1, s[24:27], s49 offen offset:1024 sc1
    buffer_load_dwordx4 v[104:107], v1, s[24:27], s49 offen offset:2048 sc1
    buffer_load_dwordx4 v[108:111], v1, s[24:27], s49 offen offset:3072 sc1
    s_waitcnt vmcnt(0)
    v_max3_u32 v26, v80, v84, v26
    v_max3_u32 v26, v88, v92, v26
    v_max3_u32 v26, v96, v100, v26
    v_max3_u32 v26, v104, v108, v26
    v_mfma_f32_32x32x16_bf16 v[224:239], v[80:83], a[0:3], 0
    v_mfma_f32_32x32x16_bf16 v[240:255], v[80:83], a[4:7], 0
    v_mfma_f32_32x32x16_bf16 v[224:239], v[84:87], a[8:11], v[224:239]
    v_mfma_f32_32x32x16_bf16 v[240:255], v[84:87], a[12:15], v[240:255]
    v_mfma_f32_32x32x16_bf16 v[224:239], v[88:91], a[16:19], v[224:239]
    v_mfma_f32_32x32x16_bf16 v[240:255], v[88:91], a[20:23], v[240:255]
    v_mfma_f32_32x32x16_bf16 v[224:239], v[92:95], a[24:27], v[224:239]
    v_mfma_f32_32x32x16_bf16 v[240:255], v[92:95], a[28:31], v[240:255]
    v_mfma_f32_32x32x16_bf16 v[224:239], v[96:99], a[32:35], v[224:239]
    v_mfma_f32_32x32x16_bf16 v[240:255], v[96:99], a[36:39], v[240:255]
    v_mfma_f32_32x32x16_bf16 v[224:239], v[100:103], a[40:43], v[224:239]
    v_mfma_f32_32x32x16_bf16 v[240:255], v[100:103], a[44:47], v[240:255]
    v_mfma_f32_32x32x16_bf16 v[224:239], v[104:107], a[48:51], v[224:239]
    v_mfma_f32_32x32x16_bf16 v[240:255], v[104:107], a[52:55], v[240:255]
    v_mfma_f32_32x32x16_bf16 v[224:239], v[108:111], a[56:59], v[224:239]
    v_mfma_f32_32x32x16_bf16 v[240:255], v[108:111], a[60:63], v[240:255]
    buffer_load_dwordx4 v[80:83], v1, s[24:27], s50 offen offset:0 sc1
    buffer_load_dwordx4 v[84:87], v1, s[24:27], s50 offen offset:1024 sc1
    buffer_load_dwordx4 v[88:91], v1, s[24:27], s50 offen offset:2048 sc1
    buffer_load_dwordx4 v[92:95], v1, s[24:27], s50 offen offset:3072 sc1
    buffer_load_dwordx4 v[96:99], v1, s[24:27], s51 offen offset:0 sc1
    buffer_load_dwordx4 v[100:103], v1, s[24:27], s51 offen offset:1024 sc1
    buffer_load_dwordx4 v[104:107], v1, s[24:27], s51 offen offset:2048 sc1
    buffer_load_dwordx4 v[108:111], v1, s[24:27], s51 offen offset:3072 sc1
    s_waitcnt vmcnt(0)
    v_max3_u32 v26, v80, v84, v26
    v_max3_u32 v26, v88, v92, v26
    v_max3_u32 v26, v96, v100, v26
    v_max3_u32 v26, v104, v108, v26
    v_mfma_f32_32x32x16_bf16 v[224:239], v[80:83], a[64:67], v[224:239]
    v_mfma_f32_32x32x16_bf16 v[240:255], v[80:83], a[68:71], v[240:255]
    v_mfma_f32_32x32x16_bf16 v[224:239], v[84:87], a[72:75], v[224:239]
    v_mfma_f32_32x32x16_bf16 v[240:255], v[84:87], a[76:79], v[240:255]
    v_mfma_f32_32x32x16_bf16 v[224:239], v[88:91], a[80:83], v[224:239]
    v_mfma_f32_32x32x16_bf16 v[240:255], v[88:91], a[84:87], v[240:255]
    v_mfma_f32_32x32x16_bf16 v[224:239], v[92:95], a[88:91], v[224:239]
    v_mfma_f32_32x32x16_bf16 v[240:255], v[92:95], a[92:95], v[240:255]
    v_mfma_f32_32x32x16_bf16 v[224:239], v[96:99], a[96:99], v[224:239]
    v_mfma_f32_32x32x16_bf16 v[240:255], v[96:99], a[100:103], v[240:255]
    v_mfma_f32_32x32x16_bf16 v[224:239], v[100:103], a[104:107], v[224:239]
    v_mfma_f32_32x32x16_bf16 v[240:255], v[100:103], a[108:111], v[240:255]
    v_mfma_f32_32x32x16_bf16 v[224:239], v[104:107], a[112:115], v[224:239]
    v_mfma_f32_32x32x16_bf16 v[240:255], v[104:107], a[116:119], v[240:255]
    v_mfma_f32_32x32x16_bf16 v[224:239], v[108:111], a[120:123], v[224:239]
    v_mfma_f32_32x32x16_bf16 v[240:255], v[108:111], a[124:127], v[240:255]
    buffer_load_dwordx4 v[80:83], v1, s[24:27], s52 offen offset:0 sc1
    buffer_load_dwordx4 v[84:87], v1, s[24:27], s52 offen offset:1024 sc1
    buffer_load_dwordx4 v[88:91], v1, s[24:27], s52 offen offset:2048 sc1
    buffer_load_dwordx4 v[92:95], v1, s[24:27], s52 offen offset:3072 sc1
    buffer_load_dwordx4 v[96:99], v1, s[24:27], s53 offen offset:0 sc1
    buffer_load_dwordx4 v[100:103], v1, s[24:27], s53 offen offset:1024 sc1
    buffer_load_dwordx4 v[104:107], v1, s[24:27], s53 offen offset:2048 sc1
    buffer_load_dwordx4 v[108:111], v1, s[24:27], s53 offen offset:3072 sc1
    s_waitcnt vmcnt(0)
    v_max3_u32 v26, v80, v84, v26
    v_max3_u32 v26, v88, v92, v26
    v_max3_u32 v26, v96, v100, v26
    v_max3_u32 v26, v104, v108, v26
    v_mfma_f32_32x32x16_bf16 v[224:239], v[80:83], a[128:131], v[224:239]
    v_mfma_f32_32x32x16_bf16 v[240:255], v[80:83], a[132:135], v[240:255]
    v_mfma_f32_32x32x16_bf16 v[224:239], v[84:87], a[136:139], v[224:239]
    v_mfma_f32_32x32x16_bf16 v[240:255], v[84:87], a[140:143], v[240:255]
    v_mfma_f32_32x32x16_bf16 v[224:239], v[88:91], a[144:147], v[224:239]
    v_mfma_f32_32x32x16_bf16 v[240:255], v[88:91], a[148:151], v[240:255]
    v_mfma_f32_32x32x16_bf16 v[224:239], v[92:95], a[152:155], v[224:239]
    v_mfma_f32_32x32x16_bf16 v[240:255], v[92:95], a[156:159], v[240:255]
    v_mfma_f32_32x32x16_bf16 v[224:239], v[96:99], a[160:163], v[224:239]
    v_mfma_f32_32x32x16_bf16 v[240:255], v[96:99], a[164:167], v[240:255]
    v_mfma_f32_32x32x16_bf16 v[224:239], v[100:103], a[168:171], v[224:239]
    v_mfma_f32_32x32x16_bf16 v[240:255], v[100:103], a[172:175], v[240:255]
    v_mfma_f32_32x32x16_bf16 v[224:239], v[104:107], a[176:179], v[224:239]
    v_mfma_f32_32x32x16_bf16 v[240:255], v[104:107], a[180:183], v[240:255]
    v_mfma_f32_32x32x16_bf16 v[224:239], v[108:111], a[184:187], v[224:239]
    v_mfma_f32_32x32x16_bf16 v[240:255], v[108:111], a[188:191], v[240:255]
    buffer_load_dwordx4 v[80:83], v1, s[24:27], s54 offen offset:0 sc1
    buffer_load_dwordx4 v[84:87], v1, s[24:27], s54 offen offset:1024 sc1
    buffer_load_dwordx4 v[88:91], v1, s[24:27], s54 offen offset:2048 sc1
    buffer_load_dwordx4 v[92:95], v1, s[24:27], s54 offen offset:3072 sc1
    buffer_load_dwordx4 v[96:99], v1, s[24:27], s55 offen offset:0 sc1
    buffer_load_dwordx4 v[100:103], v1, s[24:27], s55 offen offset:1024 sc1
    buffer_load_dwordx4 v[104:107], v1, s[24:27], s55 offen offset:2048 sc1
    buffer_load_dwordx4 v[108:111], v1, s[24:27], s55 offen offset:3072 sc1
    s_waitcnt vmcnt(0)
    v_max3_u32 v26, v80, v84, v26
    v_max3_u32 v26, v88, v92, v26
    v_max3_u32 v26, v96, v100, v26
    v_max3_u32 v26, v104, v108, v26
    v_mfma_f32_32x32x16_bf16 v[224:239], v[80:83], a[192:195], v[224:239]
    v_mfma_f32_32x32x16_bf16 v[240:255], v[80:83], a[196:199], v[240:255]
    v_mfma_f32_32x32x16_bf16 v[224:239], v[84:87], a[200:203], v[224:239]
    v_mfma_f32_32x32x16_bf16 v[240:255], v[84:87], a[204:207], v[240:255]
    v_mfma_f32_32x32x16_bf16 v[224:239], v[88:91], a[208:211], v[224:239]
    v_mfma_f32_32x32x16_bf16 v[240:255], v[88:91], a[212:215], v[240:255]
    v_mfma_f32_32x32x16_bf16 v[224:239], v[92:95], a[216:219], v[224:239]
    v_mfma_f32_32x32x16_bf16 v[240:255], v[92:95], a[220:223], v[240:255]
    v_mfma_f32_32x32x16_bf16 v[224:239], v[96:99], a[224:227], v[224:239]
    v_mfma_f32_32x32x16_bf16 v[240:255], v[96:99], a[228:231], v[240:255]
    v_mfma_f32_32x32x16_bf16 v[224:239], v[100:103], a[232:235], v[224:239]
    v_mfma_f32_32x32x16_bf16 v[240:255], v[100:103], a[236:239], v[240:255]
    v_mfma_f32_32x32x16_bf16 v[224:239], v[104:107], a[240:243], v[224:239]
    v_mfma_f32_32x32x16_bf16 v[240:255], v[104:107], a[244:247], v[240:255]
    v_mfma_f32_32x32x16_bf16 v[224:239], v[108:111], a[248:251], v[224:239]
    v_mfma_f32_32x32x16_bf16 v[240:255], v[108:111], a[252:255], v[240:255]
    v_cmp_eq_u32 vcc, -1, v26
    s_cbranch_vccnz L_slowA0
    s_nop 7
    s_nop 7
    s_branch L_retA0
L_slowA1:
    s_cmp_gt_u32 s91, 40000
    s_cbranch_scc1 L_retA1
    s_add_u32 s91, s91, 1
    v_mov_b32 v27, 0
    buffer_load_dwordx4 v[80:83], v2, s[24:27], s48 offen offset:0 sc1
    buffer_load_dwordx4 v[84:87], v2, s[24:27], s48 offen offset:1024 sc1
    buffer_load_dwordx4 v[88:91], v2, s[24:27], s48 offen offset:2048 sc1
    buffer_load_dwordx4 v[92:95], v2, s[24:27], s48 offen offset:3072 sc1
    buffer_load_dwordx4 v[96:99], v2, s[24:27], s49 offen offset:0 sc1
    buffer_load_dwordx4 v[100:103], v2, s[24:27], s49 offen offset:1024 sc1
    buffer_load_dwordx4 v[104:107], v2, s[24:27], s49 offen offset:2048 sc1
    buffer_load_dwordx4 v[108:111], v2, s[24:27], s49 offen offset:3072 sc1
    s_waitcnt vmcnt(0)
    v_max3_u32 v27, v80, v84, v27
    v_max3_u32 v27, v88, v92, v27
    v_max3_u32 v27, v96, v100, v27
    v_max3_u32 v27, v104, v108, v27
    v_mfma_f32_32x32x16_bf16 v[192:207], v[80:83], a[0:3], 0
    v_mfma_f32_32x32x16_bf16 v[208:223], v[80:83], a[4:7], 0
    v_mfma_f32_32x32x16_bf16 v[192:207], v[84:87], a[8:11], v[192:207]
    v_mfma_f32_32x32x16_bf16 v[208:223], v[84:87], a[12:15], v[208:223]
    v_mfma_f32_32x32x16_bf16 v[192:207], v[88:91], a[16:19], v[192:207]
    v_mfma_f32_32x32x16_bf16 v[208:223], v[88:91], a[20:23], v[208:223]
    v_mfma_f32_32x32x16_bf16 v[192:207], v[92:95], a[24:27], v[192:207]
    v_mfma_f32_32x32x16_bf16 v[208:223], v[92:95], a[28:31], v[208:223]
    v_mfma_f32_32x32x16_bf16 v[192:207], v[96:99], a[32:35], v[192:207]
    v_mfma_f32_32x32x16_bf16 v[208:223], v[96:99], a[36:39], v[208:223]
    v_mfma_f32_32x32x16_bf16 v[192:207], v[100:103], a[40:43], v[192:207]
    v_mfma_f32_32x32x16_bf16 v[208:223], v[100:103], a[44:47], v[208:223]
    v_mfma_f32_32x32x16_bf16 v[192:207], v[104:107], a[48:51], v[192:207]
    v_mfma_f32_32x32x16_bf16 v[208:223], v[104:107], a[52:55], v[208:223]
    v_mfma_f32_32x32x16_bf16 v[192:207], v[108:111], a[56:59], v[192:207]
    v_mfma_f32_32x32x16_bf16 v[208:223], v[108:111], a[60:63], v[208:223]
    buffer_load_dwordx4 v[80:83], v2, s[24:27], s50 offen offset:0 sc1
    buffer_load_dwordx4 v[84:87], v2, s[24:27], s50 offen offset:1024 sc1
    buffer_load_dwordx4 v[88:91], v2, s[24:27], s50 offen offset:2048 sc1
    buffer_load_dwordx4 v[92:95], v2, s[24:27], s50 offen offset:3072 sc1
    buffer_load_dwordx4 v[96:99], v2, s[24:27], s51 offen offset:0 sc1
    buffer_load_dwordx4 v[100:103], v2, s[24:27], s51 offen offset:1024 sc1
    buffer_load_dwordx4 v[104:107], v2, s[24:27], s51 offen offset:2048 sc1
    buffer_load_dwordx4 v[108:111], v2, s[24:27], s51 offen offset:3072 sc1
    s_waitcnt vmcnt(0)
    v_max3_u32 v27, v80, v84, v27
    v_max3_u32 v27, v88, v92, v27
    v_max3_u32 v27, v96, v100, v27
    v_max3_u32 v27, v104, v108, v27
    v_mfma_f32_32x32x16_bf16 v[192:207], v[80:83], a[64:67], v[192:207]
    v_mfma_f32_32x32x16_bf16 v[208:223], v[80:83], a[68:71], v[208:223]
    v_mfma_f32_32x32x16_bf16 v[192:207], v[84:87], a[72:75], v[192:207]
    v_mfma_f32_32x32x16_bf16 v[208:223], v[84:87], a[76:79], v[208:223]
    v_mfma_f32_32x32x16_bf16 v[192:207], v[88:91], a[80:83], v[192:207]
    v_mfma_f32_32x32x16_bf16 v[208:223], v[88:91], a[84:87], v[208:223]
    v_mfma_f32_32x32x16_bf16 v[192:207], v[92:95], a[88:91], v[192:207]
    v_mfma_f32_32x32x16_bf16 v[208:223], v[92:95], a[92:95], v[208:223]
    v_mfma_f32_32x32x16_bf16 v[192:207], v[96:99], a[96:99], v[192:207]
    v_mfma_f32_32x32x16_bf16 v[208:223], v[96:99], a[100:103], v[208:223]
    v_mfma_f32_32x32x16_bf16 v[192:207], v[100:103], a[104:107], v[192:207]
    v_mfma_f32_32x32x16_bf16 v[208:223], v[100:103], a[108:111], v[208:223]
    v_mfma_f32_32x32x16_bf16 v[192:207], v[104:107], a[112:115], v[192:207]
    v_mfma_f32_32x32x16_bf16 v[208:223], v[104:107], a[116:119], v[208:223]
    v_mfma_f32_32x32x16_bf16 v[192:207], v[108:111], a[120:123], v[192:207]
    v_mfma_f32_32x32x16_bf16 v[208:223], v[108:111], a[124:127], v[208:223]
    buffer_load_dwordx4 v[80:83], v2, s[24:27], s52 offen offset:0 sc1
    buffer_load_dwordx4 v[84:87], v2, s[24:27], s52 offen offset:1024 sc1
    buffer_load_dwordx4 v[88:91], v2, s[24:27], s52 offen offset:2048 sc1
    buffer_load_dwordx4 v[92:95], v2, s[24:27], s52 offen offset:3072 sc1
    buffer_load_dwordx4 v[96:99], v2, s[24:27], s53 offen offset:0 sc1
    buffer_load_dwordx4 v[100:103], v2, s[24:27], s53 offen offset:1024 sc1
    buffer_load_dwordx4 v[104:107], v2, s[24:27], s53 offen offset:2048 sc1
    buffer_load_dwordx4 v[108:111], v2, s[24:27], s53 offen offset:3072 sc1
    s_waitcnt vmcnt(0)
    v_max3_u32 v27, v80, v84, v27
    v_max3_u32 v27, v88, v92, v27
    v_max3_u32 v27, v96, v100, v27
    v_max3_u32 v27, v104, v108, v27
    v_mfma_f32_32x32x16_bf16 v[192:207], v[80:83], a[128:131], v[192:207]
    v_mfma_f32_32x32x16_bf16 v[208:223], v[80:83], a[132:135], v[208:223]
    v_mfma_f32_32x32x16_bf16 v[192:207], v[84:87], a[136:139], v[192:207]
    v_mfma_f32_32x32x16_bf16 v[208:223], v[84:87], a[140:143], v[208:223]
    v_mfma_f32_32x32x16_bf16 v[192:207], v[88:91], a[144:147], v[192:207]
    v_mfma_f32_32x32x16_bf16 v[208:223], v[88:91], a[148:151], v[208:223]
    v_mfma_f32_32x32x16_bf16 v[192:207], v[92:95], a[152:155], v[192:207]
    v_mfma_f32_32x32x16_bf16 v[208:223], v[92:95], a[156:159], v[208:223]
    v_mfma_f32_32x32x16_bf16 v[192:207], v[96:99], a[160:163], v[192:207]
    v_mfma_f32_32x32x16_bf16 v[208:223], v[96:99], a[164:167], v[208:223]
    v_mfma_f32_32x32x16_bf16 v[192:207], v[100:103], a[168:171], v[192:207]
    v_mfma_f32_32x32x16_bf16 v[208:223], v[100:103], a[172:175], v[208:223]
    v_mfma_f32_32x32x16_bf16 v[192:207], v[104:107], a[176:179], v[192:207]
    v_mfma_f32_32x32x16_bf16 v[208:223], v[104:107], a[180:183], v[208:223]
    v_mfma_f32_32x32x16_bf16 v[192:207], v[108:111], a[184:187], v[192:207]
    v_mfma_f32_32x32x16_bf16 v[208:223], v[108:111], a[188:191], v[208:223]
    buffer_load_dwordx4 v[80:83], v2, s[24:27], s54 offen offset:0 sc1
    buffer_load_dwordx4 v[84:87], v2, s[24:27], s54 offen offset:1024 sc1
    buffer_load_dwordx4 v[88:91], v2, s[24:27], s54 offen offset:2048 sc1
    buffer_load_dwordx4 v[92:95], v2, s[24:27], s54 offen offset:3072 sc1
    buffer_load_dwordx4 v[96:99], v2, s[24:27], s55 offen offset:0 sc1
    buffer_load_dwordx4 v[100:103], v2, s[24:27], s55 offen offset:1024 sc1
    buffer_load_dwordx4 v[104:107], v2, s[24:27], s55 offen offset:2048 sc1
    buffer_load_dwordx4 v[108:111], v2, s[24:27], s55 offen offset:3072 sc1
    s_waitcnt vmcnt(0)
    v_max3_u32 v27, v80, v84, v27
    v_max3_u32 v27, v88, v92, v27
    v_max3_u32 v27, v96, v100, v27
    v_max3_u32 v27, v104, v108, v27
    v_mfma_f32_32x32x16_bf16 v[192:207], v[80:83], a[192:195], v[192:207]
    v_mfma_f32_32x32x16_bf16 v[208:223], v[80:83], a[196:199], v[208:223]
    v_mfma_f32_32x32x16_bf16 v[192:207], v[84:87], a[200:203], v[192:207]
    v_mfma_f32_32x32x16_bf16 v[208:223], v[84:87], a[204:207], v[208:223]
    v_mfma_f32_32x32x16_bf16 v[192:207], v[88:91], a[208:211], v[192:207]
    v_mfma_f32_32x32x16_bf16 v[208:223], v[88:91], a[212:215], v[208:223]
    v_mfma_f32_32x32x16_bf16 v[192:207], v[92:95], a[216:219], v[192:207]
    v_mfma_f32_32x32x16_bf16 v[208:223], v[92:95], a[220:223], v[208:223]
    v_mfma_f32_32x32x16_bf16 v[192:207], v[96:99], a[224:227], v[192:207]
    v_mfma_f32_32x32x16_bf16 v[208:223], v[96:99], a[228:231], v[208:223]
    v_mfma_f32_32x32x16_bf16 v[192:207], v[100:103], a[232:235], v[192:207]
    v_mfma_f32_32x32x16_bf16 v[208:223], v[100:103], a[236:239], v[208:223]
    v_mfma_f32_32x32x16_bf16 v[192:207], v[104:107], a[240:243], v[192:207]
    v_mfma_f32_32x32x16_bf16 v[208:223], v[104:107], a[244:247], v[208:223]
    v_mfma_f32_32x32x16_bf16 v[192:207], v[108:111], a[248:251], v[192:207]
    v_mfma_f32_32x32x16_bf16 v[208:223], v[108:111], a[252:255], v[208:223]
    v_cmp_eq_u32_e64 vcc, -1, v27
    s_cbranch_vccnz L_slowA1
    s_nop 7
    s_nop 7
    s_branch L_retA1
L_slowA2:
    s_cmp_gt_u32 s91, 40000
    s_cbranch_scc1 L_retA2
    s_add_u32 s91, s91, 1
    v_mov_b32_e64 v26, 0
    buffer_load_dwordx4 v[80:83], v3, s[24:27], s48 offen offset:0 sc1
    buffer_load_dwordx4 v[84:87], v3, s[24:27], s48 offen offset:1024 sc1
    buffer_load_dwordx4 v[88:91], v3, s[24:27], s48 offen offset:2048 sc1
    buffer_load_dwordx4 v[92:95], v3, s[24:27], s48 offen offset:3072 sc1
    buffer_load_dwordx4 v[96:99], v3, s[24:27], s49 offen offset:0 sc1
    buffer_load_dwordx4 v[100:103], v3, s[24:27], s49 offen offset:1024 sc1
    buffer_load_dwordx4 v[104:107], v3, s[24:27], s49 offen offset:2048 sc1
    buffer_load_dwordx4 v[108:111], v3, s[24:27], s49 offen offset:3072 sc1
    s_waitcnt vmcnt(0)
    v_max3_u32 v26, v80, v84, v26
    v_max3_u32 v26, v88, v92, v26
    v_max3_u32 v26, v96, v100, v26
    v_max3_u32 v26, v104, v108, v26
    v_mfma_f32_32x32x16_bf16 v[224:239], v[80:83], a[0:3], 0
    v_mfma_f32_32x32x16_bf16 v[240:255], v[80:83], a[4:7], 0
    v_mfma_f32_32x32x16_bf16 v[224:239], v[84:87], a[8:11], v[224:239]
    v_mfma_f32_32x32x16_bf16 v[240:255], v[84:87], a[12:15], v[240:255]
    v_mfma_f32_32x32x16_bf16 v[224:239], v[88:91], a[16:19], v[224:239]
    v_mfma_f32_32x32x16_bf16 v[240:255], v[88:91], a[20:23], v[240:255]
    v_mfma_f32_32x32x16_bf16 v[224:239], v[92:95], a[24:27], v[224:239]
    v_mfma_f32_32x32x16_bf16 v[240:255], v[92:95], a[28:31], v[240:255]
    v_mfma_f32_32x32x16_bf16 v[224:239], v[96:99], a[32:35], v[224:239]
    v_mfma_f32_32x32x16_bf16 v[240:255], v[96:99], a[36:39], v[240:255]
    v_mfma_f32_32x32x16_bf16 v[224:239], v[100:103], a[40:43], v[224:239]
    v_mfma_f32_32x32x16_bf16 v[240:255], v[100:103], a[44:47], v[240:255]
    v_mfma_f32_32x32x16_bf16 v[224:239], v[104:107], a[48:51], v[224:239]
    v_mfma_f32_32x32x16_bf16 v[240:255], v[104:107], a[52:55], v[240:255]
    v_mfma_f32_32x32x16_bf16 v[224:239], v[108:111], a[56:59], v[224:239]
    v_mfma_f32_32x32x16_bf16 v[240:255], v[108:111], a[60:63], v[240:255]
    buffer_load_dwordx4 v[80:83], v3, s[24:27], s50 offen offset:0 sc1
    buffer_load_dwordx4 v[84:87], v3, s[24:27], s50 offen offset:1024 sc1
    buffer_load_dwordx4 v[88:91], v3, s[24:27], s50 offen offset:2048 sc1
    buffer_load_dwordx4 v[92:95], v3, s[24:27], s50 offen offset:3072 sc1
    buffer_load_dwordx4 v[96:99], v3, s[24:27], s51 offen offset:0 sc1
    buffer_load_dwordx4 v[100:103], v3, s[24:27], s51 offen offset:1024 sc1
    buffer_load_dwordx4 v[104:107], v3, s[24:27], s51 offen offset:2048 sc1
    buffer_load_dwordx4 v[108:111], v3, s[24:27], s51 offen offset:3072 sc1
    s_waitcnt vmcnt(0)
    v_max3_u32 v26, v80, v84, v26
    v_max3_u32 v26, v88, v92, v26
    v_max3_u32 v26, v96, v100, v26
    v_max3_u32 v26, v104, v108, v26
    v_mfma_f32_32x32x16_bf16 v[224:239], v[80:83], a[64:67], v[224:239]
    v_mfma_f32_32x32x16_bf16 v[240:255], v[80:83], a[68:71], v[240:255]
    v_mfma_f32_32x32x16_bf16 v[224:239], v[84:87], a[72:75], v[224:239]
    v_mfma_f32_32x32x16_bf16 v[240:255], v[84:87], a[76:79], v[240:255]
    v_mfma_f32_32x32x16_bf16 v[224:239], v[88:91], a[80:83], v[224:239]
    v_mfma_f32_32x32x16_bf16 v[240:255], v[88:91], a[84:87], v[240:255]
    v_mfma_f32_32x32x16_bf16 v[224:239], v[92:95], a[88:91], v[224:239]
    v_mfma_f32_32x32x16_bf16 v[240:255], v[92:95], a[92:95], v[240:255]
    v_mfma_f32_32x32x16_bf16 v[224:239], v[96:99], a[96:99], v[224:239]
    v_mfma_f32_32x32x16_bf16 v[240:255], v[96:99], a[100:103], v[240:255]
    v_mfma_f32_32x32x16_bf16 v[224:239], v[100:103], a[104:107], v[224:239]
    v_mfma_f32_32x32x16_bf16 v[240:255], v[100:103], a[108:111], v[240:255]
    v_mfma_f32_32x32x16_bf16 v[224:239], v[104:107], a[112:115], v[224:239]
    v_mfma_f32_32x32x16_bf16 v[240:255], v[104:107], a[116:119], v[240:255]
    v_mfma_f32_32x32x16_bf16 v[224:239], v[108:111], a[120:123], v[224:239]
    v_mfma_f32_32x32x16_bf16 v[240:255], v[108:111], a[124:127], v[240:255]
    buffer_load_dwordx4 v[80:83], v3, s[24:27], s52 offen offset:0 sc1
    buffer_load_dwordx4 v[84:87], v3, s[24:27], s52 offen offset:1024 sc1
    buffer_load_dwordx4 v[88:91], v3, s[24:27], s52 offen offset:2048 sc1
    buffer_load_dwordx4 v[92:95], v3, s[24:27], s52 offen offset:3072 sc1
    buffer_load_dwordx4 v[96:99], v3, s[24:27], s53 offen offset:0 sc1
    buffer_load_dwordx4 v[100:103], v3, s[24:27], s53 offen offset:1024 sc1
    buffer_load_dwordx4 v[104:107], v3, s[24:27], s53 offen offset:2048 sc1
    buffer_load_dwordx4 v[108:111], v3, s[24:27], s53 offen offset:3072 sc1
    s_waitcnt vmcnt(0)
    v_max3_u32 v26, v80, v84, v26
    v_max3_u32 v26, v88, v92, v26
    v_max3_u32 v26, v96, v100, v26
    v_max3_u32 v26, v104, v108, v26
    v_mfma_f32_32x32x16_bf16 v[224:239], v[80:83], a[128:131], v[224:239]
    v_mfma_f32_32x32x16_bf16 v[240:255], v[80:83], a[132:135], v[240:255]
    v_mfma_f32_32x32x16_bf16 v[224:239], v[84:87], a[136:139], v[224:239]
    v_mfma_f32_32x32x16_bf16 v[240:255], v[84:87], a[140:143], v[240:255]
    v_mfma_f32_32x32x16_bf16 v[224:239], v[88:91], a[144:147], v[224:239]
    v_mfma_f32_32x32x16_bf16 v[240:255], v[88:91], a[148:151], v[240:255]
    v_mfma_f32_32x32x16_bf16 v[224:239], v[92:95], a[152:155], v[224:239]
    v_mfma_f32_32x32x16_bf16 v[240:255], v[92:95], a[156:159], v[240:255]
    v_mfma_f32_32x32x16_bf16 v[224:239], v[96:99], a[160:163], v[224:239]
    v_mfma_f32_32x32x16_bf16 v[240:255], v[96:99], a[164:167], v[240:255]
    v_mfma_f32_32x32x16_bf16 v[224:239], v[100:103], a[168:171], v[224:239]
    v_mfma_f32_32x32x16_bf16 v[240:255], v[100:103], a[172:175], v[240:255]
    v_mfma_f32_32x32x16_bf16 v[224:239], v[104:107], a[176:179], v[224:239]
    v_mfma_f32_32x32x16_bf16 v[240:255], v[104:107], a[180:183], v[240:255]
    v_mfma_f32_32x32x16_bf16 v[224:239], v[108:111], a[184:187], v[224:239]
    v_mfma_f32_32x32x16_bf16 v[240:255], v[108:111], a[188:191], v[240:255]
    buffer_load_dwordx4 v[80:83], v3, s[24:27], s54 offen offset:0 sc1
    buffer_load_dwordx4 v[84:87], v3, s[24:27], s54 offen offset:1024 sc1
    buffer_load_dwordx4 v[88:91], v3, s[24:27], s54 offen offset:2048 sc1
    buffer_load_dwordx4 v[92:95], v3, s[24:27], s54 offen offset:3072 sc1
    buffer_load_dwordx4 v[96:99], v3, s[24:27], s55 offen offset:0 sc1
    buffer_load_dwordx4 v[100:103], v3, s[24:27], s55 offen offset:1024 sc1
    buffer_load_dwordx4 v[104:107], v3, s[24:27], s55 offen offset:2048 sc1
    buffer_load_dwordx4 v[108:111], v3, s[24:27], s55 offen offset:3072 sc1
    s_waitcnt vmcnt(0)
    v_max3_u32 v26, v80, v84, v26
    v_max3_u32 v26, v88, v92, v26
    v_max3_u32 v26, v96, v100, v26
    v_max3_u32 v26, v104, v108, v26
    v_mfma_f32_32x32x16_bf16 v[224:239], v[80:83], a[192:195], v[224:239]
    v_mfma_f32_32x32x16_bf16 v[240:255], v[80:83], a[196:199], v[240:255]
    v_mfma_f32_32x32x16_bf16 v[224:239], v[84:87], a[200:203], v[224:239]
    v_mfma_f32_32x32x16_bf16 v[240:255], v[84:87], a[204:207], v[240:255]
    v_mfma_f32_32x32x16_bf16 v[224:239], v[88:91], a[208:211], v[224:239]
    v_mfma_f32_32x32x16_bf16 v[240:255], v[88:91], a[212:215], v[240:255]
    v_mfma_f32_32x32x16_bf16 v[224:239], v[92:95], a[216:219], v[224:239]
    v_mfma_f32_32x32x16_bf16 v[240:255], v[92:95], a[220:223], v[240:255]
    v_mfma_f32_32x32x16_bf16 v[224:239], v[96:99], a[224:227], v[224:239]
    v_mfma_f32_32x32x16_bf16 v[240:255], v[96:99], a[228:231], v[240:255]
    v_mfma_f32_32x32x16_bf16 v[224:239], v[100:103], a[232:235], v[224:239]
    v_mfma_f32_32x32x16_bf16 v[240:255], v[100:103], a[236:239], v[240:255]
    v_mfma_f32_32x32x16_bf16 v[224:239], v[104:107], a[240:243], v[224:239]
    v_mfma_f32_32x32x16_bf16 v[240:255], v[104:107], a[244:247], v[240:255]
    v_mfma_f32_32x32x16_bf16 v[224:239], v[108:111], a[248:251], v[224:239]
    v_mfma_f32_32x32x16_bf16 v[240:255], v[108:111], a[252:255], v[240:255]
    v_cmp_eq_u32_e64 vcc, -1, v26
    s_cbranch_vccnz L_slowA2
    s_nop 7
    s_nop 7
    s_branch L_retA2
L_hA0_retry:
    s_cmp_gt_u32 s91, 40000
    s_cbranch_scc1 L_hA0_ok
    s_add_u32 s91, s91, 1
    s_add_u32 s3, s65, s56
    buffer_load_dwordx4 v[128:131], v1, s[24:27], s3 offen sc1
    s_add_u32 s3, s65, s57
    buffer_load_dwordx4 v[132:135], v1, s[24:27], s3 offen sc1
    s_add_u32 s3, s65, s58
    buffer_load_dwordx4 v[136:139], v1, s[24:27], s3 offen sc1
    s_add_u32 s3, s65, s59
    buffer_load_dwordx4 v[140:143], v1, s[24:27], s3 offen sc1
    s_add_u32 s3, s65, s60
    buffer_load_dwordx4 v[144:147], v1, s[24:27], s3 offen sc1
    s_add_u32 s3, s65, s61
    buffer_load_dwordx4 v[148:151], v1, s[24:27], s3 offen sc1
    s_add_u32 s3, s65, s62
    buffer_load_dwordx4 v[152:155], v1, s[24:27], s3 offen sc1
    s_add_u32 s3, s65, s63
    buffer_load_dwordx4 v[156:159], v1, s[24:27], s3 offen sc1
    s_waitcnt vmcnt(0)
    s_branch L_hA0_chk
L_hA1_retry:
    s_cmp_gt_u32 s91, 40000
    s_cbranch_scc1 L_hA1_ok
    s_add_u32 s91, s91, 1
    s_add_u32 s3, s79, s56
    buffer_load_dwordx4 v[160:163], v1, s[24:27], s3 offen sc1
    s_add_u32 s3, s79, s57
    buffer_load_dwordx4 v[164:167], v1, s[24:27], s3 offen sc1
    s_add_u32 s3, s79, s58
    buffer_load_dwordx4 v[168:171], v1, s[24:27], s3 offen sc1
    s_add_u32 s3, s79, s59
    buffer_load_dwordx4 v[172:175], v1, s[24:27], s3 offen sc1
    s_add_u32 s3, s79, s60
    buffer_load_dwordx4 v[176:179], v1, s[24:27], s3 offen sc1
    s_add_u32 s3, s79, s61
    buffer_load_dwordx4 v[180:183], v1, s[24:27], s3 offen sc1
    s_add_u32 s3, s79, s62
    buffer_load_dwordx4 v[184:187], v1, s[24:27], s3 offen sc1
    s_add_u32 s3, s79, s63
    buffer_load_dwordx4 v[188:191], v1, s[24:27], s3 offen sc1
    s_waitcnt vmcnt(0)
    s_branch L_hA1_chk
L_hA2_retry:
    s_cmp_gt_u32 s91, 40000
    s_cbranch_scc1 L_hA2_ok
    s_add_u32 s91, s91, 1
    s_add_u32 s3, s65, s74
    buffer_load_dwordx4 v[192:195], v1, s[24:27], s3 offen sc1
    s_add_u32 s3, s65, s75
    buffer_load_dwordx4 v[196:199], v1, s[24:27], s3 offen sc1
    s_add_u32 s3, s65, s76
    buffer_load_dwordx4 v[200:203], v1, s[24:27], s3 offen sc1
    s_add_u32 s3, s65, s84
    buffer_load_dwordx4 v[204:207], v1, s[24:27], s3 offen sc1
    s_add_u32 s3, s65, s88
    buffer_load_dwordx4 v[208:211], v1, s[24:27], s3 offen sc1
    s_add_u32 s3, s65, s45
    buffer_load_dwordx4 v[212:215], v1, s[24:27], s3 offen sc1
    s_waitcnt vmcnt(0)
    s_branch L_hA2_chk
L_yA_retry:
    s_cmp_gt_u32 s91, 40000
    s_cbranch_scc1 L_yA_ok
    s_add_u32 s91, s91, 1
    s_mov_b32 s7, s66
    s_add_u32 s6, s7, s68
    buffer_load_dwordx2 v[56:57], v10, s[24:27], s7 offen sc1
    buffer_load_dword v64, v11, s[24:27], s6 offen offset:4 sc1
    s_add_u32 s7, s7, s67
    s_add_u32 s6, s7, s68
    buffer_load_dwordx2 v[58:59], v10, s[24:27], s7 offen sc1
    buffer_load_dword v65, v10, s[24:27], s6 offen offset:4 sc1
    s_add_u32 s7, s7, s67
    s_add_u32 s6, s7, s68
    buffer_load_dwordx2 v[60:61], v10, s[24:27], s7 offen sc1
    buffer_load_dword v66, v10, s[24:27], s6 offen offset:4 sc1
    s_add_u32 s7, s7, s67
    s_add_u32 s6, s7, s68
    buffer_load_dwordx2 v[62:63], v10, s[24:27], s7 offen sc1
    buffer_load_dword v67, v10, s[24:27], s6 offen offset:4 sc1
    s_waitcnt vmcnt(0)
    s_branch L_yA_chk
L_slowB0:
    s_cmp_gt_u32 s91, 40000
    s_cbranch_scc1 L_retB0
    s_add_u32 s91, s91, 1
    v_mov_b32 v26, 0
    buffer_load_dwordx4 v[80:83], v1, s[24:27], s48 offen offset:0 sc1
    buffer_load_dwordx4 v[84:87], v1, s[24:27], s48 offen offset:1024 sc1
    buffer_load_dwordx4 v[88:91], v1, s[24:27], s48 offen offset:2048 sc1
    buffer_load_dwordx4 v[92:95], v1, s[24:27], s48 offen offset:3072 sc1
    buffer_load_dwordx4 v[96:99], v1, s[24:27], s49 offen offset:0 sc1
    buffer_load_dwordx4 v[100:103], v1, s[24:27], s49 offen offset:1024 sc1
    buffer_load_dwordx4 v[104:107], v1, s[24:27], s49 offen offset:2048 sc1
    buffer_load_dwordx4 v[108:111], v1, s[24:27], s49 offen offset:3072 sc1
    s_waitcnt vmcnt(0)
    v_max3_u32 v26, v80, v84, v26
    v_max3_u32 v26, v88, v92, v26
    v_max3_u32 v26, v96, v100, v26
    v_max3_u32 v26, v104, v108, v26
    v_mfma_f32_32x32x16_bf16 v[192:207], v[80:83], a[0:3], 0
    v_mfma_f32_32x32x16_bf16 v[208:223], v[80:83], a[4:7], 0
    v_mfma_f32_32x32x16_bf16 v[192:207], v[84:87], a[8:11], v[192:207]
    v_mfma_f32_32x32x16_bf16 v[208:223], v[84:87], a[12:15], v[208:223]
    v_mfma_f32_32x32x16_bf16 v[192:207], v[88:91], a[16:19], v[192:207]
    v_mfma_f32_32x32x16_bf16 v[208:223], v[88:91], a[20:23], v[208:223]
    v_mfma_f32_32x32x16_bf16 v[192:207], v[92:95], a[24:27], v[192:207]
    v_mfma_f32_32x32x16_bf16 v[208:223], v[92:95], a[28:31], v[208:223]
    v_mfma_f32_32x32x16_bf16 v[192:207], v[96:99], a[32:35], v[192:207]
    v_mfma_f32_32x32x16_bf16 v[208:223], v[96:99], a[36:39], v[208:223]
    v_mfma_f32_32x32x16_bf16 v[192:207], v[100:103], a[40:43], v[192:207]
    v_mfma_f32_32x32x16_bf16 v[208:223], v[100:103], a[44:47], v[208:223]
    v_mfma_f32_32x32x16_bf16 v[192:207], v[104:107], a[48:51], v[192:207]
    v_mfma_f32_32x32x16_bf16 v[208:223], v[104:107], a[52:55], v[208:223]
    v_mfma_f32_32x32x16_bf16 v[192:207], v[108:111], a[56:59], v[192:207]
    v_mfma_f32_32x32x16_bf16 v[208:223], v[108:111], a[60:63], v[208:223]
    buffer_load_dwordx4 v[80:83], v1, s[24:27], s50 offen offset:0 sc1
    buffer_load_dwordx4 v[84:87], v1, s[24:27], s50 offen offset:1024 sc1
    buffer_load_dwordx4 v[88:91], v1, s[24:27], s50 offen offset:2048 sc1
    buffer_load_dwordx4 v[92:95], v1, s[24:27], s50 offen offset:3072 sc1
    buffer_load_dwordx4 v[96:99], v1, s[24:27], s51 offen offset:0 sc1
    buffer_load_dwordx4 v[100:103], v1, s[24:27], s51 offen offset:1024 sc1
    buffer_load_dwordx4 v[104:107], v1, s[24:27], s51 offen offset:2048 sc1
    buffer_load_dwordx4 v[108:111], v1, s[24:27], s51 offen offset:3072 sc1
    s_waitcnt vmcnt(0)
    v_max3_u32 v26, v80, v84, v26
    v_max3_u32 v26, v88, v92, v26
    v_max3_u32 v26, v96, v100, v26
    v_max3_u32 v26, v104, v108, v26
    v_mfma_f32_32x32x16_bf16 v[192:207], v[80:83], a[64:67], v[192:207]
    v_mfma_f32_32x32x16_bf16 v[208:223], v[80:83], a[68:71], v[208:223]
    v_mfma_f32_32x32x16_bf16 v[192:207], v[84:87], a[72:75], v[192:207]
    v_mfma_f32_32x32x16_bf16 v[208:223], v[84:87], a[76:79], v[208:223]
    v_mfma_f32_32x32x16_bf16 v[192:207], v[88:91], a[80:83], v[192:207]
    v_mfma_f32_32x32x16_bf16 v[208:223], v[88:91], a[84:87], v[208:223]
    v_mfma_f32_32x32x16_bf16 v[192:207], v[92:95], a[88:91], v[192:207]
    v_mfma_f32_32x32x16_bf16 v[208:223], v[92:95], a[92:95], v[208:223]
    v_mfma_f32_32x32x16_bf16 v[192:207], v[96:99], a[96:99], v[192:207]
    v_mfma_f32_32x32x16_bf16 v[208:223], v[96:99], a[100:103], v[208:223]
    v_mfma_f32_32x32x16_bf16 v[192:207], v[100:103], a[104:107], v[192:207]
    v_mfma_f32_32x32x16_bf16 v[208:223], v[100:103], a[108:111], v[208:223]
    v_mfma_f32_32x32x16_bf16 v[192:207], v[104:107], a[112:115], v[192:207]
    v_mfma_f32_32x32x16_bf16 v[208:223], v[104:107], a[116:119], v[208:223]
    v_mfma_f32_32x32x16_bf16 v[192:207], v[108:111], a[120:123], v[192:207]
    v_mfma_f32_32x32x16_bf16 v[208:223], v[108:111], a[124:127], v[208:223]
    buffer_load_dwordx4 v[80:83], v1, s[24:27], s52 offen offset:0 sc1
    buffer_load_dwordx4 v[84:87], v1, s[24:27], s52 offen offset:1024 sc1
    buffer_load_dwordx4 v[88:91], v1, s[24:27], s52 offen offset:2048 sc1
    buffer_load_dwordx4 v[92:95], v1, s[24:27], s52 offen offset:3072 sc1
    buffer_load_dwordx4 v[96:99], v1, s[24:27], s53 offen offset:0 sc1
    buffer_load_dwordx4 v[100:103], v1, s[24:27], s53 offen offset:1024 sc1
    buffer_load_dwordx4 v[104:107], v1, s[24:27], s53 offen offset:2048 sc1
    buffer_load_dwordx4 v[108:111], v1, s[24:27], s53 offen offset:3072 sc1
    s_waitcnt vmcnt(0)
    v_max3_u32 v26, v80, v84, v26
    v_max3_u32 v26, v88, v92, v26
    v_max3_u32 v26, v96, v100, v26
    v_max3_u32 v26, v104, v108, v26
    v_mfma_f32_32x32x16_bf16 v[192:207], v[80:83], a[128:131], v[192:207]
    v_mfma_f32_32x32x16_bf16 v[208:223], v[80:83], a[132:135], v[208:223]
    v_mfma_f32_32x32x16_bf16 v[192:207], v[84:87], a[136:139], v[192:207]
    v_mfma_f32_32x32x16_bf16 v[208:223], v[84:87], a[140:143], v[208:223]
    v_mfma_f32_32x32x16_bf16 v[192:207], v[88:91], a[144:147], v[192:207]
    v_mfma_f32_32x32x16_bf16 v[208:223], v[88:91], a[148:151], v[208:223]
    v_mfma_f32_32x32x16_bf16 v[192:207], v[92:95], a[152:155], v[192:207]
    v_mfma_f32_32x32x16_bf16 v[208:223], v[92:95], a[156:159], v[208:223]
    v_mfma_f32_32x32x16_bf16 v[192:207], v[96:99], a[160:163], v[192:207]
    v_mfma_f32_32x32x16_bf16 v[208:223], v[96:99], a[164:167], v[208:223]
    v_mfma_f32_32x32x16_bf16 v[192:207], v[100:103], a[168:171], v[192:207]
    v_mfma_f32_32x32x16_bf16 v[208:223], v[100:103], a[172:175], v[208:223]
    v_mfma_f32_32x32x16_bf16 v[192:207], v[104:107], a[176:179], v[192:207]
    v_mfma_f32_32x32x16_bf16 v[208:223], v[104:107], a[180:183], v[208:223]
    v_mfma_f32_32x32x16_bf16 v[192:207], v[108:111], a[184:187], v[192:207]
    v_mfma_f32_32x32x16_bf16 v[208:223], v[108:111], a[188:191], v[208:223]
    buffer_load_dwordx4 v[80:83], v1, s[24:27], s54 offen offset:0 sc1
    buffer_load_dwordx4 v[84:87], v1, s[24:27], s54 offen offset:1024 sc1
    buffer_load_dwordx4 v[88:91], v1, s[24:27], s54 offen offset:2048 sc1
    buffer_load_dwordx4 v[92:95], v1, s[24:27], s54 offen offset:3072 sc1
    buffer_load_dwordx4 v[96:99], v1, s[24:27], s55 offen offset:0 sc1
    buffer_load_dwordx4 v[100:103], v1, s[24:27], s55 offen offset:1024 sc1
    buffer_load_dwordx4 v[104:107], v1, s[24:27], s55 offen offset:2048 sc1
    buffer_load_dwordx4 v[108:111], v1, s[24:27], s55 offen offset:3072 sc1
    s_waitcnt vmcnt(0)
    v_max3_u32 v26, v80, v84, v26
    v_max3_u32 v26, v88, v92, v26
    v_max3_u32 v26, v96, v100, v26
    v_max3_u32 v26, v104, v108, v26
    v_mfma_f32_32x32x16_bf16 v[192:207], v[80:83], a[192:195], v[192:207]
    v_mfma_f32_32x32x16_bf16 v[208:223], v[80:83], a[196:199], v[208:223]
    v_mfma_f32_32x32x16_bf16 v[192:207], v[84:87], a[200:203], v[192:207]
    v_mfma_f32_32x32x16_bf16 v[208:223], v[84:87], a[204:207], v[208:223]
    v_mfma_f32_32x32x16_bf16 v[192:207], v[88:91], a[208:211], v[192:207]
    v_mfma_f32_32x32x16_bf16 v[208:223], v[88:91], a[212:215], v[208:223]
    v_mfma_f32_32x32x16_bf16 v[192:207], v[92:95], a[216:219], v[192:207]
    v_mfma_f32_32x32x16_bf16 v[208:223], v[92:95], a[220:223], v[208:223]
    v_mfma_f32_32x32x16_bf16 v[192:207], v[96:99], a[224:227], v[192:207]
    v_mfma_f32_32x32x16_bf16 v[208:223], v[96:99], a[228:231], v[208:223]
    v_mfma_f32_32x32x16_bf16 v[192:207], v[100:103], a[232:235], v[192:207]
    v_mfma_f32_32x32x16_bf16 v[208:223], v[100:103], a[236:239], v[208:223]
    v_mfma_f32_32x32x16_bf16 v[192:207], v[104:107], a[240:243], v[192:207]
    v_mfma_f32_32x32x16_bf16 v[208:223], v[104:107], a[244:247], v[208:223]
    v_mfma_f32_32x32x16_bf16 v[192:207], v[108:111], a[248:251], v[192:207]
    v_mfma_f32_32x32x16_bf16 v[208:223], v[108:111], a[252:255], v[208:223]
    v_cmp_eq_u32_e64 vcc, -1, v26
    s_cbranch_vccnz L_slowB0
    s_nop 7
    s_nop 7
    s_branch L_retB0
L_d2B_retry:
    v_mul_u32_u24 v25, 260, v0
    v_and_b32 v25, 0x3e04, v25
    v_or_b32 v25, 9240576, v25
    buffer_load_dword v30, v25, s[24:27], 0 offen sc1
    s_waitcnt vmcnt(0)
    s_add_u32 s91, s91, 1
    s_cmp_gt_u32 s91, 40000
    s_cbranch_scc1 L_d2B_ok
    s_branch L_d2B_chk
L_slowB1:
    s_cmp_gt_u32 s91, 40000
    s_cbranch_scc1 L_retB1
    s_add_u32 s91, s91, 1
    v_mov_b32_e64 v27, 0
    buffer_load_dwordx4 v[80:83], v2, s[24:27], s48 offen offset:0 sc1
    buffer_load_dwordx4 v[84:87], v2, s[24:27], s48 offen offset:1024 sc1
    buffer_load_dwordx4 v[88:91], v2, s[24:27], s48 offen offset:2048 sc1
    buffer_load_dwordx4 v[92:95], v2, s[24:27], s48 offen offset:3072 sc1
    buffer_load_dwordx4 v[96:99], v2, s[24:27], s49 offen offset:0 sc1
    buffer_load_dwordx4 v[100:103], v2, s[24:27], s49 offen offset:1024 sc1
    buffer_load_dwordx4 v[104:107], v2, s[24:27], s49 offen offset:2048 sc1
    buffer_load_dwordx4 v[108:111], v2, s[24:27], s49 offen offset:3072 sc1
    s_waitcnt vmcnt(0)
    v_max3_u32 v27, v80, v84, v27
    v_max3_u32 v27, v88, v92, v27
    v_max3_u32 v27, v96, v100, v27
    v_max3_u32 v27, v104, v108, v27
    v_mfma_f32_32x32x16_bf16 v[224:239], v[80:83], a[0:3], 0
    v_mfma_f32_32x32x16_bf16 v[240:255], v[80:83], a[4:7], 0
    v_mfma_f32_32x32x16_bf16 v[224:239], v[84:87], a[8:11], v[224:239]
    v_mfma_f32_32x32x16_bf16 v[240:255], v[84:87], a[12:15], v[240:255]
    v_mfma_f32_32x32x16_bf16 v[224:239], v[88:91], a[16:19], v[224:239]
    v_mfma_f32_32x32x16_bf16 v[240:255], v[88:91], a[20:23], v[240:255]
    v_mfma_f32_32x32x16_bf16 v[224:239], v[92:95], a[24:27], v[224:239]
    v_mfma_f32_32x32x16_bf16 v[240:255], v[92:95], a[28:31], v[240:255]
    v_mfma_f32_32x32x16_bf16 v[224:239], v[96:99], a[32:35], v[224:239]
    v_mfma_f32_32x32x16_bf16 v[240:255], v[96:99], a[36:39], v[240:255]
    v_mfma_f32_32x32x16_bf16 v[224:239], v[100:103], a[40:43], v[224:239]
    v_mfma_f32_32x32x16_bf16 v[240:255], v[100:103], a[44:47], v[240:255]
    v_mfma_f32_32x32x16_bf16 v[224:239], v[104:107], a[48:51], v[224:239]
    v_mfma_f32_32x32x16_bf16 v[240:255], v[104:107], a[52:55], v[240:255]
    v_mfma_f32_32x32x16_bf16 v[224:239], v[108:111], a[56:59], v[224:239]
    v_mfma_f32_32x32x16_bf16 v[240:255], v[108:111], a[60:63], v[240:255]
    buffer_load_dwordx4 v[80:83], v2, s[24:27], s50 offen offset:0 sc1
    buffer_load_dwordx4 v[84:87], v2, s[24:27], s50 offen offset:1024 sc1
    buffer_load_dwordx4 v[88:91], v2, s[24:27], s50 offen offset:2048 sc1
    buffer_load_dwordx4 v[92:95], v2, s[24:27], s50 offen offset:3072 sc1
    buffer_load_dwordx4 v[96:99], v2, s[24:27], s51 offen offset:0 sc1
    buffer_load_dwordx4 v[100:103], v2, s[24:27], s51 offen offset:1024 sc1
    buffer_load_dwordx4 v[104:107], v2, s[24:27], s51 offen offset:2048 sc1
    buffer_load_dwordx4 v[108:111], v2, s[24:27], s51 offen offset:3072 sc1
    s_waitcnt vmcnt(0)
    v_max3_u32 v27, v80, v84, v27
    v_max3_u32 v27, v88, v92, v27
    v_max3_u32 v27, v96, v100, v27
    v_max3_u32 v27, v104, v108, v27
    v_mfma_f32_32x32x16_bf16 v[224:239], v[80:83], a[64:67], v[224:239]
    v_mfma_f32_32x32x16_bf16 v[240:255], v[80:83], a[68:71], v[240:255]
    v_mfma_f32_32x32x16_bf16 v[224:239], v[84:87], a[72:75], v[224:239]
    v_mfma_f32_32x32x16_bf16 v[240:255], v[84:87], a[76:79], v[240:255]
    v_mfma_f32_32x32x16_bf16 v[224:239], v[88:91], a[80:83], v[224:239]
    v_mfma_f32_32x32x16_bf16 v[240:255], v[88:91], a[84:87], v[240:255]
    v_mfma_f32_32x32x16_bf16 v[224:239], v[92:95], a[88:91], v[224:239]
    v_mfma_f32_32x32x16_bf16 v[240:255], v[92:95], a[92:95], v[240:255]
    v_mfma_f32_32x32x16_bf16 v[224:239], v[96:99], a[96:99], v[224:239]
    v_mfma_f32_32x32x16_bf16 v[240:255], v[96:99], a[100:103], v[240:255]
    v_mfma_f32_32x32x16_bf16 v[224:239], v[100:103], a[104:107], v[224:239]
    v_mfma_f32_32x32x16_bf16 v[240:255], v[100:103], a[108:111], v[240:255]
    v_mfma_f32_32x32x16_bf16 v[224:239], v[104:107], a[112:115], v[224:239]
    v_mfma_f32_32x32x16_bf16 v[240:255], v[104:107], a[116:119], v[240:255]
    v_mfma_f32_32x32x16_bf16 v[224:239], v[108:111], a[120:123], v[224:239]
    v_mfma_f32_32x32x16_bf16 v[240:255], v[108:111], a[124:127], v[240:255]
    buffer_load_dwordx4 v[80:83], v2, s[24:27], s52 offen offset:0 sc1
    buffer_load_dwordx4 v[84:87], v2, s[24:27], s52 offen offset:1024 sc1
    buffer_load_dwordx4 v[88:91], v2, s[24:27], s52 offen offset:2048 sc1
    buffer_load_dwordx4 v[92:95], v2, s[24:27], s52 offen offset:3072 sc1
    buffer_load_dwordx4 v[96:99], v2, s[24:27], s53 offen offset:0 sc1
    buffer_load_dwordx4 v[100:103], v2, s[24:27], s53 offen offset:1024 sc1
    buffer_load_dwordx4 v[104:107], v2, s[24:27], s53 offen offset:2048 sc1
    buffer_load_dwordx4 v[108:111], v2, s[24:27], s53 offen offset:3072 sc1
    s_waitcnt vmcnt(0)
    v_max3_u32 v27, v80, v84, v27
    v_max3_u32 v27, v88, v92, v27
    v_max3_u32 v27, v96, v100, v27
    v_max3_u32 v27, v104, v108, v27
    v_mfma_f32_32x32x16_bf16 v[224:239], v[80:83], a[128:131], v[224:239]
    v_mfma_f32_32x32x16_bf16 v[240:255], v[80:83], a[132:135], v[240:255]
    v_mfma_f32_32x32x16_bf16 v[224:239], v[84:87], a[136:139], v[224:239]
    v_mfma_f32_32x32x16_bf16 v[240:255], v[84:87], a[140:143], v[240:255]
    v_mfma_f32_32x32x16_bf16 v[224:239], v[88:91], a[144:147], v[224:239]
    v_mfma_f32_32x32x16_bf16 v[240:255], v[88:91], a[148:151], v[240:255]
    v_mfma_f32_32x32x16_bf16 v[224:239], v[92:95], a[152:155], v[224:239]
    v_mfma_f32_32x32x16_bf16 v[240:255], v[92:95], a[156:159], v[240:255]
    v_mfma_f32_32x32x16_bf16 v[224:239], v[96:99], a[160:163], v[224:239]
    v_mfma_f32_32x32x16_bf16 v[240:255], v[96:99], a[164:167], v[240:255]
    v_mfma_f32_32x32x16_bf16 v[224:239], v[100:103], a[168:171], v[224:239]
    v_mfma_f32_32x32x16_bf16 v[240:255], v[100:103], a[172:175], v[240:255]
    v_mfma_f32_32x32x16_bf16 v[224:239], v[104:107], a[176:179], v[224:239]
    v_mfma_f32_32x32x16_bf16 v[240:255], v[104:107], a[180:183], v[240:255]
    v_mfma_f32_32x32x16_bf16 v[224:239], v[108:111], a[184:187], v[224:239]
    v_mfma_f32_32x32x16_bf16 v[240:255], v[108:111], a[188:191], v[240:255]
    buffer_load_dwordx4 v[80:83], v2, s[24:27], s54 offen offset:0 sc1
    buffer_load_dwordx4 v[84:87], v2, s[24:27], s54 offen offset:1024 sc1
    buffer_load_dwordx4 v[88:91], v2, s[24:27], s54 offen offset:2048 sc1
    buffer_load_dwordx4 v[92:95], v2, s[24:27], s54 offen offset:3072 sc1
    buffer_load_dwordx4 v[96:99], v2, s[24:27], s55 offen offset:0 sc1
    buffer_load_dwordx4 v[100:103], v2, s[24:27], s55 offen offset:1024 sc1
    buffer_load_dwordx4 v[104:107], v2, s[24:27], s55 offen offset:2048 sc1
    buffer_load_dwordx4 v[108:111], v2, s[24:27], s55 offen offset:3072 sc1
    s_waitcnt vmcnt(0)
    v_max3_u32 v27, v80, v84, v27
    v_max3_u32 v27, v88, v92, v27
    v_max3_u32 v27, v96, v100, v27
    v_max3_u32 v27, v104, v108, v27
    v_mfma_f32_32x32x16_bf16 v[224:239], v[80:83], a[192:195], v[224:239]
    v_mfma_f32_32x32x16_bf16 v[240:255], v[80:83], a[196:199], v[240:255]
    v_mfma_f32_32x32x16_bf16 v[224:239], v[84:87], a[200:203], v[224:239]
    v_mfma_f32_32x32x16_bf16 v[240:255], v[84:87], a[204:207], v[240:255]
    v_mfma_f32_32x32x16_bf16 v[224:239], v[88:91], a[208:211], v[224:239]
    v_mfma_f32_32x32x16_bf16 v[240:255], v[88:91], a[212:215], v[240:255]
    v_mfma_f32_32x32x16_bf16 v[224:239], v[92:95], a[216:219], v[224:239]
    v_mfma_f32_32x32x16_bf16 v[240:255], v[92:95], a[220:223], v[240:255]
    v_mfma_f32_32x32x16_bf16 v[224:239], v[96:99], a[224:227], v[224:239]
    v_mfma_f32_32x32x16_bf16 v[240:255], v[96:99], a[228:231], v[240:255]
    v_mfma_f32_32x32x16_bf16 v[224:239], v[100:103], a[232:235], v[224:239]
    v_mfma_f32_32x32x16_bf16 v[240:255], v[100:103], a[236:239], v[240:255]
    v_mfma_f32_32x32x16_bf16 v[224:239], v[104:107], a[240:243], v[224:239]
    v_mfma_f32_32x32x16_bf16 v[240:255], v[104:107], a[244:247], v[240:255]
    v_mfma_f32_32x32x16_bf16 v[224:239], v[108:111], a[248:251], v[224:239]
    v_mfma_f32_32x32x16_bf16 v[240:255], v[108:111], a[252:255], v[240:255]
    v_cmp_eq_u32 vcc, -1, v27
    s_cbranch_vccnz L_slowB1
    s_nop 7
    s_nop 7
    s_branch L_retB1
L_hB0_retry:
    s_cmp_gt_u32 s91, 40000
    s_cbranch_scc1 L_hB0_ok
    s_add_u32 s91, s91, 1
    s_add_u32 s3, s65, s56
    buffer_load_dwordx4 a[192:195], v1, s[24:27], s3 offen sc1
    s_add_u32 s3, s65, s57
    buffer_load_dwordx4 a[196:199], v1, s[24:27], s3 offen sc1
    s_add_u32 s3, s65, s58
    buffer_load_dwordx4 a[200:203], v1, s[24:27], s3 offen sc1
    s_add_u32 s3, s65, s59
    buffer_load_dwordx4 a[204:207], v1, s[24:27], s3 offen sc1
    s_add_u32 s3, s65, s60
    buffer_load_dwordx4 a[208:211], v1, s[24:27], s3 offen sc1
    s_add_u32 s3, s65, s61
    buffer_load_dwordx4 a[212:215], v1, s[24:27], s3 offen sc1
    s_add_u32 s3, s65, s62
    buffer_load_dwordx4 a[216:219], v1, s[24:27], s3 offen sc1
    s_add_u32 s3, s65, s63
    buffer_load_dwordx4 a[220:223], v1, s[24:27], s3 offen sc1
    s_waitcnt vmcnt(0)
    s_branch L_hB0_chk
L_hB1_retry:
    s_cmp_gt_u32 s91, 40000
    s_cbranch_scc1 L_hB1_ok
    s_add_u32 s91, s91, 1
    s_add_u32 s3, s79, s56
    buffer_load_dwordx4 a[224:227], v1, s[24:27], s3 offen sc1
    s_add_u32 s3, s79, s57
    buffer_load_dwordx4 a[228:231], v1, s[24:27], s3 offen sc1
    s_add_u32 s3, s79, s58
    buffer_load_dwordx4 a[232:235], v1, s[24:27], s3 offen sc1
    s_add_u32 s3, s79, s59
    buffer_load_dwordx4 a[236:239], v1, s[24:27], s3 offen sc1
    s_add_u32 s3, s79, s60
    buffer_load_dwordx4 a[240:243], v1, s[24:27], s3 offen sc1
    s_add_u32 s3, s79, s61
    buffer_load_dwordx4 a[244:247], v1, s[24:27], s3 offen sc1
    s_add_u32 s3, s79, s62
    buffer_load_dwordx4 a[248:251], v1, s[24:27], s3 offen sc1
    s_add_u32 s3, s79, s63
    buffer_load_dwordx4 a[252:255], v1, s[24:27], s3 offen sc1
    s_waitcnt vmcnt(0)
    s_branch L_hB1_chk
L_hB2_retry:
    s_cmp_gt_u32 s91, 40000
    s_cbranch_scc1 L_hB2_ok
    s_add_u32 s91, s91, 1
    s_add_u32 s3, s65, s74
    buffer_load_dwordx4 v[192:195], v1, s[24:27], s3 offen sc1
    s_add_u32 s3, s65, s75
    buffer_load_dwordx4 v[196:199], v1, s[24:27], s3 offen sc1
    s_add_u32 s3, s65, s76
    buffer_load_dwordx4 v[200:203], v1, s[24:27], s3 offen sc1
    s_add_u32 s3, s65, s84
    buffer_load_dwordx4 v[204:207], v1, s[24:27], s3 offen sc1
    s_add_u32 s3, s65, s88
    buffer_load_dwordx4 v[208:211], v1, s[24:27], s3 offen sc1
    s_add_u32 s3, s65, s45
    buffer_load_dwordx4 v[212:215], v1, s[24:27], s3 offen sc1
    s_waitcnt vmcnt(0)
    s_branch L_hB2_chk
L_yB_retry:
    s_cmp_gt_u32 s91, 40000
    s_cbranch_scc1 L_yB_ok
    s_add_u32 s91, s91, 1
    s_mov_b32 s7, s66
    buffer_load_dwordx2 v[56:57], v10, s[24:27], s7 offen sc1
    s_add_u32 s7, s7, s67
    buffer_load_dwordx2 v[58:59], v10, s[24:27], s7 offen sc1
    s_add_u32 s7, s7, s67
    buffer_load_dwordx2 v[60:61], v10, s[24:27], s7 offen sc1
    s_add_u32 s7, s7, s67
    buffer_load_dwordx2 v[62:63], v10, s[24:27], s7 offen sc1
    s_waitcnt vmcnt(0)
    s_branch L_yB_chk
L_end:
    s_endpgm
L_codeend:
.section .rodata,"a"
.p2align 6
.amdhsa_kernel parallel_sum__spectral_fnet__mixer_gmlp__prompt_kernel
  .amdhsa_next_free_vgpr 512
  .amdhsa_next_free_sgpr 102
  .amdhsa_accum_offset 256
  .amdhsa_group_segment_fixed_size 0
  .amdhsa_kernarg_size 104
  .amdhsa_user_sgpr_count 2
  .amdhsa_user_sgpr_kernarg_segment_ptr 1
  .amdhsa_system_sgpr_workgroup_id_x 1
.end_amdhsa_kernel
```
